```python
import torch

def _softmax(x, axis=-1):
    return torch.softmax(x, dim=axis)

def _gelu(x):
    return torch.nn.functional.gelu(x, approximate='tanh')

def _silu(x):
    return torch.nn.functional.silu(x)

def _sigmoid(x):
    return torch.sigmoid(x)

def _layernorm(x, axis=-1, eps=1e-05):
    m = x.mean(dim=axis, keepdim=True)
    v = x.var(dim=axis, keepdim=True, unbiased=False)
    return (x - m) / torch.sqrt(v + eps)

def _scatter_add(tgt, idx, src, axis=0):
    return tgt.clone().index_add_(axis, idx, src)

def _segment_sum(src, seg, n):
    out = torch.zeros((n,) + src.shape[1:], dtype=src.dtype)
    return out.index_add_(0, seg, src)

def _pad(x, pw):
    flat = tuple((v for pair in reversed(pw) for v in pair))
    return torch.nn.functional.pad(x, flat)
kernel_name = 'adaLN_cond__gqa_block_cached__geglu_ffn__decode'

def setup_inputs():

    _w = lambda a: (lambda t: t.to(torch.bfloat16) if t.is_floating_point() else t)(torch.as_tensor(a))

    def _A_setup():
        B, Sq, D = (8, 1, 576)
        Hq, Hkv, Sk, Dh = (32, 16, 8192, 128)
        assert Hq % Hkv == 0, (Hq, Hkv)
        return {'x': _w((lambda *s: torch.randn(*s, dtype=torch.bfloat16) * 0.1)(B, Sq, D)), 'k_cache': _w((lambda *s: torch.randn(*s, dtype=torch.bfloat16) * 0.8)(B, Hkv, Sk, Dh)), 'v_cache': _w((lambda *s: torch.randn(*s, dtype=torch.bfloat16) * 0.8)(B, Hkv, Sk, Dh)), 'wq': _w((lambda *s: torch.randn(*s, dtype=torch.bfloat16) * 0.8)(D, Hq * Dh) * D ** (-0.5)), 'wo': _w((lambda *s: torch.randn(*s, dtype=torch.bfloat16) * 0.8)(Hq * Dh, D) * (Hq * Dh) ** (-0.5))}
    _A_in = _A_setup()

    def _B_setup():
        B, S, D, F = (8, 1, 576, 4608)
        return {'x': _w((lambda *s: torch.randn(*s, dtype=torch.bfloat16) * 0.1)(B, S, D)), 'w_gate': _w((lambda *s: torch.randn(*s, dtype=torch.bfloat16) * 0.1)(D, F)), 'w_up': _w((lambda *s: torch.randn(*s, dtype=torch.bfloat16) * 0.1)(D, F)), 'w_down': _w((lambda *s: torch.randn(*s, dtype=torch.bfloat16) * 0.1)(F, D))}
    _B_in = _B_setup()
    return {'A_x': _A_in['x'], 'A_k_cache': _A_in['k_cache'], 'A_v_cache': _A_in['v_cache'], 'A_wq': _A_in['wq'], 'A_wo': _A_in['wo'], 'B_x': _B_in['x'], 'B_w_gate': _B_in['w_gate'], 'B_w_up': _B_in['w_up'], 'B_w_down': _B_in['w_down'], 'c': _w((lambda *s: torch.randn(*s, dtype=torch.bfloat16) * 0.4)(8, 576) * 8.0), 'w_mod': _w((lambda *s: torch.randn(*s, dtype=torch.bfloat16) * 0.4)(576, 6 * 576) * 576 ** (-0.5) * 8.0)}

def reference(A_x, A_k_cache, A_v_cache, A_wq, A_wo, B_x, B_w_gate, B_w_up, B_w_down, c, w_mod):

    def _A_ref(x, k_cache, v_cache, wq, wo):
        B, Sq, D = x.shape
        Hq, Dh = (32, 128)
        Hkv = k_cache.shape[1]
        rep = Hq // Hkv
        q = (lambda x, *d: x.permute(*d))((x @ wq).reshape(B, Sq, Hq, Dh), 0, 2, 1, 3)
        k = (lambda x, n, axis: torch.repeat_interleave(x, n, dim=axis))(k_cache, rep, axis=1)
        v = (lambda x, n, axis: torch.repeat_interleave(x, n, dim=axis))(v_cache, rep, axis=1)
        scores = torch.einsum('bhqd,bhkd->bhqk', q, k) * Dh ** (-0.5)
        p = _softmax(scores, axis=-1)
        o = torch.einsum('bhqk,bhkd->bhqd', p, v)
        return (lambda x, *d: x.permute(*d))(o, 0, 2, 1, 3).reshape(B, Sq, Hq * Dh) @ wo

    def _B_ref(x, w_gate, w_up, w_down):
        return _gelu(x @ w_gate) * (x @ w_up) @ w_down
    x = A_x
    mod = (_silu(c) @ w_mod).reshape(c.shape[0], 6, 1, -1)
    sa, ca, ga, sb, cb, gb = (mod[:, 0].clone(), mod[:, 1].clone(), mod[:, 2].clone(), mod[:, 3].clone(), mod[:, 4].clone(), mod[:, 5].clone())
    h = _layernorm(x, axis=-1) * (1 + ca) + sa
    x = x + ga * _A_ref(h, A_k_cache, A_v_cache, A_wq, A_wo)
    h = _layernorm(x, axis=-1) * (1 + cb) + sb
    x = x + gb * _B_ref(h, B_w_gate, B_w_up, B_w_down)
    return x
```

```asm
; @launch kernel=ka_kernel grid=(54,1,1) block=(256,1,1) lds=83968
; @launch kernel=kb_kernel grid=(64,1,1) block=(256,1,1) lds=83968
; @launch kernel=kc_kernel grid=(1024,1,1) block=(256,1,1) lds=16640
; @launch kernel=kd_kernel grid=(72,1,1) block=(256,1,1) lds=83968
; @launch kernel=ke_kernel grid=(144,1,1) block=(256,1,1) lds=83968
; @launch kernel=kf_kernel grid=(72,1,1) block=(256,1,1) lds=83968
; @launch kernel=kg_kernel grid=(18,1,1) block=(256,1,1) lds=0
.amdgcn_target "amdgcn-amd-amdhsa--gfx950"
.text
.globl ka_kernel
.p2align 8
.type ka_kernel,@function
ka_kernel:
    s_cmp_ge_u32 s2, 54
    s_cbranch_scc1 L_end_ka_kernel
    s_load_dwordx2 s[28:29], s[0:1], 80
    s_load_dwordx2 s[36:37], s[0:1], 104
    s_load_dwordx2 s[38:39], s[0:1], 72
    s_waitcnt lgkmcnt(0)
    s_mov_b32 s30, s2
    s_mov_b32 s31, 0
    s_mov_b32 s45, 0
    s_mov_b32 s8, s28
    s_and_b32 s9, s29, 0xffff
    s_mov_b32 s10, 0x3cc000
    s_mov_b32 s11, 0x20000
    s_mov_b32 s12, s36
    s_and_b32 s13, s37, 0xffff
    s_mov_b32 s14, 0x40000000
    s_mov_b32 s15, 0x20000
    s_mov_b32 s16, s38
    s_and_b32 s17, s39, 0xffff
    s_mov_b32 s18, 0x2400
    s_mov_b32 s19, 0x20000
    v_and_b32 v1, 63, v0
    v_lshrrev_b32 v2, 6, v0
    v_lshrrev_b32 v3, 3, v1
    v_and_b32 v4, 7, v1
    v_lshl_add_u32 v5, v2, 3, v3
    s_mov_b32 s33, 6912
    v_mul_lo_u32 v6, v5, s33
    v_lshl_add_u32 v6, v4, 4, v6
    v_lshlrev_b32 v7, 5, v5
    s_lshl_b32 s32, s30, 7
    s_mul_i32 s34, s31, 3981312
    s_add_u32 s32, s32, s34
    buffer_load_dwordx4 v[128:131], v6, s[8:11], s32 offen
    s_add_u32 s32, s32, 221184
    buffer_load_dwordx4 v[132:135], v6, s[8:11], s32 offen
    s_add_u32 s32, s32, 221184
    buffer_load_dwordx4 v[136:139], v6, s[8:11], s32 offen
    s_add_u32 s32, s32, 221184
    buffer_load_dwordx4 v[140:143], v6, s[8:11], s32 offen
    s_add_u32 s32, s32, 221184
    buffer_load_dwordx4 v[144:147], v6, s[8:11], s32 offen
    s_add_u32 s32, s32, 221184
    buffer_load_dwordx4 v[148:151], v6, s[8:11], s32 offen
    s_add_u32 s32, s32, 221184
    buffer_load_dwordx4 v[152:155], v6, s[8:11], s32 offen
    s_add_u32 s32, s32, 221184
    buffer_load_dwordx4 v[156:159], v6, s[8:11], s32 offen
    s_add_u32 s32, s32, 221184
    buffer_load_dwordx4 v[160:163], v6, s[8:11], s32 offen
    s_add_u32 s32, s32, 221184
    buffer_load_dwordx4 v[164:167], v6, s[8:11], s32 offen
    s_add_u32 s32, s32, 221184
    buffer_load_dwordx4 v[168:171], v6, s[8:11], s32 offen
    s_add_u32 s32, s32, 221184
    buffer_load_dwordx4 v[172:175], v6, s[8:11], s32 offen
    s_add_u32 s32, s32, 221184
    buffer_load_dwordx4 v[176:179], v6, s[8:11], s32 offen
    s_add_u32 s32, s32, 221184
    buffer_load_dwordx4 v[180:183], v6, s[8:11], s32 offen
    s_add_u32 s32, s32, 221184
    buffer_load_dwordx4 v[184:187], v6, s[8:11], s32 offen
    s_add_u32 s32, s32, 221184
    buffer_load_dwordx4 v[188:191], v6, s[8:11], s32 offen
    s_add_u32 s32, s32, 221184
    buffer_load_dwordx4 v[192:195], v6, s[8:11], s32 offen
    s_add_u32 s32, s32, 221184
    buffer_load_dwordx4 v[196:199], v6, s[8:11], s32 offen
    v_lshlrev_b32 v216, 1, v0
    s_mov_b32 s48, 0
    buffer_load_ushort v8, v216, s[16:19], s48 offen offset:0
    buffer_load_ushort v9, v216, s[16:19], s48 offen offset:512
    buffer_load_ushort v10, v216, s[16:19], s48 offen offset:1024
    s_mov_b32 s48, 1152
    buffer_load_ushort v11, v216, s[16:19], s48 offen offset:0
    buffer_load_ushort v12, v216, s[16:19], s48 offen offset:512
    buffer_load_ushort v13, v216, s[16:19], s48 offen offset:1024
    s_mov_b32 s48, 2304
    buffer_load_ushort v14, v216, s[16:19], s48 offen offset:0
    buffer_load_ushort v15, v216, s[16:19], s48 offen offset:512
    buffer_load_ushort v16, v216, s[16:19], s48 offen offset:1024
    s_mov_b32 s48, 3456
    buffer_load_ushort v17, v216, s[16:19], s48 offen offset:0
    buffer_load_ushort v18, v216, s[16:19], s48 offen offset:512
    buffer_load_ushort v19, v216, s[16:19], s48 offen offset:1024
    s_mov_b32 s48, 4608
    buffer_load_ushort v20, v216, s[16:19], s48 offen offset:0
    buffer_load_ushort v21, v216, s[16:19], s48 offen offset:512
    buffer_load_ushort v22, v216, s[16:19], s48 offen offset:1024
    s_mov_b32 s48, 5760
    buffer_load_ushort v23, v216, s[16:19], s48 offen offset:0
    buffer_load_ushort v24, v216, s[16:19], s48 offen offset:512
    buffer_load_ushort v25, v216, s[16:19], s48 offen offset:1024
    s_mov_b32 s48, 6912
    buffer_load_ushort v26, v216, s[16:19], s48 offen offset:0
    buffer_load_ushort v27, v216, s[16:19], s48 offen offset:512
    buffer_load_ushort v28, v216, s[16:19], s48 offen offset:1024
    s_mov_b32 s48, 8064
    buffer_load_ushort v29, v216, s[16:19], s48 offen offset:0
    buffer_load_ushort v30, v216, s[16:19], s48 offen offset:512
    buffer_load_ushort v31, v216, s[16:19], s48 offen offset:1024
    s_mov_b32 s40, 0xbfb8aa3b
    v_lshlrev_b32 v217, 5, v0
    s_waitcnt vmcnt(0)
    v_lshlrev_b32 v8, 16, v8
    v_mul_f32 v218, s40, v8
    v_exp_f32 v218, v218
    s_nop 0
    v_add_f32 v218, 1.0, v218
    v_rcp_f32 v218, v218
    s_nop 0
    v_mul_f32 v8, v8, v218
    v_lshlrev_b32 v9, 16, v9
    v_mul_f32 v218, s40, v9
    v_exp_f32 v218, v218
    s_nop 0
    v_add_f32 v218, 1.0, v218
    v_rcp_f32 v218, v218
    s_nop 0
    v_mul_f32 v9, v9, v218
    v_lshlrev_b32 v10, 16, v10
    v_mul_f32 v218, s40, v10
    v_exp_f32 v218, v218
    s_nop 0
    v_add_f32 v218, 1.0, v218
    v_rcp_f32 v218, v218
    s_nop 0
    v_mul_f32 v10, v10, v218
    v_lshlrev_b32 v11, 16, v11
    v_mul_f32 v218, s40, v11
    v_exp_f32 v218, v218
    s_nop 0
    v_add_f32 v218, 1.0, v218
    v_rcp_f32 v218, v218
    s_nop 0
    v_mul_f32 v11, v11, v218
    v_lshlrev_b32 v12, 16, v12
    v_mul_f32 v218, s40, v12
    v_exp_f32 v218, v218
    s_nop 0
    v_add_f32 v218, 1.0, v218
    v_rcp_f32 v218, v218
    s_nop 0
    v_mul_f32 v12, v12, v218
    v_lshlrev_b32 v13, 16, v13
    v_mul_f32 v218, s40, v13
    v_exp_f32 v218, v218
    s_nop 0
    v_add_f32 v218, 1.0, v218
    v_rcp_f32 v218, v218
    s_nop 0
    v_mul_f32 v13, v13, v218
    v_lshlrev_b32 v14, 16, v14
    v_mul_f32 v218, s40, v14
    v_exp_f32 v218, v218
    s_nop 0
    v_add_f32 v218, 1.0, v218
    v_rcp_f32 v218, v218
    s_nop 0
    v_mul_f32 v14, v14, v218
    v_lshlrev_b32 v15, 16, v15
    v_mul_f32 v218, s40, v15
    v_exp_f32 v218, v218
    s_nop 0
    v_add_f32 v218, 1.0, v218
    v_rcp_f32 v218, v218
    s_nop 0
    v_mul_f32 v15, v15, v218
    v_lshlrev_b32 v16, 16, v16
    v_mul_f32 v218, s40, v16
    v_exp_f32 v218, v218
    s_nop 0
    v_add_f32 v218, 1.0, v218
    v_rcp_f32 v218, v218
    s_nop 0
    v_mul_f32 v16, v16, v218
    v_lshlrev_b32 v17, 16, v17
    v_mul_f32 v218, s40, v17
    v_exp_f32 v218, v218
    s_nop 0
    v_add_f32 v218, 1.0, v218
    v_rcp_f32 v218, v218
    s_nop 0
    v_mul_f32 v17, v17, v218
    v_lshlrev_b32 v18, 16, v18
    v_mul_f32 v218, s40, v18
    v_exp_f32 v218, v218
    s_nop 0
    v_add_f32 v218, 1.0, v218
    v_rcp_f32 v218, v218
    s_nop 0
    v_mul_f32 v18, v18, v218
    v_lshlrev_b32 v19, 16, v19
    v_mul_f32 v218, s40, v19
    v_exp_f32 v218, v218
    s_nop 0
    v_add_f32 v218, 1.0, v218
    v_rcp_f32 v218, v218
    s_nop 0
    v_mul_f32 v19, v19, v218
    v_lshlrev_b32 v20, 16, v20
    v_mul_f32 v218, s40, v20
    v_exp_f32 v218, v218
    s_nop 0
    v_add_f32 v218, 1.0, v218
    v_rcp_f32 v218, v218
    s_nop 0
    v_mul_f32 v20, v20, v218
    v_lshlrev_b32 v21, 16, v21
    v_mul_f32 v218, s40, v21
    v_exp_f32 v218, v218
    s_nop 0
    v_add_f32 v218, 1.0, v218
    v_rcp_f32 v218, v218
    s_nop 0
    v_mul_f32 v21, v21, v218
    v_lshlrev_b32 v22, 16, v22
    v_mul_f32 v218, s40, v22
    v_exp_f32 v218, v218
    s_nop 0
    v_add_f32 v218, 1.0, v218
    v_rcp_f32 v218, v218
    s_nop 0
    v_mul_f32 v22, v22, v218
    v_lshlrev_b32 v23, 16, v23
    v_mul_f32 v218, s40, v23
    v_exp_f32 v218, v218
    s_nop 0
    v_add_f32 v218, 1.0, v218
    v_rcp_f32 v218, v218
    s_nop 0
    v_mul_f32 v23, v23, v218
    v_lshlrev_b32 v24, 16, v24
    v_mul_f32 v218, s40, v24
    v_exp_f32 v218, v218
    s_nop 0
    v_add_f32 v218, 1.0, v218
    v_rcp_f32 v218, v218
    s_nop 0
    v_mul_f32 v24, v24, v218
    v_lshlrev_b32 v25, 16, v25
    v_mul_f32 v218, s40, v25
    v_exp_f32 v218, v218
    s_nop 0
    v_add_f32 v218, 1.0, v218
    v_rcp_f32 v218, v218
    s_nop 0
    v_mul_f32 v25, v25, v218
    v_lshlrev_b32 v26, 16, v26
    v_mul_f32 v218, s40, v26
    v_exp_f32 v218, v218
    s_nop 0
    v_add_f32 v218, 1.0, v218
    v_rcp_f32 v218, v218
    s_nop 0
    v_mul_f32 v26, v26, v218
    v_lshlrev_b32 v27, 16, v27
    v_mul_f32 v218, s40, v27
    v_exp_f32 v218, v218
    s_nop 0
    v_add_f32 v218, 1.0, v218
    v_rcp_f32 v218, v218
    s_nop 0
    v_mul_f32 v27, v27, v218
    v_lshlrev_b32 v28, 16, v28
    v_mul_f32 v218, s40, v28
    v_exp_f32 v218, v218
    s_nop 0
    v_add_f32 v218, 1.0, v218
    v_rcp_f32 v218, v218
    s_nop 0
    v_mul_f32 v28, v28, v218
    v_lshlrev_b32 v29, 16, v29
    v_mul_f32 v218, s40, v29
    v_exp_f32 v218, v218
    s_nop 0
    v_add_f32 v218, 1.0, v218
    v_rcp_f32 v218, v218
    s_nop 0
    v_mul_f32 v29, v29, v218
    v_lshlrev_b32 v30, 16, v30
    v_mul_f32 v218, s40, v30
    v_exp_f32 v218, v218
    s_nop 0
    v_add_f32 v218, 1.0, v218
    v_rcp_f32 v218, v218
    s_nop 0
    v_mul_f32 v30, v30, v218
    v_lshlrev_b32 v31, 16, v31
    v_mul_f32 v218, s40, v31
    v_exp_f32 v218, v218
    s_nop 0
    v_add_f32 v218, 1.0, v218
    v_rcp_f32 v218, v218
    s_nop 0
    v_mul_f32 v31, v31, v218
    ds_write_b32 v217, v8 offset:0
    ds_write_b32 v217, v9 offset:8192
    ds_write_b32 v217, v11 offset:4
    ds_write_b32 v217, v12 offset:8196
    ds_write_b32 v217, v14 offset:8
    ds_write_b32 v217, v15 offset:8200
    ds_write_b32 v217, v17 offset:12
    ds_write_b32 v217, v18 offset:8204
    ds_write_b32 v217, v20 offset:16
    ds_write_b32 v217, v21 offset:8208
    ds_write_b32 v217, v23 offset:20
    ds_write_b32 v217, v24 offset:8212
    ds_write_b32 v217, v26 offset:24
    ds_write_b32 v217, v27 offset:8216
    ds_write_b32 v217, v29 offset:28
    ds_write_b32 v217, v30 offset:8220
    v_cmp_gt_u32 vcc, 64, v0
    s_nop 1
    s_and_saveexec_b64 s[42:43], vcc
    ds_write_b32 v217, v10 offset:16384
    ds_write_b32 v217, v13 offset:16388
    ds_write_b32 v217, v16 offset:16392
    ds_write_b32 v217, v19 offset:16396
    ds_write_b32 v217, v22 offset:16400
    ds_write_b32 v217, v25 offset:16404
    ds_write_b32 v217, v28 offset:16408
    ds_write_b32 v217, v31 offset:16412
    s_mov_b64 exec, s[42:43]
    s_waitcnt vmcnt(0) lgkmcnt(0)
    s_barrier
    v_mov_b32 v64, 0
    v_mov_b32 v65, 0
    v_mov_b32 v66, 0
    v_mov_b32 v67, 0
    v_mov_b32 v68, 0
    v_mov_b32 v69, 0
    v_mov_b32 v70, 0
    v_mov_b32 v71, 0
    v_mov_b32 v72, 0
    v_mov_b32 v73, 0
    v_mov_b32 v74, 0
    v_mov_b32 v75, 0
    v_mov_b32 v76, 0
    v_mov_b32 v77, 0
    v_mov_b32 v78, 0
    v_mov_b32 v79, 0
    v_mov_b32 v80, 0
    v_mov_b32 v81, 0
    v_mov_b32 v82, 0
    v_mov_b32 v83, 0
    v_mov_b32 v84, 0
    v_mov_b32 v85, 0
    v_mov_b32 v86, 0
    v_mov_b32 v87, 0
    v_mov_b32 v88, 0
    v_mov_b32 v89, 0
    v_mov_b32 v90, 0
    v_mov_b32 v91, 0
    v_mov_b32 v92, 0
    v_mov_b32 v93, 0
    v_mov_b32 v94, 0
    v_mov_b32 v95, 0
    v_mov_b32 v96, 0
    v_mov_b32 v97, 0
    v_mov_b32 v98, 0
    v_mov_b32 v99, 0
    v_mov_b32 v100, 0
    v_mov_b32 v101, 0
    v_mov_b32 v102, 0
    v_mov_b32 v103, 0
    v_mov_b32 v104, 0
    v_mov_b32 v105, 0
    v_mov_b32 v106, 0
    v_mov_b32 v107, 0
    v_mov_b32 v108, 0
    v_mov_b32 v109, 0
    v_mov_b32 v110, 0
    v_mov_b32 v111, 0
    v_mov_b32 v112, 0
    v_mov_b32 v113, 0
    v_mov_b32 v114, 0
    v_mov_b32 v115, 0
    v_mov_b32 v116, 0
    v_mov_b32 v117, 0
    v_mov_b32 v118, 0
    v_mov_b32 v119, 0
    v_mov_b32 v120, 0
    v_mov_b32 v121, 0
    v_mov_b32 v122, 0
    v_mov_b32 v123, 0
    v_mov_b32 v124, 0
    v_mov_b32 v125, 0
    v_mov_b32 v126, 0
    v_mov_b32 v127, 0
    ds_read_b128 v[200:203], v7 offset:0
    ds_read_b128 v[204:207], v7 offset:16
    v_lshlrev_b32 v208, 16, v128
    v_and_b32 v209, 0xffff0000, v128
    v_lshlrev_b32 v210, 16, v129
    v_and_b32 v211, 0xffff0000, v129
    v_lshlrev_b32 v212, 16, v130
    v_and_b32 v213, 0xffff0000, v130
    v_lshlrev_b32 v214, 16, v131
    v_and_b32 v215, 0xffff0000, v131
    s_waitcnt lgkmcnt(0)
    v_fmac_f32 v64, v200, v208
    v_fmac_f32 v65, v200, v209
    v_fmac_f32 v66, v200, v210
    v_fmac_f32 v67, v200, v211
    v_fmac_f32 v68, v200, v212
    v_fmac_f32 v69, v200, v213
    v_fmac_f32 v70, v200, v214
    v_fmac_f32 v71, v200, v215
    v_fmac_f32 v72, v201, v208
    v_fmac_f32 v73, v201, v209
    v_fmac_f32 v74, v201, v210
    v_fmac_f32 v75, v201, v211
    v_fmac_f32 v76, v201, v212
    v_fmac_f32 v77, v201, v213
    v_fmac_f32 v78, v201, v214
    v_fmac_f32 v79, v201, v215
    v_fmac_f32 v80, v202, v208
    v_fmac_f32 v81, v202, v209
    v_fmac_f32 v82, v202, v210
    v_fmac_f32 v83, v202, v211
    v_fmac_f32 v84, v202, v212
    v_fmac_f32 v85, v202, v213
    v_fmac_f32 v86, v202, v214
    v_fmac_f32 v87, v202, v215
    v_fmac_f32 v88, v203, v208
    v_fmac_f32 v89, v203, v209
    v_fmac_f32 v90, v203, v210
    v_fmac_f32 v91, v203, v211
    v_fmac_f32 v92, v203, v212
    v_fmac_f32 v93, v203, v213
    v_fmac_f32 v94, v203, v214
    v_fmac_f32 v95, v203, v215
    v_fmac_f32 v96, v204, v208
    v_fmac_f32 v97, v204, v209
    v_fmac_f32 v98, v204, v210
    v_fmac_f32 v99, v204, v211
    v_fmac_f32 v100, v204, v212
    v_fmac_f32 v101, v204, v213
    v_fmac_f32 v102, v204, v214
    v_fmac_f32 v103, v204, v215
    v_fmac_f32 v104, v205, v208
    v_fmac_f32 v105, v205, v209
    v_fmac_f32 v106, v205, v210
    v_fmac_f32 v107, v205, v211
    v_fmac_f32 v108, v205, v212
    v_fmac_f32 v109, v205, v213
    v_fmac_f32 v110, v205, v214
    v_fmac_f32 v111, v205, v215
    v_fmac_f32 v112, v206, v208
    v_fmac_f32 v113, v206, v209
    v_fmac_f32 v114, v206, v210
    v_fmac_f32 v115, v206, v211
    v_fmac_f32 v116, v206, v212
    v_fmac_f32 v117, v206, v213
    v_fmac_f32 v118, v206, v214
    v_fmac_f32 v119, v206, v215
    v_fmac_f32 v120, v207, v208
    v_fmac_f32 v121, v207, v209
    v_fmac_f32 v122, v207, v210
    v_fmac_f32 v123, v207, v211
    v_fmac_f32 v124, v207, v212
    v_fmac_f32 v125, v207, v213
    v_fmac_f32 v126, v207, v214
    v_fmac_f32 v127, v207, v215
    ds_read_b128 v[200:203], v7 offset:1024
    ds_read_b128 v[204:207], v7 offset:1040
    v_lshlrev_b32 v208, 16, v132
    v_and_b32 v209, 0xffff0000, v132
    v_lshlrev_b32 v210, 16, v133
    v_and_b32 v211, 0xffff0000, v133
    v_lshlrev_b32 v212, 16, v134
    v_and_b32 v213, 0xffff0000, v134
    v_lshlrev_b32 v214, 16, v135
    v_and_b32 v215, 0xffff0000, v135
    s_waitcnt lgkmcnt(0)
    v_fmac_f32 v64, v200, v208
    v_fmac_f32 v65, v200, v209
    v_fmac_f32 v66, v200, v210
    v_fmac_f32 v67, v200, v211
    v_fmac_f32 v68, v200, v212
    v_fmac_f32 v69, v200, v213
    v_fmac_f32 v70, v200, v214
    v_fmac_f32 v71, v200, v215
    v_fmac_f32 v72, v201, v208
    v_fmac_f32 v73, v201, v209
    v_fmac_f32 v74, v201, v210
    v_fmac_f32 v75, v201, v211
    v_fmac_f32 v76, v201, v212
    v_fmac_f32 v77, v201, v213
    v_fmac_f32 v78, v201, v214
    v_fmac_f32 v79, v201, v215
    v_fmac_f32 v80, v202, v208
    v_fmac_f32 v81, v202, v209
    v_fmac_f32 v82, v202, v210
    v_fmac_f32 v83, v202, v211
    v_fmac_f32 v84, v202, v212
    v_fmac_f32 v85, v202, v213
    v_fmac_f32 v86, v202, v214
    v_fmac_f32 v87, v202, v215
    v_fmac_f32 v88, v203, v208
    v_fmac_f32 v89, v203, v209
    v_fmac_f32 v90, v203, v210
    v_fmac_f32 v91, v203, v211
    v_fmac_f32 v92, v203, v212
    v_fmac_f32 v93, v203, v213
    v_fmac_f32 v94, v203, v214
    v_fmac_f32 v95, v203, v215
    v_fmac_f32 v96, v204, v208
    v_fmac_f32 v97, v204, v209
    v_fmac_f32 v98, v204, v210
    v_fmac_f32 v99, v204, v211
    v_fmac_f32 v100, v204, v212
    v_fmac_f32 v101, v204, v213
    v_fmac_f32 v102, v204, v214
    v_fmac_f32 v103, v204, v215
    v_fmac_f32 v104, v205, v208
    v_fmac_f32 v105, v205, v209
    v_fmac_f32 v106, v205, v210
    v_fmac_f32 v107, v205, v211
    v_fmac_f32 v108, v205, v212
    v_fmac_f32 v109, v205, v213
    v_fmac_f32 v110, v205, v214
    v_fmac_f32 v111, v205, v215
    v_fmac_f32 v112, v206, v208
    v_fmac_f32 v113, v206, v209
    v_fmac_f32 v114, v206, v210
    v_fmac_f32 v115, v206, v211
    v_fmac_f32 v116, v206, v212
    v_fmac_f32 v117, v206, v213
    v_fmac_f32 v118, v206, v214
    v_fmac_f32 v119, v206, v215
    v_fmac_f32 v120, v207, v208
    v_fmac_f32 v121, v207, v209
    v_fmac_f32 v122, v207, v210
    v_fmac_f32 v123, v207, v211
    v_fmac_f32 v124, v207, v212
    v_fmac_f32 v125, v207, v213
    v_fmac_f32 v126, v207, v214
    v_fmac_f32 v127, v207, v215
    ds_read_b128 v[200:203], v7 offset:2048
    ds_read_b128 v[204:207], v7 offset:2064
    v_lshlrev_b32 v208, 16, v136
    v_and_b32 v209, 0xffff0000, v136
    v_lshlrev_b32 v210, 16, v137
    v_and_b32 v211, 0xffff0000, v137
    v_lshlrev_b32 v212, 16, v138
    v_and_b32 v213, 0xffff0000, v138
    v_lshlrev_b32 v214, 16, v139
    v_and_b32 v215, 0xffff0000, v139
    s_waitcnt lgkmcnt(0)
    v_fmac_f32 v64, v200, v208
    v_fmac_f32 v65, v200, v209
    v_fmac_f32 v66, v200, v210
    v_fmac_f32 v67, v200, v211
    v_fmac_f32 v68, v200, v212
    v_fmac_f32 v69, v200, v213
    v_fmac_f32 v70, v200, v214
    v_fmac_f32 v71, v200, v215
    v_fmac_f32 v72, v201, v208
    v_fmac_f32 v73, v201, v209
    v_fmac_f32 v74, v201, v210
    v_fmac_f32 v75, v201, v211
    v_fmac_f32 v76, v201, v212
    v_fmac_f32 v77, v201, v213
    v_fmac_f32 v78, v201, v214
    v_fmac_f32 v79, v201, v215
    v_fmac_f32 v80, v202, v208
    v_fmac_f32 v81, v202, v209
    v_fmac_f32 v82, v202, v210
    v_fmac_f32 v83, v202, v211
    v_fmac_f32 v84, v202, v212
    v_fmac_f32 v85, v202, v213
    v_fmac_f32 v86, v202, v214
    v_fmac_f32 v87, v202, v215
    v_fmac_f32 v88, v203, v208
    v_fmac_f32 v89, v203, v209
    v_fmac_f32 v90, v203, v210
    v_fmac_f32 v91, v203, v211
    v_fmac_f32 v92, v203, v212
    v_fmac_f32 v93, v203, v213
    v_fmac_f32 v94, v203, v214
    v_fmac_f32 v95, v203, v215
    v_fmac_f32 v96, v204, v208
    v_fmac_f32 v97, v204, v209
    v_fmac_f32 v98, v204, v210
    v_fmac_f32 v99, v204, v211
    v_fmac_f32 v100, v204, v212
    v_fmac_f32 v101, v204, v213
    v_fmac_f32 v102, v204, v214
    v_fmac_f32 v103, v204, v215
    v_fmac_f32 v104, v205, v208
    v_fmac_f32 v105, v205, v209
    v_fmac_f32 v106, v205, v210
    v_fmac_f32 v107, v205, v211
    v_fmac_f32 v108, v205, v212
    v_fmac_f32 v109, v205, v213
    v_fmac_f32 v110, v205, v214
    v_fmac_f32 v111, v205, v215
    v_fmac_f32 v112, v206, v208
    v_fmac_f32 v113, v206, v209
    v_fmac_f32 v114, v206, v210
    v_fmac_f32 v115, v206, v211
    v_fmac_f32 v116, v206, v212
    v_fmac_f32 v117, v206, v213
    v_fmac_f32 v118, v206, v214
    v_fmac_f32 v119, v206, v215
    v_fmac_f32 v120, v207, v208
    v_fmac_f32 v121, v207, v209
    v_fmac_f32 v122, v207, v210
    v_fmac_f32 v123, v207, v211
    v_fmac_f32 v124, v207, v212
    v_fmac_f32 v125, v207, v213
    v_fmac_f32 v126, v207, v214
    v_fmac_f32 v127, v207, v215
    ds_read_b128 v[200:203], v7 offset:3072
    ds_read_b128 v[204:207], v7 offset:3088
    v_lshlrev_b32 v208, 16, v140
    v_and_b32 v209, 0xffff0000, v140
    v_lshlrev_b32 v210, 16, v141
    v_and_b32 v211, 0xffff0000, v141
    v_lshlrev_b32 v212, 16, v142
    v_and_b32 v213, 0xffff0000, v142
    v_lshlrev_b32 v214, 16, v143
    v_and_b32 v215, 0xffff0000, v143
    s_waitcnt lgkmcnt(0)
    v_fmac_f32 v64, v200, v208
    v_fmac_f32 v65, v200, v209
    v_fmac_f32 v66, v200, v210
    v_fmac_f32 v67, v200, v211
    v_fmac_f32 v68, v200, v212
    v_fmac_f32 v69, v200, v213
    v_fmac_f32 v70, v200, v214
    v_fmac_f32 v71, v200, v215
    v_fmac_f32 v72, v201, v208
    v_fmac_f32 v73, v201, v209
    v_fmac_f32 v74, v201, v210
    v_fmac_f32 v75, v201, v211
    v_fmac_f32 v76, v201, v212
    v_fmac_f32 v77, v201, v213
    v_fmac_f32 v78, v201, v214
    v_fmac_f32 v79, v201, v215
    v_fmac_f32 v80, v202, v208
    v_fmac_f32 v81, v202, v209
    v_fmac_f32 v82, v202, v210
    v_fmac_f32 v83, v202, v211
    v_fmac_f32 v84, v202, v212
    v_fmac_f32 v85, v202, v213
    v_fmac_f32 v86, v202, v214
    v_fmac_f32 v87, v202, v215
    v_fmac_f32 v88, v203, v208
    v_fmac_f32 v89, v203, v209
    v_fmac_f32 v90, v203, v210
    v_fmac_f32 v91, v203, v211
    v_fmac_f32 v92, v203, v212
    v_fmac_f32 v93, v203, v213
    v_fmac_f32 v94, v203, v214
    v_fmac_f32 v95, v203, v215
    v_fmac_f32 v96, v204, v208
    v_fmac_f32 v97, v204, v209
    v_fmac_f32 v98, v204, v210
    v_fmac_f32 v99, v204, v211
    v_fmac_f32 v100, v204, v212
    v_fmac_f32 v101, v204, v213
    v_fmac_f32 v102, v204, v214
    v_fmac_f32 v103, v204, v215
    v_fmac_f32 v104, v205, v208
    v_fmac_f32 v105, v205, v209
    v_fmac_f32 v106, v205, v210
    v_fmac_f32 v107, v205, v211
    v_fmac_f32 v108, v205, v212
    v_fmac_f32 v109, v205, v213
    v_fmac_f32 v110, v205, v214
    v_fmac_f32 v111, v205, v215
    v_fmac_f32 v112, v206, v208
    v_fmac_f32 v113, v206, v209
    v_fmac_f32 v114, v206, v210
    v_fmac_f32 v115, v206, v211
    v_fmac_f32 v116, v206, v212
    v_fmac_f32 v117, v206, v213
    v_fmac_f32 v118, v206, v214
    v_fmac_f32 v119, v206, v215
    v_fmac_f32 v120, v207, v208
    v_fmac_f32 v121, v207, v209
    v_fmac_f32 v122, v207, v210
    v_fmac_f32 v123, v207, v211
    v_fmac_f32 v124, v207, v212
    v_fmac_f32 v125, v207, v213
    v_fmac_f32 v126, v207, v214
    v_fmac_f32 v127, v207, v215
    ds_read_b128 v[200:203], v7 offset:4096
    ds_read_b128 v[204:207], v7 offset:4112
    v_lshlrev_b32 v208, 16, v144
    v_and_b32 v209, 0xffff0000, v144
    v_lshlrev_b32 v210, 16, v145
    v_and_b32 v211, 0xffff0000, v145
    v_lshlrev_b32 v212, 16, v146
    v_and_b32 v213, 0xffff0000, v146
    v_lshlrev_b32 v214, 16, v147
    v_and_b32 v215, 0xffff0000, v147
    s_waitcnt lgkmcnt(0)
    v_fmac_f32 v64, v200, v208
    v_fmac_f32 v65, v200, v209
    v_fmac_f32 v66, v200, v210
    v_fmac_f32 v67, v200, v211
    v_fmac_f32 v68, v200, v212
    v_fmac_f32 v69, v200, v213
    v_fmac_f32 v70, v200, v214
    v_fmac_f32 v71, v200, v215
    v_fmac_f32 v72, v201, v208
    v_fmac_f32 v73, v201, v209
    v_fmac_f32 v74, v201, v210
    v_fmac_f32 v75, v201, v211
    v_fmac_f32 v76, v201, v212
    v_fmac_f32 v77, v201, v213
    v_fmac_f32 v78, v201, v214
    v_fmac_f32 v79, v201, v215
    v_fmac_f32 v80, v202, v208
    v_fmac_f32 v81, v202, v209
    v_fmac_f32 v82, v202, v210
    v_fmac_f32 v83, v202, v211
    v_fmac_f32 v84, v202, v212
    v_fmac_f32 v85, v202, v213
    v_fmac_f32 v86, v202, v214
    v_fmac_f32 v87, v202, v215
    v_fmac_f32 v88, v203, v208
    v_fmac_f32 v89, v203, v209
    v_fmac_f32 v90, v203, v210
    v_fmac_f32 v91, v203, v211
    v_fmac_f32 v92, v203, v212
    v_fmac_f32 v93, v203, v213
    v_fmac_f32 v94, v203, v214
    v_fmac_f32 v95, v203, v215
    v_fmac_f32 v96, v204, v208
    v_fmac_f32 v97, v204, v209
    v_fmac_f32 v98, v204, v210
    v_fmac_f32 v99, v204, v211
    v_fmac_f32 v100, v204, v212
    v_fmac_f32 v101, v204, v213
    v_fmac_f32 v102, v204, v214
    v_fmac_f32 v103, v204, v215
    v_fmac_f32 v104, v205, v208
    v_fmac_f32 v105, v205, v209
    v_fmac_f32 v106, v205, v210
    v_fmac_f32 v107, v205, v211
    v_fmac_f32 v108, v205, v212
    v_fmac_f32 v109, v205, v213
    v_fmac_f32 v110, v205, v214
    v_fmac_f32 v111, v205, v215
    v_fmac_f32 v112, v206, v208
    v_fmac_f32 v113, v206, v209
    v_fmac_f32 v114, v206, v210
    v_fmac_f32 v115, v206, v211
    v_fmac_f32 v116, v206, v212
    v_fmac_f32 v117, v206, v213
    v_fmac_f32 v118, v206, v214
    v_fmac_f32 v119, v206, v215
    v_fmac_f32 v120, v207, v208
    v_fmac_f32 v121, v207, v209
    v_fmac_f32 v122, v207, v210
    v_fmac_f32 v123, v207, v211
    v_fmac_f32 v124, v207, v212
    v_fmac_f32 v125, v207, v213
    v_fmac_f32 v126, v207, v214
    v_fmac_f32 v127, v207, v215
    ds_read_b128 v[200:203], v7 offset:5120
    ds_read_b128 v[204:207], v7 offset:5136
    v_lshlrev_b32 v208, 16, v148
    v_and_b32 v209, 0xffff0000, v148
    v_lshlrev_b32 v210, 16, v149
    v_and_b32 v211, 0xffff0000, v149
    v_lshlrev_b32 v212, 16, v150
    v_and_b32 v213, 0xffff0000, v150
    v_lshlrev_b32 v214, 16, v151
    v_and_b32 v215, 0xffff0000, v151
    s_waitcnt lgkmcnt(0)
    v_fmac_f32 v64, v200, v208
    v_fmac_f32 v65, v200, v209
    v_fmac_f32 v66, v200, v210
    v_fmac_f32 v67, v200, v211
    v_fmac_f32 v68, v200, v212
    v_fmac_f32 v69, v200, v213
    v_fmac_f32 v70, v200, v214
    v_fmac_f32 v71, v200, v215
    v_fmac_f32 v72, v201, v208
    v_fmac_f32 v73, v201, v209
    v_fmac_f32 v74, v201, v210
    v_fmac_f32 v75, v201, v211
    v_fmac_f32 v76, v201, v212
    v_fmac_f32 v77, v201, v213
    v_fmac_f32 v78, v201, v214
    v_fmac_f32 v79, v201, v215
    v_fmac_f32 v80, v202, v208
    v_fmac_f32 v81, v202, v209
    v_fmac_f32 v82, v202, v210
    v_fmac_f32 v83, v202, v211
    v_fmac_f32 v84, v202, v212
    v_fmac_f32 v85, v202, v213
    v_fmac_f32 v86, v202, v214
    v_fmac_f32 v87, v202, v215
    v_fmac_f32 v88, v203, v208
    v_fmac_f32 v89, v203, v209
    v_fmac_f32 v90, v203, v210
    v_fmac_f32 v91, v203, v211
    v_fmac_f32 v92, v203, v212
    v_fmac_f32 v93, v203, v213
    v_fmac_f32 v94, v203, v214
    v_fmac_f32 v95, v203, v215
    v_fmac_f32 v96, v204, v208
    v_fmac_f32 v97, v204, v209
    v_fmac_f32 v98, v204, v210
    v_fmac_f32 v99, v204, v211
    v_fmac_f32 v100, v204, v212
    v_fmac_f32 v101, v204, v213
    v_fmac_f32 v102, v204, v214
    v_fmac_f32 v103, v204, v215
    v_fmac_f32 v104, v205, v208
    v_fmac_f32 v105, v205, v209
    v_fmac_f32 v106, v205, v210
    v_fmac_f32 v107, v205, v211
    v_fmac_f32 v108, v205, v212
    v_fmac_f32 v109, v205, v213
    v_fmac_f32 v110, v205, v214
    v_fmac_f32 v111, v205, v215
    v_fmac_f32 v112, v206, v208
    v_fmac_f32 v113, v206, v209
    v_fmac_f32 v114, v206, v210
    v_fmac_f32 v115, v206, v211
    v_fmac_f32 v116, v206, v212
    v_fmac_f32 v117, v206, v213
    v_fmac_f32 v118, v206, v214
    v_fmac_f32 v119, v206, v215
    v_fmac_f32 v120, v207, v208
    v_fmac_f32 v121, v207, v209
    v_fmac_f32 v122, v207, v210
    v_fmac_f32 v123, v207, v211
    v_fmac_f32 v124, v207, v212
    v_fmac_f32 v125, v207, v213
    v_fmac_f32 v126, v207, v214
    v_fmac_f32 v127, v207, v215
    ds_read_b128 v[200:203], v7 offset:6144
    ds_read_b128 v[204:207], v7 offset:6160
    v_lshlrev_b32 v208, 16, v152
    v_and_b32 v209, 0xffff0000, v152
    v_lshlrev_b32 v210, 16, v153
    v_and_b32 v211, 0xffff0000, v153
    v_lshlrev_b32 v212, 16, v154
    v_and_b32 v213, 0xffff0000, v154
    v_lshlrev_b32 v214, 16, v155
    v_and_b32 v215, 0xffff0000, v155
    s_waitcnt lgkmcnt(0)
    v_fmac_f32 v64, v200, v208
    v_fmac_f32 v65, v200, v209
    v_fmac_f32 v66, v200, v210
    v_fmac_f32 v67, v200, v211
    v_fmac_f32 v68, v200, v212
    v_fmac_f32 v69, v200, v213
    v_fmac_f32 v70, v200, v214
    v_fmac_f32 v71, v200, v215
    v_fmac_f32 v72, v201, v208
    v_fmac_f32 v73, v201, v209
    v_fmac_f32 v74, v201, v210
    v_fmac_f32 v75, v201, v211
    v_fmac_f32 v76, v201, v212
    v_fmac_f32 v77, v201, v213
    v_fmac_f32 v78, v201, v214
    v_fmac_f32 v79, v201, v215
    v_fmac_f32 v80, v202, v208
    v_fmac_f32 v81, v202, v209
    v_fmac_f32 v82, v202, v210
    v_fmac_f32 v83, v202, v211
    v_fmac_f32 v84, v202, v212
    v_fmac_f32 v85, v202, v213
    v_fmac_f32 v86, v202, v214
    v_fmac_f32 v87, v202, v215
    v_fmac_f32 v88, v203, v208
    v_fmac_f32 v89, v203, v209
    v_fmac_f32 v90, v203, v210
    v_fmac_f32 v91, v203, v211
    v_fmac_f32 v92, v203, v212
    v_fmac_f32 v93, v203, v213
    v_fmac_f32 v94, v203, v214
    v_fmac_f32 v95, v203, v215
    v_fmac_f32 v96, v204, v208
    v_fmac_f32 v97, v204, v209
    v_fmac_f32 v98, v204, v210
    v_fmac_f32 v99, v204, v211
    v_fmac_f32 v100, v204, v212
    v_fmac_f32 v101, v204, v213
    v_fmac_f32 v102, v204, v214
    v_fmac_f32 v103, v204, v215
    v_fmac_f32 v104, v205, v208
    v_fmac_f32 v105, v205, v209
    v_fmac_f32 v106, v205, v210
    v_fmac_f32 v107, v205, v211
    v_fmac_f32 v108, v205, v212
    v_fmac_f32 v109, v205, v213
    v_fmac_f32 v110, v205, v214
    v_fmac_f32 v111, v205, v215
    v_fmac_f32 v112, v206, v208
    v_fmac_f32 v113, v206, v209
    v_fmac_f32 v114, v206, v210
    v_fmac_f32 v115, v206, v211
    v_fmac_f32 v116, v206, v212
    v_fmac_f32 v117, v206, v213
    v_fmac_f32 v118, v206, v214
    v_fmac_f32 v119, v206, v215
    v_fmac_f32 v120, v207, v208
    v_fmac_f32 v121, v207, v209
    v_fmac_f32 v122, v207, v210
    v_fmac_f32 v123, v207, v211
    v_fmac_f32 v124, v207, v212
    v_fmac_f32 v125, v207, v213
    v_fmac_f32 v126, v207, v214
    v_fmac_f32 v127, v207, v215
    ds_read_b128 v[200:203], v7 offset:7168
    ds_read_b128 v[204:207], v7 offset:7184
    v_lshlrev_b32 v208, 16, v156
    v_and_b32 v209, 0xffff0000, v156
    v_lshlrev_b32 v210, 16, v157
    v_and_b32 v211, 0xffff0000, v157
    v_lshlrev_b32 v212, 16, v158
    v_and_b32 v213, 0xffff0000, v158
    v_lshlrev_b32 v214, 16, v159
    v_and_b32 v215, 0xffff0000, v159
    s_waitcnt lgkmcnt(0)
    v_fmac_f32 v64, v200, v208
    v_fmac_f32 v65, v200, v209
    v_fmac_f32 v66, v200, v210
    v_fmac_f32 v67, v200, v211
    v_fmac_f32 v68, v200, v212
    v_fmac_f32 v69, v200, v213
    v_fmac_f32 v70, v200, v214
    v_fmac_f32 v71, v200, v215
    v_fmac_f32 v72, v201, v208
    v_fmac_f32 v73, v201, v209
    v_fmac_f32 v74, v201, v210
    v_fmac_f32 v75, v201, v211
    v_fmac_f32 v76, v201, v212
    v_fmac_f32 v77, v201, v213
    v_fmac_f32 v78, v201, v214
    v_fmac_f32 v79, v201, v215
    v_fmac_f32 v80, v202, v208
    v_fmac_f32 v81, v202, v209
    v_fmac_f32 v82, v202, v210
    v_fmac_f32 v83, v202, v211
    v_fmac_f32 v84, v202, v212
    v_fmac_f32 v85, v202, v213
    v_fmac_f32 v86, v202, v214
    v_fmac_f32 v87, v202, v215
    v_fmac_f32 v88, v203, v208
    v_fmac_f32 v89, v203, v209
    v_fmac_f32 v90, v203, v210
    v_fmac_f32 v91, v203, v211
    v_fmac_f32 v92, v203, v212
    v_fmac_f32 v93, v203, v213
    v_fmac_f32 v94, v203, v214
    v_fmac_f32 v95, v203, v215
    v_fmac_f32 v96, v204, v208
    v_fmac_f32 v97, v204, v209
    v_fmac_f32 v98, v204, v210
    v_fmac_f32 v99, v204, v211
    v_fmac_f32 v100, v204, v212
    v_fmac_f32 v101, v204, v213
    v_fmac_f32 v102, v204, v214
    v_fmac_f32 v103, v204, v215
    v_fmac_f32 v104, v205, v208
    v_fmac_f32 v105, v205, v209
    v_fmac_f32 v106, v205, v210
    v_fmac_f32 v107, v205, v211
    v_fmac_f32 v108, v205, v212
    v_fmac_f32 v109, v205, v213
    v_fmac_f32 v110, v205, v214
    v_fmac_f32 v111, v205, v215
    v_fmac_f32 v112, v206, v208
    v_fmac_f32 v113, v206, v209
    v_fmac_f32 v114, v206, v210
    v_fmac_f32 v115, v206, v211
    v_fmac_f32 v116, v206, v212
    v_fmac_f32 v117, v206, v213
    v_fmac_f32 v118, v206, v214
    v_fmac_f32 v119, v206, v215
    v_fmac_f32 v120, v207, v208
    v_fmac_f32 v121, v207, v209
    v_fmac_f32 v122, v207, v210
    v_fmac_f32 v123, v207, v211
    v_fmac_f32 v124, v207, v212
    v_fmac_f32 v125, v207, v213
    v_fmac_f32 v126, v207, v214
    v_fmac_f32 v127, v207, v215
    ds_read_b128 v[200:203], v7 offset:8192
    ds_read_b128 v[204:207], v7 offset:8208
    v_lshlrev_b32 v208, 16, v160
    v_and_b32 v209, 0xffff0000, v160
    v_lshlrev_b32 v210, 16, v161
    v_and_b32 v211, 0xffff0000, v161
    v_lshlrev_b32 v212, 16, v162
    v_and_b32 v213, 0xffff0000, v162
    v_lshlrev_b32 v214, 16, v163
    v_and_b32 v215, 0xffff0000, v163
    s_waitcnt lgkmcnt(0)
    v_fmac_f32 v64, v200, v208
    v_fmac_f32 v65, v200, v209
    v_fmac_f32 v66, v200, v210
    v_fmac_f32 v67, v200, v211
    v_fmac_f32 v68, v200, v212
    v_fmac_f32 v69, v200, v213
    v_fmac_f32 v70, v200, v214
    v_fmac_f32 v71, v200, v215
    v_fmac_f32 v72, v201, v208
    v_fmac_f32 v73, v201, v209
    v_fmac_f32 v74, v201, v210
    v_fmac_f32 v75, v201, v211
    v_fmac_f32 v76, v201, v212
    v_fmac_f32 v77, v201, v213
    v_fmac_f32 v78, v201, v214
    v_fmac_f32 v79, v201, v215
    v_fmac_f32 v80, v202, v208
    v_fmac_f32 v81, v202, v209
    v_fmac_f32 v82, v202, v210
    v_fmac_f32 v83, v202, v211
    v_fmac_f32 v84, v202, v212
    v_fmac_f32 v85, v202, v213
    v_fmac_f32 v86, v202, v214
    v_fmac_f32 v87, v202, v215
    v_fmac_f32 v88, v203, v208
    v_fmac_f32 v89, v203, v209
    v_fmac_f32 v90, v203, v210
    v_fmac_f32 v91, v203, v211
    v_fmac_f32 v92, v203, v212
    v_fmac_f32 v93, v203, v213
    v_fmac_f32 v94, v203, v214
    v_fmac_f32 v95, v203, v215
    v_fmac_f32 v96, v204, v208
    v_fmac_f32 v97, v204, v209
    v_fmac_f32 v98, v204, v210
    v_fmac_f32 v99, v204, v211
    v_fmac_f32 v100, v204, v212
    v_fmac_f32 v101, v204, v213
    v_fmac_f32 v102, v204, v214
    v_fmac_f32 v103, v204, v215
    v_fmac_f32 v104, v205, v208
    v_fmac_f32 v105, v205, v209
    v_fmac_f32 v106, v205, v210
    v_fmac_f32 v107, v205, v211
    v_fmac_f32 v108, v205, v212
    v_fmac_f32 v109, v205, v213
    v_fmac_f32 v110, v205, v214
    v_fmac_f32 v111, v205, v215
    v_fmac_f32 v112, v206, v208
    v_fmac_f32 v113, v206, v209
    v_fmac_f32 v114, v206, v210
    v_fmac_f32 v115, v206, v211
    v_fmac_f32 v116, v206, v212
    v_fmac_f32 v117, v206, v213
    v_fmac_f32 v118, v206, v214
    v_fmac_f32 v119, v206, v215
    v_fmac_f32 v120, v207, v208
    v_fmac_f32 v121, v207, v209
    v_fmac_f32 v122, v207, v210
    v_fmac_f32 v123, v207, v211
    v_fmac_f32 v124, v207, v212
    v_fmac_f32 v125, v207, v213
    v_fmac_f32 v126, v207, v214
    v_fmac_f32 v127, v207, v215
    ds_read_b128 v[200:203], v7 offset:9216
    ds_read_b128 v[204:207], v7 offset:9232
    v_lshlrev_b32 v208, 16, v164
    v_and_b32 v209, 0xffff0000, v164
    v_lshlrev_b32 v210, 16, v165
    v_and_b32 v211, 0xffff0000, v165
    v_lshlrev_b32 v212, 16, v166
    v_and_b32 v213, 0xffff0000, v166
    v_lshlrev_b32 v214, 16, v167
    v_and_b32 v215, 0xffff0000, v167
    s_waitcnt lgkmcnt(0)
    v_fmac_f32 v64, v200, v208
    v_fmac_f32 v65, v200, v209
    v_fmac_f32 v66, v200, v210
    v_fmac_f32 v67, v200, v211
    v_fmac_f32 v68, v200, v212
    v_fmac_f32 v69, v200, v213
    v_fmac_f32 v70, v200, v214
    v_fmac_f32 v71, v200, v215
    v_fmac_f32 v72, v201, v208
    v_fmac_f32 v73, v201, v209
    v_fmac_f32 v74, v201, v210
    v_fmac_f32 v75, v201, v211
    v_fmac_f32 v76, v201, v212
    v_fmac_f32 v77, v201, v213
    v_fmac_f32 v78, v201, v214
    v_fmac_f32 v79, v201, v215
    v_fmac_f32 v80, v202, v208
    v_fmac_f32 v81, v202, v209
    v_fmac_f32 v82, v202, v210
    v_fmac_f32 v83, v202, v211
    v_fmac_f32 v84, v202, v212
    v_fmac_f32 v85, v202, v213
    v_fmac_f32 v86, v202, v214
    v_fmac_f32 v87, v202, v215
    v_fmac_f32 v88, v203, v208
    v_fmac_f32 v89, v203, v209
    v_fmac_f32 v90, v203, v210
    v_fmac_f32 v91, v203, v211
    v_fmac_f32 v92, v203, v212
    v_fmac_f32 v93, v203, v213
    v_fmac_f32 v94, v203, v214
    v_fmac_f32 v95, v203, v215
    v_fmac_f32 v96, v204, v208
    v_fmac_f32 v97, v204, v209
    v_fmac_f32 v98, v204, v210
    v_fmac_f32 v99, v204, v211
    v_fmac_f32 v100, v204, v212
    v_fmac_f32 v101, v204, v213
    v_fmac_f32 v102, v204, v214
    v_fmac_f32 v103, v204, v215
    v_fmac_f32 v104, v205, v208
    v_fmac_f32 v105, v205, v209
    v_fmac_f32 v106, v205, v210
    v_fmac_f32 v107, v205, v211
    v_fmac_f32 v108, v205, v212
    v_fmac_f32 v109, v205, v213
    v_fmac_f32 v110, v205, v214
    v_fmac_f32 v111, v205, v215
    v_fmac_f32 v112, v206, v208
    v_fmac_f32 v113, v206, v209
    v_fmac_f32 v114, v206, v210
    v_fmac_f32 v115, v206, v211
    v_fmac_f32 v116, v206, v212
    v_fmac_f32 v117, v206, v213
    v_fmac_f32 v118, v206, v214
    v_fmac_f32 v119, v206, v215
    v_fmac_f32 v120, v207, v208
    v_fmac_f32 v121, v207, v209
    v_fmac_f32 v122, v207, v210
    v_fmac_f32 v123, v207, v211
    v_fmac_f32 v124, v207, v212
    v_fmac_f32 v125, v207, v213
    v_fmac_f32 v126, v207, v214
    v_fmac_f32 v127, v207, v215
    ds_read_b128 v[200:203], v7 offset:10240
    ds_read_b128 v[204:207], v7 offset:10256
    v_lshlrev_b32 v208, 16, v168
    v_and_b32 v209, 0xffff0000, v168
    v_lshlrev_b32 v210, 16, v169
    v_and_b32 v211, 0xffff0000, v169
    v_lshlrev_b32 v212, 16, v170
    v_and_b32 v213, 0xffff0000, v170
    v_lshlrev_b32 v214, 16, v171
    v_and_b32 v215, 0xffff0000, v171
    s_waitcnt lgkmcnt(0)
    v_fmac_f32 v64, v200, v208
    v_fmac_f32 v65, v200, v209
    v_fmac_f32 v66, v200, v210
    v_fmac_f32 v67, v200, v211
    v_fmac_f32 v68, v200, v212
    v_fmac_f32 v69, v200, v213
    v_fmac_f32 v70, v200, v214
    v_fmac_f32 v71, v200, v215
    v_fmac_f32 v72, v201, v208
    v_fmac_f32 v73, v201, v209
    v_fmac_f32 v74, v201, v210
    v_fmac_f32 v75, v201, v211
    v_fmac_f32 v76, v201, v212
    v_fmac_f32 v77, v201, v213
    v_fmac_f32 v78, v201, v214
    v_fmac_f32 v79, v201, v215
    v_fmac_f32 v80, v202, v208
    v_fmac_f32 v81, v202, v209
    v_fmac_f32 v82, v202, v210
    v_fmac_f32 v83, v202, v211
    v_fmac_f32 v84, v202, v212
    v_fmac_f32 v85, v202, v213
    v_fmac_f32 v86, v202, v214
    v_fmac_f32 v87, v202, v215
    v_fmac_f32 v88, v203, v208
    v_fmac_f32 v89, v203, v209
    v_fmac_f32 v90, v203, v210
    v_fmac_f32 v91, v203, v211
    v_fmac_f32 v92, v203, v212
    v_fmac_f32 v93, v203, v213
    v_fmac_f32 v94, v203, v214
    v_fmac_f32 v95, v203, v215
    v_fmac_f32 v96, v204, v208
    v_fmac_f32 v97, v204, v209
    v_fmac_f32 v98, v204, v210
    v_fmac_f32 v99, v204, v211
    v_fmac_f32 v100, v204, v212
    v_fmac_f32 v101, v204, v213
    v_fmac_f32 v102, v204, v214
    v_fmac_f32 v103, v204, v215
    v_fmac_f32 v104, v205, v208
    v_fmac_f32 v105, v205, v209
    v_fmac_f32 v106, v205, v210
    v_fmac_f32 v107, v205, v211
    v_fmac_f32 v108, v205, v212
    v_fmac_f32 v109, v205, v213
    v_fmac_f32 v110, v205, v214
    v_fmac_f32 v111, v205, v215
    v_fmac_f32 v112, v206, v208
    v_fmac_f32 v113, v206, v209
    v_fmac_f32 v114, v206, v210
    v_fmac_f32 v115, v206, v211
    v_fmac_f32 v116, v206, v212
    v_fmac_f32 v117, v206, v213
    v_fmac_f32 v118, v206, v214
    v_fmac_f32 v119, v206, v215
    v_fmac_f32 v120, v207, v208
    v_fmac_f32 v121, v207, v209
    v_fmac_f32 v122, v207, v210
    v_fmac_f32 v123, v207, v211
    v_fmac_f32 v124, v207, v212
    v_fmac_f32 v125, v207, v213
    v_fmac_f32 v126, v207, v214
    v_fmac_f32 v127, v207, v215
    ds_read_b128 v[200:203], v7 offset:11264
    ds_read_b128 v[204:207], v7 offset:11280
    v_lshlrev_b32 v208, 16, v172
    v_and_b32 v209, 0xffff0000, v172
    v_lshlrev_b32 v210, 16, v173
    v_and_b32 v211, 0xffff0000, v173
    v_lshlrev_b32 v212, 16, v174
    v_and_b32 v213, 0xffff0000, v174
    v_lshlrev_b32 v214, 16, v175
    v_and_b32 v215, 0xffff0000, v175
    s_waitcnt lgkmcnt(0)
    v_fmac_f32 v64, v200, v208
    v_fmac_f32 v65, v200, v209
    v_fmac_f32 v66, v200, v210
    v_fmac_f32 v67, v200, v211
    v_fmac_f32 v68, v200, v212
    v_fmac_f32 v69, v200, v213
    v_fmac_f32 v70, v200, v214
    v_fmac_f32 v71, v200, v215
    v_fmac_f32 v72, v201, v208
    v_fmac_f32 v73, v201, v209
    v_fmac_f32 v74, v201, v210
    v_fmac_f32 v75, v201, v211
    v_fmac_f32 v76, v201, v212
    v_fmac_f32 v77, v201, v213
    v_fmac_f32 v78, v201, v214
    v_fmac_f32 v79, v201, v215
    v_fmac_f32 v80, v202, v208
    v_fmac_f32 v81, v202, v209
    v_fmac_f32 v82, v202, v210
    v_fmac_f32 v83, v202, v211
    v_fmac_f32 v84, v202, v212
    v_fmac_f32 v85, v202, v213
    v_fmac_f32 v86, v202, v214
    v_fmac_f32 v87, v202, v215
    v_fmac_f32 v88, v203, v208
    v_fmac_f32 v89, v203, v209
    v_fmac_f32 v90, v203, v210
    v_fmac_f32 v91, v203, v211
    v_fmac_f32 v92, v203, v212
    v_fmac_f32 v93, v203, v213
    v_fmac_f32 v94, v203, v214
    v_fmac_f32 v95, v203, v215
    v_fmac_f32 v96, v204, v208
    v_fmac_f32 v97, v204, v209
    v_fmac_f32 v98, v204, v210
    v_fmac_f32 v99, v204, v211
    v_fmac_f32 v100, v204, v212
    v_fmac_f32 v101, v204, v213
    v_fmac_f32 v102, v204, v214
    v_fmac_f32 v103, v204, v215
    v_fmac_f32 v104, v205, v208
    v_fmac_f32 v105, v205, v209
    v_fmac_f32 v106, v205, v210
    v_fmac_f32 v107, v205, v211
    v_fmac_f32 v108, v205, v212
    v_fmac_f32 v109, v205, v213
    v_fmac_f32 v110, v205, v214
    v_fmac_f32 v111, v205, v215
    v_fmac_f32 v112, v206, v208
    v_fmac_f32 v113, v206, v209
    v_fmac_f32 v114, v206, v210
    v_fmac_f32 v115, v206, v211
    v_fmac_f32 v116, v206, v212
    v_fmac_f32 v117, v206, v213
    v_fmac_f32 v118, v206, v214
    v_fmac_f32 v119, v206, v215
    v_fmac_f32 v120, v207, v208
    v_fmac_f32 v121, v207, v209
    v_fmac_f32 v122, v207, v210
    v_fmac_f32 v123, v207, v211
    v_fmac_f32 v124, v207, v212
    v_fmac_f32 v125, v207, v213
    v_fmac_f32 v126, v207, v214
    v_fmac_f32 v127, v207, v215
    ds_read_b128 v[200:203], v7 offset:12288
    ds_read_b128 v[204:207], v7 offset:12304
    v_lshlrev_b32 v208, 16, v176
    v_and_b32 v209, 0xffff0000, v176
    v_lshlrev_b32 v210, 16, v177
    v_and_b32 v211, 0xffff0000, v177
    v_lshlrev_b32 v212, 16, v178
    v_and_b32 v213, 0xffff0000, v178
    v_lshlrev_b32 v214, 16, v179
    v_and_b32 v215, 0xffff0000, v179
    s_waitcnt lgkmcnt(0)
    v_fmac_f32 v64, v200, v208
    v_fmac_f32 v65, v200, v209
    v_fmac_f32 v66, v200, v210
    v_fmac_f32 v67, v200, v211
    v_fmac_f32 v68, v200, v212
    v_fmac_f32 v69, v200, v213
    v_fmac_f32 v70, v200, v214
    v_fmac_f32 v71, v200, v215
    v_fmac_f32 v72, v201, v208
    v_fmac_f32 v73, v201, v209
    v_fmac_f32 v74, v201, v210
    v_fmac_f32 v75, v201, v211
    v_fmac_f32 v76, v201, v212
    v_fmac_f32 v77, v201, v213
    v_fmac_f32 v78, v201, v214
    v_fmac_f32 v79, v201, v215
    v_fmac_f32 v80, v202, v208
    v_fmac_f32 v81, v202, v209
    v_fmac_f32 v82, v202, v210
    v_fmac_f32 v83, v202, v211
    v_fmac_f32 v84, v202, v212
    v_fmac_f32 v85, v202, v213
    v_fmac_f32 v86, v202, v214
    v_fmac_f32 v87, v202, v215
    v_fmac_f32 v88, v203, v208
    v_fmac_f32 v89, v203, v209
    v_fmac_f32 v90, v203, v210
    v_fmac_f32 v91, v203, v211
    v_fmac_f32 v92, v203, v212
    v_fmac_f32 v93, v203, v213
    v_fmac_f32 v94, v203, v214
    v_fmac_f32 v95, v203, v215
    v_fmac_f32 v96, v204, v208
    v_fmac_f32 v97, v204, v209
    v_fmac_f32 v98, v204, v210
    v_fmac_f32 v99, v204, v211
    v_fmac_f32 v100, v204, v212
    v_fmac_f32 v101, v204, v213
    v_fmac_f32 v102, v204, v214
    v_fmac_f32 v103, v204, v215
    v_fmac_f32 v104, v205, v208
    v_fmac_f32 v105, v205, v209
    v_fmac_f32 v106, v205, v210
    v_fmac_f32 v107, v205, v211
    v_fmac_f32 v108, v205, v212
    v_fmac_f32 v109, v205, v213
    v_fmac_f32 v110, v205, v214
    v_fmac_f32 v111, v205, v215
    v_fmac_f32 v112, v206, v208
    v_fmac_f32 v113, v206, v209
    v_fmac_f32 v114, v206, v210
    v_fmac_f32 v115, v206, v211
    v_fmac_f32 v116, v206, v212
    v_fmac_f32 v117, v206, v213
    v_fmac_f32 v118, v206, v214
    v_fmac_f32 v119, v206, v215
    v_fmac_f32 v120, v207, v208
    v_fmac_f32 v121, v207, v209
    v_fmac_f32 v122, v207, v210
    v_fmac_f32 v123, v207, v211
    v_fmac_f32 v124, v207, v212
    v_fmac_f32 v125, v207, v213
    v_fmac_f32 v126, v207, v214
    v_fmac_f32 v127, v207, v215
    ds_read_b128 v[200:203], v7 offset:13312
    ds_read_b128 v[204:207], v7 offset:13328
    v_lshlrev_b32 v208, 16, v180
    v_and_b32 v209, 0xffff0000, v180
    v_lshlrev_b32 v210, 16, v181
    v_and_b32 v211, 0xffff0000, v181
    v_lshlrev_b32 v212, 16, v182
    v_and_b32 v213, 0xffff0000, v182
    v_lshlrev_b32 v214, 16, v183
    v_and_b32 v215, 0xffff0000, v183
    s_waitcnt lgkmcnt(0)
    v_fmac_f32 v64, v200, v208
    v_fmac_f32 v65, v200, v209
    v_fmac_f32 v66, v200, v210
    v_fmac_f32 v67, v200, v211
    v_fmac_f32 v68, v200, v212
    v_fmac_f32 v69, v200, v213
    v_fmac_f32 v70, v200, v214
    v_fmac_f32 v71, v200, v215
    v_fmac_f32 v72, v201, v208
    v_fmac_f32 v73, v201, v209
    v_fmac_f32 v74, v201, v210
    v_fmac_f32 v75, v201, v211
    v_fmac_f32 v76, v201, v212
    v_fmac_f32 v77, v201, v213
    v_fmac_f32 v78, v201, v214
    v_fmac_f32 v79, v201, v215
    v_fmac_f32 v80, v202, v208
    v_fmac_f32 v81, v202, v209
    v_fmac_f32 v82, v202, v210
    v_fmac_f32 v83, v202, v211
    v_fmac_f32 v84, v202, v212
    v_fmac_f32 v85, v202, v213
    v_fmac_f32 v86, v202, v214
    v_fmac_f32 v87, v202, v215
    v_fmac_f32 v88, v203, v208
    v_fmac_f32 v89, v203, v209
    v_fmac_f32 v90, v203, v210
    v_fmac_f32 v91, v203, v211
    v_fmac_f32 v92, v203, v212
    v_fmac_f32 v93, v203, v213
    v_fmac_f32 v94, v203, v214
    v_fmac_f32 v95, v203, v215
    v_fmac_f32 v96, v204, v208
    v_fmac_f32 v97, v204, v209
    v_fmac_f32 v98, v204, v210
    v_fmac_f32 v99, v204, v211
    v_fmac_f32 v100, v204, v212
    v_fmac_f32 v101, v204, v213
    v_fmac_f32 v102, v204, v214
    v_fmac_f32 v103, v204, v215
    v_fmac_f32 v104, v205, v208
    v_fmac_f32 v105, v205, v209
    v_fmac_f32 v106, v205, v210
    v_fmac_f32 v107, v205, v211
    v_fmac_f32 v108, v205, v212
    v_fmac_f32 v109, v205, v213
    v_fmac_f32 v110, v205, v214
    v_fmac_f32 v111, v205, v215
    v_fmac_f32 v112, v206, v208
    v_fmac_f32 v113, v206, v209
    v_fmac_f32 v114, v206, v210
    v_fmac_f32 v115, v206, v211
    v_fmac_f32 v116, v206, v212
    v_fmac_f32 v117, v206, v213
    v_fmac_f32 v118, v206, v214
    v_fmac_f32 v119, v206, v215
    v_fmac_f32 v120, v207, v208
    v_fmac_f32 v121, v207, v209
    v_fmac_f32 v122, v207, v210
    v_fmac_f32 v123, v207, v211
    v_fmac_f32 v124, v207, v212
    v_fmac_f32 v125, v207, v213
    v_fmac_f32 v126, v207, v214
    v_fmac_f32 v127, v207, v215
    ds_read_b128 v[200:203], v7 offset:14336
    ds_read_b128 v[204:207], v7 offset:14352
    v_lshlrev_b32 v208, 16, v184
    v_and_b32 v209, 0xffff0000, v184
    v_lshlrev_b32 v210, 16, v185
    v_and_b32 v211, 0xffff0000, v185
    v_lshlrev_b32 v212, 16, v186
    v_and_b32 v213, 0xffff0000, v186
    v_lshlrev_b32 v214, 16, v187
    v_and_b32 v215, 0xffff0000, v187
    s_waitcnt lgkmcnt(0)
    v_fmac_f32 v64, v200, v208
    v_fmac_f32 v65, v200, v209
    v_fmac_f32 v66, v200, v210
    v_fmac_f32 v67, v200, v211
    v_fmac_f32 v68, v200, v212
    v_fmac_f32 v69, v200, v213
    v_fmac_f32 v70, v200, v214
    v_fmac_f32 v71, v200, v215
    v_fmac_f32 v72, v201, v208
    v_fmac_f32 v73, v201, v209
    v_fmac_f32 v74, v201, v210
    v_fmac_f32 v75, v201, v211
    v_fmac_f32 v76, v201, v212
    v_fmac_f32 v77, v201, v213
    v_fmac_f32 v78, v201, v214
    v_fmac_f32 v79, v201, v215
    v_fmac_f32 v80, v202, v208
    v_fmac_f32 v81, v202, v209
    v_fmac_f32 v82, v202, v210
    v_fmac_f32 v83, v202, v211
    v_fmac_f32 v84, v202, v212
    v_fmac_f32 v85, v202, v213
    v_fmac_f32 v86, v202, v214
    v_fmac_f32 v87, v202, v215
    v_fmac_f32 v88, v203, v208
    v_fmac_f32 v89, v203, v209
    v_fmac_f32 v90, v203, v210
    v_fmac_f32 v91, v203, v211
    v_fmac_f32 v92, v203, v212
    v_fmac_f32 v93, v203, v213
    v_fmac_f32 v94, v203, v214
    v_fmac_f32 v95, v203, v215
    v_fmac_f32 v96, v204, v208
    v_fmac_f32 v97, v204, v209
    v_fmac_f32 v98, v204, v210
    v_fmac_f32 v99, v204, v211
    v_fmac_f32 v100, v204, v212
    v_fmac_f32 v101, v204, v213
    v_fmac_f32 v102, v204, v214
    v_fmac_f32 v103, v204, v215
    v_fmac_f32 v104, v205, v208
    v_fmac_f32 v105, v205, v209
    v_fmac_f32 v106, v205, v210
    v_fmac_f32 v107, v205, v211
    v_fmac_f32 v108, v205, v212
    v_fmac_f32 v109, v205, v213
    v_fmac_f32 v110, v205, v214
    v_fmac_f32 v111, v205, v215
    v_fmac_f32 v112, v206, v208
    v_fmac_f32 v113, v206, v209
    v_fmac_f32 v114, v206, v210
    v_fmac_f32 v115, v206, v211
    v_fmac_f32 v116, v206, v212
    v_fmac_f32 v117, v206, v213
    v_fmac_f32 v118, v206, v214
    v_fmac_f32 v119, v206, v215
    v_fmac_f32 v120, v207, v208
    v_fmac_f32 v121, v207, v209
    v_fmac_f32 v122, v207, v210
    v_fmac_f32 v123, v207, v211
    v_fmac_f32 v124, v207, v212
    v_fmac_f32 v125, v207, v213
    v_fmac_f32 v126, v207, v214
    v_fmac_f32 v127, v207, v215
    ds_read_b128 v[200:203], v7 offset:15360
    ds_read_b128 v[204:207], v7 offset:15376
    v_lshlrev_b32 v208, 16, v188
    v_and_b32 v209, 0xffff0000, v188
    v_lshlrev_b32 v210, 16, v189
    v_and_b32 v211, 0xffff0000, v189
    v_lshlrev_b32 v212, 16, v190
    v_and_b32 v213, 0xffff0000, v190
    v_lshlrev_b32 v214, 16, v191
    v_and_b32 v215, 0xffff0000, v191
    s_waitcnt lgkmcnt(0)
    v_fmac_f32 v64, v200, v208
    v_fmac_f32 v65, v200, v209
    v_fmac_f32 v66, v200, v210
    v_fmac_f32 v67, v200, v211
    v_fmac_f32 v68, v200, v212
    v_fmac_f32 v69, v200, v213
    v_fmac_f32 v70, v200, v214
    v_fmac_f32 v71, v200, v215
    v_fmac_f32 v72, v201, v208
    v_fmac_f32 v73, v201, v209
    v_fmac_f32 v74, v201, v210
    v_fmac_f32 v75, v201, v211
    v_fmac_f32 v76, v201, v212
    v_fmac_f32 v77, v201, v213
    v_fmac_f32 v78, v201, v214
    v_fmac_f32 v79, v201, v215
    v_fmac_f32 v80, v202, v208
    v_fmac_f32 v81, v202, v209
    v_fmac_f32 v82, v202, v210
    v_fmac_f32 v83, v202, v211
    v_fmac_f32 v84, v202, v212
    v_fmac_f32 v85, v202, v213
    v_fmac_f32 v86, v202, v214
    v_fmac_f32 v87, v202, v215
    v_fmac_f32 v88, v203, v208
    v_fmac_f32 v89, v203, v209
    v_fmac_f32 v90, v203, v210
    v_fmac_f32 v91, v203, v211
    v_fmac_f32 v92, v203, v212
    v_fmac_f32 v93, v203, v213
    v_fmac_f32 v94, v203, v214
    v_fmac_f32 v95, v203, v215
    v_fmac_f32 v96, v204, v208
    v_fmac_f32 v97, v204, v209
    v_fmac_f32 v98, v204, v210
    v_fmac_f32 v99, v204, v211
    v_fmac_f32 v100, v204, v212
    v_fmac_f32 v101, v204, v213
    v_fmac_f32 v102, v204, v214
    v_fmac_f32 v103, v204, v215
    v_fmac_f32 v104, v205, v208
    v_fmac_f32 v105, v205, v209
    v_fmac_f32 v106, v205, v210
    v_fmac_f32 v107, v205, v211
    v_fmac_f32 v108, v205, v212
    v_fmac_f32 v109, v205, v213
    v_fmac_f32 v110, v205, v214
    v_fmac_f32 v111, v205, v215
    v_fmac_f32 v112, v206, v208
    v_fmac_f32 v113, v206, v209
    v_fmac_f32 v114, v206, v210
    v_fmac_f32 v115, v206, v211
    v_fmac_f32 v116, v206, v212
    v_fmac_f32 v117, v206, v213
    v_fmac_f32 v118, v206, v214
    v_fmac_f32 v119, v206, v215
    v_fmac_f32 v120, v207, v208
    v_fmac_f32 v121, v207, v209
    v_fmac_f32 v122, v207, v210
    v_fmac_f32 v123, v207, v211
    v_fmac_f32 v124, v207, v212
    v_fmac_f32 v125, v207, v213
    v_fmac_f32 v126, v207, v214
    v_fmac_f32 v127, v207, v215
    ds_read_b128 v[200:203], v7 offset:16384
    ds_read_b128 v[204:207], v7 offset:16400
    v_lshlrev_b32 v208, 16, v192
    v_and_b32 v209, 0xffff0000, v192
    v_lshlrev_b32 v210, 16, v193
    v_and_b32 v211, 0xffff0000, v193
    v_lshlrev_b32 v212, 16, v194
    v_and_b32 v213, 0xffff0000, v194
    v_lshlrev_b32 v214, 16, v195
    v_and_b32 v215, 0xffff0000, v195
    s_waitcnt lgkmcnt(0)
    v_fmac_f32 v64, v200, v208
    v_fmac_f32 v65, v200, v209
    v_fmac_f32 v66, v200, v210
    v_fmac_f32 v67, v200, v211
    v_fmac_f32 v68, v200, v212
    v_fmac_f32 v69, v200, v213
    v_fmac_f32 v70, v200, v214
    v_fmac_f32 v71, v200, v215
    v_fmac_f32 v72, v201, v208
    v_fmac_f32 v73, v201, v209
    v_fmac_f32 v74, v201, v210
    v_fmac_f32 v75, v201, v211
    v_fmac_f32 v76, v201, v212
    v_fmac_f32 v77, v201, v213
    v_fmac_f32 v78, v201, v214
    v_fmac_f32 v79, v201, v215
    v_fmac_f32 v80, v202, v208
    v_fmac_f32 v81, v202, v209
    v_fmac_f32 v82, v202, v210
    v_fmac_f32 v83, v202, v211
    v_fmac_f32 v84, v202, v212
    v_fmac_f32 v85, v202, v213
    v_fmac_f32 v86, v202, v214
    v_fmac_f32 v87, v202, v215
    v_fmac_f32 v88, v203, v208
    v_fmac_f32 v89, v203, v209
    v_fmac_f32 v90, v203, v210
    v_fmac_f32 v91, v203, v211
    v_fmac_f32 v92, v203, v212
    v_fmac_f32 v93, v203, v213
    v_fmac_f32 v94, v203, v214
    v_fmac_f32 v95, v203, v215
    v_fmac_f32 v96, v204, v208
    v_fmac_f32 v97, v204, v209
    v_fmac_f32 v98, v204, v210
    v_fmac_f32 v99, v204, v211
    v_fmac_f32 v100, v204, v212
    v_fmac_f32 v101, v204, v213
    v_fmac_f32 v102, v204, v214
    v_fmac_f32 v103, v204, v215
    v_fmac_f32 v104, v205, v208
    v_fmac_f32 v105, v205, v209
    v_fmac_f32 v106, v205, v210
    v_fmac_f32 v107, v205, v211
    v_fmac_f32 v108, v205, v212
    v_fmac_f32 v109, v205, v213
    v_fmac_f32 v110, v205, v214
    v_fmac_f32 v111, v205, v215
    v_fmac_f32 v112, v206, v208
    v_fmac_f32 v113, v206, v209
    v_fmac_f32 v114, v206, v210
    v_fmac_f32 v115, v206, v211
    v_fmac_f32 v116, v206, v212
    v_fmac_f32 v117, v206, v213
    v_fmac_f32 v118, v206, v214
    v_fmac_f32 v119, v206, v215
    v_fmac_f32 v120, v207, v208
    v_fmac_f32 v121, v207, v209
    v_fmac_f32 v122, v207, v210
    v_fmac_f32 v123, v207, v211
    v_fmac_f32 v124, v207, v212
    v_fmac_f32 v125, v207, v213
    v_fmac_f32 v126, v207, v214
    v_fmac_f32 v127, v207, v215
    ds_read_b128 v[200:203], v7 offset:17408
    ds_read_b128 v[204:207], v7 offset:17424
    v_lshlrev_b32 v208, 16, v196
    v_and_b32 v209, 0xffff0000, v196
    v_lshlrev_b32 v210, 16, v197
    v_and_b32 v211, 0xffff0000, v197
    v_lshlrev_b32 v212, 16, v198
    v_and_b32 v213, 0xffff0000, v198
    v_lshlrev_b32 v214, 16, v199
    v_and_b32 v215, 0xffff0000, v199
    s_waitcnt lgkmcnt(0)
    v_fmac_f32 v64, v200, v208
    v_fmac_f32 v65, v200, v209
    v_fmac_f32 v66, v200, v210
    v_fmac_f32 v67, v200, v211
    v_fmac_f32 v68, v200, v212
    v_fmac_f32 v69, v200, v213
    v_fmac_f32 v70, v200, v214
    v_fmac_f32 v71, v200, v215
    v_fmac_f32 v72, v201, v208
    v_fmac_f32 v73, v201, v209
    v_fmac_f32 v74, v201, v210
    v_fmac_f32 v75, v201, v211
    v_fmac_f32 v76, v201, v212
    v_fmac_f32 v77, v201, v213
    v_fmac_f32 v78, v201, v214
    v_fmac_f32 v79, v201, v215
    v_fmac_f32 v80, v202, v208
    v_fmac_f32 v81, v202, v209
    v_fmac_f32 v82, v202, v210
    v_fmac_f32 v83, v202, v211
    v_fmac_f32 v84, v202, v212
    v_fmac_f32 v85, v202, v213
    v_fmac_f32 v86, v202, v214
    v_fmac_f32 v87, v202, v215
    v_fmac_f32 v88, v203, v208
    v_fmac_f32 v89, v203, v209
    v_fmac_f32 v90, v203, v210
    v_fmac_f32 v91, v203, v211
    v_fmac_f32 v92, v203, v212
    v_fmac_f32 v93, v203, v213
    v_fmac_f32 v94, v203, v214
    v_fmac_f32 v95, v203, v215
    v_fmac_f32 v96, v204, v208
    v_fmac_f32 v97, v204, v209
    v_fmac_f32 v98, v204, v210
    v_fmac_f32 v99, v204, v211
    v_fmac_f32 v100, v204, v212
    v_fmac_f32 v101, v204, v213
    v_fmac_f32 v102, v204, v214
    v_fmac_f32 v103, v204, v215
    v_fmac_f32 v104, v205, v208
    v_fmac_f32 v105, v205, v209
    v_fmac_f32 v106, v205, v210
    v_fmac_f32 v107, v205, v211
    v_fmac_f32 v108, v205, v212
    v_fmac_f32 v109, v205, v213
    v_fmac_f32 v110, v205, v214
    v_fmac_f32 v111, v205, v215
    v_fmac_f32 v112, v206, v208
    v_fmac_f32 v113, v206, v209
    v_fmac_f32 v114, v206, v210
    v_fmac_f32 v115, v206, v211
    v_fmac_f32 v116, v206, v212
    v_fmac_f32 v117, v206, v213
    v_fmac_f32 v118, v206, v214
    v_fmac_f32 v119, v206, v215
    v_fmac_f32 v120, v207, v208
    v_fmac_f32 v121, v207, v209
    v_fmac_f32 v122, v207, v210
    v_fmac_f32 v123, v207, v211
    v_fmac_f32 v124, v207, v212
    v_fmac_f32 v125, v207, v213
    v_fmac_f32 v126, v207, v214
    v_fmac_f32 v127, v207, v215
    v_lshlrev_b32 v8, 11, v5
    v_lshl_add_u32 v8, v4, 5, v8
    v_add_u32 v8, 18432, v8
    ds_write_b128 v8, v[64:67] offset:0
    ds_write_b128 v8, v[68:71] offset:16
    ds_write_b128 v8, v[72:75] offset:256
    ds_write_b128 v8, v[76:79] offset:272
    ds_write_b128 v8, v[80:83] offset:512
    ds_write_b128 v8, v[84:87] offset:528
    ds_write_b128 v8, v[88:91] offset:768
    ds_write_b128 v8, v[92:95] offset:784
    ds_write_b128 v8, v[96:99] offset:1024
    ds_write_b128 v8, v[100:103] offset:1040
    ds_write_b128 v8, v[104:107] offset:1280
    ds_write_b128 v8, v[108:111] offset:1296
    ds_write_b128 v8, v[112:115] offset:1536
    ds_write_b128 v8, v[116:119] offset:1552
    ds_write_b128 v8, v[120:123] offset:1792
    ds_write_b128 v8, v[124:127] offset:1808
    s_waitcnt lgkmcnt(0)
    s_barrier
    v_lshrrev_b32 v9, 5, v0
    v_and_b32 v10, 31, v0
    v_lshlrev_b32 v11, 8, v9
    v_lshl_add_u32 v11, v10, 3, v11
    v_add_u32 v11, 18432, v11
    ds_read_b64 v[64:65], v11 offset:0
    ds_read_b64 v[66:67], v11 offset:2048
    ds_read_b64 v[68:69], v11 offset:4096
    ds_read_b64 v[70:71], v11 offset:6144
    ds_read_b64 v[72:73], v11 offset:8192
    ds_read_b64 v[74:75], v11 offset:10240
    ds_read_b64 v[76:77], v11 offset:12288
    ds_read_b64 v[78:79], v11 offset:14336
    ds_read_b64 v[80:81], v11 offset:16384
    ds_read_b64 v[82:83], v11 offset:18432
    ds_read_b64 v[84:85], v11 offset:20480
    ds_read_b64 v[86:87], v11 offset:22528
    ds_read_b64 v[88:89], v11 offset:24576
    ds_read_b64 v[90:91], v11 offset:26624
    ds_read_b64 v[92:93], v11 offset:28672
    ds_read_b64 v[94:95], v11 offset:30720
    ds_read_b64 v[96:97], v11 offset:32768
    ds_read_b64 v[98:99], v11 offset:34816
    ds_read_b64 v[100:101], v11 offset:36864
    ds_read_b64 v[102:103], v11 offset:38912
    ds_read_b64 v[104:105], v11 offset:40960
    ds_read_b64 v[106:107], v11 offset:43008
    ds_read_b64 v[108:109], v11 offset:45056
    ds_read_b64 v[110:111], v11 offset:47104
    ds_read_b64 v[112:113], v11 offset:49152
    ds_read_b64 v[114:115], v11 offset:51200
    ds_read_b64 v[116:117], v11 offset:53248
    ds_read_b64 v[118:119], v11 offset:55296
    ds_read_b64 v[120:121], v11 offset:57344
    ds_read_b64 v[122:123], v11 offset:59392
    ds_read_b64 v[124:125], v11 offset:61440
    ds_read_b64 v[126:127], v11 offset:63488
    s_waitcnt lgkmcnt(0)
    v_add_f32 v64, v64, v66
    v_add_f32 v65, v65, v67
    v_add_f32 v64, v64, v68
    v_add_f32 v65, v65, v69
    v_add_f32 v64, v64, v70
    v_add_f32 v65, v65, v71
    v_add_f32 v64, v64, v72
    v_add_f32 v65, v65, v73
    v_add_f32 v64, v64, v74
    v_add_f32 v65, v65, v75
    v_add_f32 v64, v64, v76
    v_add_f32 v65, v65, v77
    v_add_f32 v64, v64, v78
    v_add_f32 v65, v65, v79
    v_add_f32 v64, v64, v80
    v_add_f32 v65, v65, v81
    v_add_f32 v64, v64, v82
    v_add_f32 v65, v65, v83
    v_add_f32 v64, v64, v84
    v_add_f32 v65, v65, v85
    v_add_f32 v64, v64, v86
    v_add_f32 v65, v65, v87
    v_add_f32 v64, v64, v88
    v_add_f32 v65, v65, v89
    v_add_f32 v64, v64, v90
    v_add_f32 v65, v65, v91
    v_add_f32 v64, v64, v92
    v_add_f32 v65, v65, v93
    v_add_f32 v64, v64, v94
    v_add_f32 v65, v65, v95
    v_add_f32 v64, v64, v96
    v_add_f32 v65, v65, v97
    v_add_f32 v64, v64, v98
    v_add_f32 v65, v65, v99
    v_add_f32 v64, v64, v100
    v_add_f32 v65, v65, v101
    v_add_f32 v64, v64, v102
    v_add_f32 v65, v65, v103
    v_add_f32 v64, v64, v104
    v_add_f32 v65, v65, v105
    v_add_f32 v64, v64, v106
    v_add_f32 v65, v65, v107
    v_add_f32 v64, v64, v108
    v_add_f32 v65, v65, v109
    v_add_f32 v64, v64, v110
    v_add_f32 v65, v65, v111
    v_add_f32 v64, v64, v112
    v_add_f32 v65, v65, v113
    v_add_f32 v64, v64, v114
    v_add_f32 v65, v65, v115
    v_add_f32 v64, v64, v116
    v_add_f32 v65, v65, v117
    v_add_f32 v64, v64, v118
    v_add_f32 v65, v65, v119
    v_add_f32 v64, v64, v120
    v_add_f32 v65, v65, v121
    v_add_f32 v64, v64, v122
    v_add_f32 v65, v65, v123
    v_add_f32 v64, v64, v124
    v_add_f32 v65, v65, v125
    v_add_f32 v64, v64, v126
    v_add_f32 v65, v65, v127
    s_lshl_b32 s40, s30, 8
    s_add_u32 s40, s40, 0
    s_mov_b32 s41, 13824
    v_mul_lo_u32 v12, v9, s41
    v_lshl_add_u32 v12, v10, 3, v12
    buffer_store_dwordx2 v[64:65], v12, s[12:15], s40 offen
    s_waitcnt vmcnt(0)
L_end_ka_kernel:
    s_endpgm
.globl kb_kernel
.p2align 8
.type kb_kernel,@function
kb_kernel:
    s_cmp_ge_u32 s2, 64
    s_cbranch_scc1 L_end_kb_kernel
    s_load_dwordx2 s[28:29], s[0:1], 24
    s_load_dwordx2 s[36:37], s[0:1], 104
    s_load_dwordx2 s[38:39], s[0:1], 0
    s_waitcnt lgkmcnt(0)
    s_mov_b32 s30, s2
    s_mov_b32 s31, 0
    s_mov_b32 s45, 0
    s_mov_b32 s8, s28
    s_and_b32 s9, s29, 0xffff
    s_mov_b32 s10, 0x480000
    s_mov_b32 s11, 0x20000
    s_mov_b32 s12, s36
    s_and_b32 s13, s37, 0xffff
    s_mov_b32 s14, 0x40000000
    s_mov_b32 s15, 0x20000
    s_mov_b32 s16, s38
    s_and_b32 s17, s39, 0xffff
    s_mov_b32 s18, 0x2400
    s_mov_b32 s19, 0x20000
    v_and_b32 v1, 63, v0
    v_lshrrev_b32 v2, 6, v0
    v_lshrrev_b32 v3, 3, v1
    v_and_b32 v4, 7, v1
    v_lshl_add_u32 v5, v2, 3, v3
    s_mov_b32 s33, 8192
    v_mul_lo_u32 v6, v5, s33
    v_lshl_add_u32 v6, v4, 4, v6
    v_lshlrev_b32 v7, 5, v5
    s_lshl_b32 s32, s30, 7
    s_mul_i32 s34, s31, 4718592
    s_add_u32 s32, s32, s34
    buffer_load_dwordx4 v[128:131], v6, s[8:11], s32 offen
    s_add_u32 s32, s32, 262144
    buffer_load_dwordx4 v[132:135], v6, s[8:11], s32 offen
    s_add_u32 s32, s32, 262144
    buffer_load_dwordx4 v[136:139], v6, s[8:11], s32 offen
    s_add_u32 s32, s32, 262144
    buffer_load_dwordx4 v[140:143], v6, s[8:11], s32 offen
    s_add_u32 s32, s32, 262144
    buffer_load_dwordx4 v[144:147], v6, s[8:11], s32 offen
    s_add_u32 s32, s32, 262144
    buffer_load_dwordx4 v[148:151], v6, s[8:11], s32 offen
    s_add_u32 s32, s32, 262144
    buffer_load_dwordx4 v[152:155], v6, s[8:11], s32 offen
    s_add_u32 s32, s32, 262144
    buffer_load_dwordx4 v[156:159], v6, s[8:11], s32 offen
    s_add_u32 s32, s32, 262144
    buffer_load_dwordx4 v[160:163], v6, s[8:11], s32 offen
    s_add_u32 s32, s32, 262144
    buffer_load_dwordx4 v[164:167], v6, s[8:11], s32 offen
    s_add_u32 s32, s32, 262144
    buffer_load_dwordx4 v[168:171], v6, s[8:11], s32 offen
    s_add_u32 s32, s32, 262144
    buffer_load_dwordx4 v[172:175], v6, s[8:11], s32 offen
    s_add_u32 s32, s32, 262144
    buffer_load_dwordx4 v[176:179], v6, s[8:11], s32 offen
    s_add_u32 s32, s32, 262144
    buffer_load_dwordx4 v[180:183], v6, s[8:11], s32 offen
    s_add_u32 s32, s32, 262144
    buffer_load_dwordx4 v[184:187], v6, s[8:11], s32 offen
    s_add_u32 s32, s32, 262144
    buffer_load_dwordx4 v[188:191], v6, s[8:11], s32 offen
    s_add_u32 s32, s32, 262144
    buffer_load_dwordx4 v[192:195], v6, s[8:11], s32 offen
    s_add_u32 s32, s32, 262144
    buffer_load_dwordx4 v[196:199], v6, s[8:11], s32 offen
    v_mul_u32_u24 v216, 2304, v2
    v_lshl_add_u32 v216, v1, 1, v216
    s_mov_b32 s40, 27648
    v_mul_lo_u32 v220, v2, s40
    v_lshl_add_u32 v220, v1, 2, v220
    v_add_u32 v221, 2304, v220
    v_add_u32 v222, 13824, v220
    v_add_u32 v223, 16128, v220
    buffer_load_ushort v8, v216, s[16:19], 0 offen offset:0
    buffer_load_dword v26, v220, s[12:15], 0 offen offset:0
    buffer_load_dword v44, v221, s[12:15], 0 offen offset:0
    buffer_load_ushort v9, v216, s[16:19], 0 offen offset:128
    buffer_load_dword v27, v220, s[12:15], 0 offen offset:256
    buffer_load_dword v45, v221, s[12:15], 0 offen offset:256
    buffer_load_ushort v10, v216, s[16:19], 0 offen offset:256
    buffer_load_dword v28, v220, s[12:15], 0 offen offset:512
    buffer_load_dword v46, v221, s[12:15], 0 offen offset:512
    buffer_load_ushort v11, v216, s[16:19], 0 offen offset:384
    buffer_load_dword v29, v220, s[12:15], 0 offen offset:768
    buffer_load_dword v47, v221, s[12:15], 0 offen offset:768
    buffer_load_ushort v12, v216, s[16:19], 0 offen offset:512
    buffer_load_dword v30, v220, s[12:15], 0 offen offset:1024
    buffer_load_dword v48, v221, s[12:15], 0 offen offset:1024
    buffer_load_ushort v13, v216, s[16:19], 0 offen offset:640
    buffer_load_dword v31, v220, s[12:15], 0 offen offset:1280
    buffer_load_dword v49, v221, s[12:15], 0 offen offset:1280
    buffer_load_ushort v14, v216, s[16:19], 0 offen offset:768
    buffer_load_dword v32, v220, s[12:15], 0 offen offset:1536
    buffer_load_dword v50, v221, s[12:15], 0 offen offset:1536
    buffer_load_ushort v15, v216, s[16:19], 0 offen offset:896
    buffer_load_dword v33, v220, s[12:15], 0 offen offset:1792
    buffer_load_dword v51, v221, s[12:15], 0 offen offset:1792
    buffer_load_ushort v16, v216, s[16:19], 0 offen offset:1024
    buffer_load_dword v34, v220, s[12:15], 0 offen offset:2048
    buffer_load_dword v52, v221, s[12:15], 0 offen offset:2048
    buffer_load_ushort v17, v216, s[16:19], 0 offen offset:1152
    buffer_load_dword v35, v222, s[12:15], 0 offen offset:0
    buffer_load_dword v53, v223, s[12:15], 0 offen offset:0
    buffer_load_ushort v18, v216, s[16:19], 0 offen offset:1280
    buffer_load_dword v36, v222, s[12:15], 0 offen offset:256
    buffer_load_dword v54, v223, s[12:15], 0 offen offset:256
    buffer_load_ushort v19, v216, s[16:19], 0 offen offset:1408
    buffer_load_dword v37, v222, s[12:15], 0 offen offset:512
    buffer_load_dword v55, v223, s[12:15], 0 offen offset:512
    buffer_load_ushort v20, v216, s[16:19], 0 offen offset:1536
    buffer_load_dword v38, v222, s[12:15], 0 offen offset:768
    buffer_load_dword v56, v223, s[12:15], 0 offen offset:768
    buffer_load_ushort v21, v216, s[16:19], 0 offen offset:1664
    buffer_load_dword v39, v222, s[12:15], 0 offen offset:1024
    buffer_load_dword v57, v223, s[12:15], 0 offen offset:1024
    buffer_load_ushort v22, v216, s[16:19], 0 offen offset:1792
    buffer_load_dword v40, v222, s[12:15], 0 offen offset:1280
    buffer_load_dword v58, v223, s[12:15], 0 offen offset:1280
    buffer_load_ushort v23, v216, s[16:19], 0 offen offset:1920
    buffer_load_dword v41, v222, s[12:15], 0 offen offset:1536
    buffer_load_dword v59, v223, s[12:15], 0 offen offset:1536
    buffer_load_ushort v24, v216, s[16:19], 0 offen offset:2048
    buffer_load_dword v42, v222, s[12:15], 0 offen offset:1792
    buffer_load_dword v60, v223, s[12:15], 0 offen offset:1792
    buffer_load_ushort v25, v216, s[16:19], 0 offen offset:2176
    buffer_load_dword v43, v222, s[12:15], 0 offen offset:2048
    buffer_load_dword v61, v223, s[12:15], 0 offen offset:2048
    v_lshlrev_b32 v224, 5, v1
    v_lshl_add_u32 v224, v2, 3, v224
    s_waitcnt vmcnt(0)
    v_lshlrev_b32 v8, 16, v8
    v_lshlrev_b32 v9, 16, v9
    v_lshlrev_b32 v10, 16, v10
    v_lshlrev_b32 v11, 16, v11
    v_lshlrev_b32 v12, 16, v12
    v_lshlrev_b32 v13, 16, v13
    v_lshlrev_b32 v14, 16, v14
    v_lshlrev_b32 v15, 16, v15
    v_lshlrev_b32 v16, 16, v16
    v_add_f32 v216, v8, v9
    v_add_f32 v216, v216, v10
    v_add_f32 v216, v216, v11
    v_add_f32 v216, v216, v12
    v_add_f32 v216, v216, v13
    v_add_f32 v216, v216, v14
    v_add_f32 v216, v216, v15
    v_add_f32 v216, v216, v16
    s_nop 1
    v_add_f32_dpp v216, v216, v216 row_ror:8 row_mask:0xf bank_mask:0xf
    s_nop 1
    v_add_f32_dpp v216, v216, v216 row_ror:4 row_mask:0xf bank_mask:0xf
    s_nop 1
    v_add_f32_dpp v216, v216, v216 row_ror:2 row_mask:0xf bank_mask:0xf
    s_nop 1
    v_add_f32_dpp v216, v216, v216 row_ror:1 row_mask:0xf bank_mask:0xf
    s_nop 0
    v_readlane_b32 s40, v216, 0
    v_readlane_b32 s41, v216, 16
    v_readlane_b32 s42, v216, 32
    v_readlane_b32 s43, v216, 48
    v_mov_b32 v216, s40
    v_add_f32 v216, s41, v216
    v_add_f32 v216, s42, v216
    v_add_f32 v216, s43, v216
    v_mul_f32 v216, 0x3ae38e39, v216
    v_sub_f32 v8, v8, v216
    v_sub_f32 v9, v9, v216
    v_sub_f32 v10, v10, v216
    v_sub_f32 v11, v11, v216
    v_sub_f32 v12, v12, v216
    v_sub_f32 v13, v13, v216
    v_sub_f32 v14, v14, v216
    v_sub_f32 v15, v15, v216
    v_sub_f32 v16, v16, v216
    v_mul_f32 v217, v8, v8
    v_fmac_f32 v217, v9, v9
    v_fmac_f32 v217, v10, v10
    v_fmac_f32 v217, v11, v11
    v_fmac_f32 v217, v12, v12
    v_fmac_f32 v217, v13, v13
    v_fmac_f32 v217, v14, v14
    v_fmac_f32 v217, v15, v15
    v_fmac_f32 v217, v16, v16
    s_nop 1
    v_add_f32_dpp v217, v217, v217 row_ror:8 row_mask:0xf bank_mask:0xf
    s_nop 1
    v_add_f32_dpp v217, v217, v217 row_ror:4 row_mask:0xf bank_mask:0xf
    s_nop 1
    v_add_f32_dpp v217, v217, v217 row_ror:2 row_mask:0xf bank_mask:0xf
    s_nop 1
    v_add_f32_dpp v217, v217, v217 row_ror:1 row_mask:0xf bank_mask:0xf
    s_nop 0
    v_readlane_b32 s40, v217, 0
    v_readlane_b32 s41, v217, 16
    v_readlane_b32 s42, v217, 32
    v_readlane_b32 s43, v217, 48
    v_mov_b32 v217, s40
    v_add_f32 v217, s41, v217
    v_add_f32 v217, s42, v217
    v_add_f32 v217, s43, v217
    v_mov_b32 v218, 0x3727c5ac
    v_fmac_f32 v218, 0x3ae38e39, v217
    v_rsq_f32 v218, v218
    s_nop 0
    v_mul_f32 v8, v8, v218
    v_mul_f32 v9, v9, v218
    v_mul_f32 v10, v10, v218
    v_mul_f32 v11, v11, v218
    v_mul_f32 v12, v12, v218
    v_mul_f32 v13, v13, v218
    v_mul_f32 v14, v14, v218
    v_mul_f32 v15, v15, v218
    v_mul_f32 v16, v16, v218
    v_add_f32 v219, 1.0, v44
    v_fma_f32 v8, v8, v219, v26
    ds_write_b32 v224, v8 offset:0
    v_add_f32 v219, 1.0, v45
    v_fma_f32 v9, v9, v219, v27
    ds_write_b32 v224, v9 offset:2048
    v_add_f32 v219, 1.0, v46
    v_fma_f32 v10, v10, v219, v28
    ds_write_b32 v224, v10 offset:4096
    v_add_f32 v219, 1.0, v47
    v_fma_f32 v11, v11, v219, v29
    ds_write_b32 v224, v11 offset:6144
    v_add_f32 v219, 1.0, v48
    v_fma_f32 v12, v12, v219, v30
    ds_write_b32 v224, v12 offset:8192
    v_add_f32 v219, 1.0, v49
    v_fma_f32 v13, v13, v219, v31
    ds_write_b32 v224, v13 offset:10240
    v_add_f32 v219, 1.0, v50
    v_fma_f32 v14, v14, v219, v32
    ds_write_b32 v224, v14 offset:12288
    v_add_f32 v219, 1.0, v51
    v_fma_f32 v15, v15, v219, v33
    ds_write_b32 v224, v15 offset:14336
    v_add_f32 v219, 1.0, v52
    v_fma_f32 v16, v16, v219, v34
    ds_write_b32 v224, v16 offset:16384
    v_lshlrev_b32 v17, 16, v17
    v_lshlrev_b32 v18, 16, v18
    v_lshlrev_b32 v19, 16, v19
    v_lshlrev_b32 v20, 16, v20
    v_lshlrev_b32 v21, 16, v21
    v_lshlrev_b32 v22, 16, v22
    v_lshlrev_b32 v23, 16, v23
    v_lshlrev_b32 v24, 16, v24
    v_lshlrev_b32 v25, 16, v25
    v_add_f32 v216, v17, v18
    v_add_f32 v216, v216, v19
    v_add_f32 v216, v216, v20
    v_add_f32 v216, v216, v21
    v_add_f32 v216, v216, v22
    v_add_f32 v216, v216, v23
    v_add_f32 v216, v216, v24
    v_add_f32 v216, v216, v25
    s_nop 1
    v_add_f32_dpp v216, v216, v216 row_ror:8 row_mask:0xf bank_mask:0xf
    s_nop 1
    v_add_f32_dpp v216, v216, v216 row_ror:4 row_mask:0xf bank_mask:0xf
    s_nop 1
    v_add_f32_dpp v216, v216, v216 row_ror:2 row_mask:0xf bank_mask:0xf
    s_nop 1
    v_add_f32_dpp v216, v216, v216 row_ror:1 row_mask:0xf bank_mask:0xf
    s_nop 0
    v_readlane_b32 s40, v216, 0
    v_readlane_b32 s41, v216, 16
    v_readlane_b32 s42, v216, 32
    v_readlane_b32 s43, v216, 48
    v_mov_b32 v216, s40
    v_add_f32 v216, s41, v216
    v_add_f32 v216, s42, v216
    v_add_f32 v216, s43, v216
    v_mul_f32 v216, 0x3ae38e39, v216
    v_sub_f32 v17, v17, v216
    v_sub_f32 v18, v18, v216
    v_sub_f32 v19, v19, v216
    v_sub_f32 v20, v20, v216
    v_sub_f32 v21, v21, v216
    v_sub_f32 v22, v22, v216
    v_sub_f32 v23, v23, v216
    v_sub_f32 v24, v24, v216
    v_sub_f32 v25, v25, v216
    v_mul_f32 v217, v17, v17
    v_fmac_f32 v217, v18, v18
    v_fmac_f32 v217, v19, v19
    v_fmac_f32 v217, v20, v20
    v_fmac_f32 v217, v21, v21
    v_fmac_f32 v217, v22, v22
    v_fmac_f32 v217, v23, v23
    v_fmac_f32 v217, v24, v24
    v_fmac_f32 v217, v25, v25
    s_nop 1
    v_add_f32_dpp v217, v217, v217 row_ror:8 row_mask:0xf bank_mask:0xf
    s_nop 1
    v_add_f32_dpp v217, v217, v217 row_ror:4 row_mask:0xf bank_mask:0xf
    s_nop 1
    v_add_f32_dpp v217, v217, v217 row_ror:2 row_mask:0xf bank_mask:0xf
    s_nop 1
    v_add_f32_dpp v217, v217, v217 row_ror:1 row_mask:0xf bank_mask:0xf
    s_nop 0
    v_readlane_b32 s40, v217, 0
    v_readlane_b32 s41, v217, 16
    v_readlane_b32 s42, v217, 32
    v_readlane_b32 s43, v217, 48
    v_mov_b32 v217, s40
    v_add_f32 v217, s41, v217
    v_add_f32 v217, s42, v217
    v_add_f32 v217, s43, v217
    v_mov_b32 v218, 0x3727c5ac
    v_fmac_f32 v218, 0x3ae38e39, v217
    v_rsq_f32 v218, v218
    s_nop 0
    v_mul_f32 v17, v17, v218
    v_mul_f32 v18, v18, v218
    v_mul_f32 v19, v19, v218
    v_mul_f32 v20, v20, v218
    v_mul_f32 v21, v21, v218
    v_mul_f32 v22, v22, v218
    v_mul_f32 v23, v23, v218
    v_mul_f32 v24, v24, v218
    v_mul_f32 v25, v25, v218
    v_add_f32 v219, 1.0, v53
    v_fma_f32 v17, v17, v219, v35
    ds_write_b32 v224, v17 offset:4
    v_add_f32 v219, 1.0, v54
    v_fma_f32 v18, v18, v219, v36
    ds_write_b32 v224, v18 offset:2052
    v_add_f32 v219, 1.0, v55
    v_fma_f32 v19, v19, v219, v37
    ds_write_b32 v224, v19 offset:4100
    v_add_f32 v219, 1.0, v56
    v_fma_f32 v20, v20, v219, v38
    ds_write_b32 v224, v20 offset:6148
    v_add_f32 v219, 1.0, v57
    v_fma_f32 v21, v21, v219, v39
    ds_write_b32 v224, v21 offset:8196
    v_add_f32 v219, 1.0, v58
    v_fma_f32 v22, v22, v219, v40
    ds_write_b32 v224, v22 offset:10244
    v_add_f32 v219, 1.0, v59
    v_fma_f32 v23, v23, v219, v41
    ds_write_b32 v224, v23 offset:12292
    v_add_f32 v219, 1.0, v60
    v_fma_f32 v24, v24, v219, v42
    ds_write_b32 v224, v24 offset:14340
    v_add_f32 v219, 1.0, v61
    v_fma_f32 v25, v25, v219, v43
    ds_write_b32 v224, v25 offset:16388
    s_waitcnt vmcnt(0) lgkmcnt(0)
    s_barrier
    v_mov_b32 v64, 0
    v_mov_b32 v65, 0
    v_mov_b32 v66, 0
    v_mov_b32 v67, 0
    v_mov_b32 v68, 0
    v_mov_b32 v69, 0
    v_mov_b32 v70, 0
    v_mov_b32 v71, 0
    v_mov_b32 v72, 0
    v_mov_b32 v73, 0
    v_mov_b32 v74, 0
    v_mov_b32 v75, 0
    v_mov_b32 v76, 0
    v_mov_b32 v77, 0
    v_mov_b32 v78, 0
    v_mov_b32 v79, 0
    v_mov_b32 v80, 0
    v_mov_b32 v81, 0
    v_mov_b32 v82, 0
    v_mov_b32 v83, 0
    v_mov_b32 v84, 0
    v_mov_b32 v85, 0
    v_mov_b32 v86, 0
    v_mov_b32 v87, 0
    v_mov_b32 v88, 0
    v_mov_b32 v89, 0
    v_mov_b32 v90, 0
    v_mov_b32 v91, 0
    v_mov_b32 v92, 0
    v_mov_b32 v93, 0
    v_mov_b32 v94, 0
    v_mov_b32 v95, 0
    v_mov_b32 v96, 0
    v_mov_b32 v97, 0
    v_mov_b32 v98, 0
    v_mov_b32 v99, 0
    v_mov_b32 v100, 0
    v_mov_b32 v101, 0
    v_mov_b32 v102, 0
    v_mov_b32 v103, 0
    v_mov_b32 v104, 0
    v_mov_b32 v105, 0
    v_mov_b32 v106, 0
    v_mov_b32 v107, 0
    v_mov_b32 v108, 0
    v_mov_b32 v109, 0
    v_mov_b32 v110, 0
    v_mov_b32 v111, 0
    v_mov_b32 v112, 0
    v_mov_b32 v113, 0
    v_mov_b32 v114, 0
    v_mov_b32 v115, 0
    v_mov_b32 v116, 0
    v_mov_b32 v117, 0
    v_mov_b32 v118, 0
    v_mov_b32 v119, 0
    v_mov_b32 v120, 0
    v_mov_b32 v121, 0
    v_mov_b32 v122, 0
    v_mov_b32 v123, 0
    v_mov_b32 v124, 0
    v_mov_b32 v125, 0
    v_mov_b32 v126, 0
    v_mov_b32 v127, 0
    ds_read_b128 v[200:203], v7 offset:0
    ds_read_b128 v[204:207], v7 offset:16
    v_lshlrev_b32 v208, 16, v128
    v_and_b32 v209, 0xffff0000, v128
    v_lshlrev_b32 v210, 16, v129
    v_and_b32 v211, 0xffff0000, v129
    v_lshlrev_b32 v212, 16, v130
    v_and_b32 v213, 0xffff0000, v130
    v_lshlrev_b32 v214, 16, v131
    v_and_b32 v215, 0xffff0000, v131
    s_waitcnt lgkmcnt(0)
    v_fmac_f32 v64, v200, v208
    v_fmac_f32 v65, v200, v209
    v_fmac_f32 v66, v200, v210
    v_fmac_f32 v67, v200, v211
    v_fmac_f32 v68, v200, v212
    v_fmac_f32 v69, v200, v213
    v_fmac_f32 v70, v200, v214
    v_fmac_f32 v71, v200, v215
    v_fmac_f32 v72, v201, v208
    v_fmac_f32 v73, v201, v209
    v_fmac_f32 v74, v201, v210
    v_fmac_f32 v75, v201, v211
    v_fmac_f32 v76, v201, v212
    v_fmac_f32 v77, v201, v213
    v_fmac_f32 v78, v201, v214
    v_fmac_f32 v79, v201, v215
    v_fmac_f32 v80, v202, v208
    v_fmac_f32 v81, v202, v209
    v_fmac_f32 v82, v202, v210
    v_fmac_f32 v83, v202, v211
    v_fmac_f32 v84, v202, v212
    v_fmac_f32 v85, v202, v213
    v_fmac_f32 v86, v202, v214
    v_fmac_f32 v87, v202, v215
    v_fmac_f32 v88, v203, v208
    v_fmac_f32 v89, v203, v209
    v_fmac_f32 v90, v203, v210
    v_fmac_f32 v91, v203, v211
    v_fmac_f32 v92, v203, v212
    v_fmac_f32 v93, v203, v213
    v_fmac_f32 v94, v203, v214
    v_fmac_f32 v95, v203, v215
    v_fmac_f32 v96, v204, v208
    v_fmac_f32 v97, v204, v209
    v_fmac_f32 v98, v204, v210
    v_fmac_f32 v99, v204, v211
    v_fmac_f32 v100, v204, v212
    v_fmac_f32 v101, v204, v213
    v_fmac_f32 v102, v204, v214
    v_fmac_f32 v103, v204, v215
    v_fmac_f32 v104, v205, v208
    v_fmac_f32 v105, v205, v209
    v_fmac_f32 v106, v205, v210
    v_fmac_f32 v107, v205, v211
    v_fmac_f32 v108, v205, v212
    v_fmac_f32 v109, v205, v213
    v_fmac_f32 v110, v205, v214
    v_fmac_f32 v111, v205, v215
    v_fmac_f32 v112, v206, v208
    v_fmac_f32 v113, v206, v209
    v_fmac_f32 v114, v206, v210
    v_fmac_f32 v115, v206, v211
    v_fmac_f32 v116, v206, v212
    v_fmac_f32 v117, v206, v213
    v_fmac_f32 v118, v206, v214
    v_fmac_f32 v119, v206, v215
    v_fmac_f32 v120, v207, v208
    v_fmac_f32 v121, v207, v209
    v_fmac_f32 v122, v207, v210
    v_fmac_f32 v123, v207, v211
    v_fmac_f32 v124, v207, v212
    v_fmac_f32 v125, v207, v213
    v_fmac_f32 v126, v207, v214
    v_fmac_f32 v127, v207, v215
    ds_read_b128 v[200:203], v7 offset:1024
    ds_read_b128 v[204:207], v7 offset:1040
    v_lshlrev_b32 v208, 16, v132
    v_and_b32 v209, 0xffff0000, v132
    v_lshlrev_b32 v210, 16, v133
    v_and_b32 v211, 0xffff0000, v133
    v_lshlrev_b32 v212, 16, v134
    v_and_b32 v213, 0xffff0000, v134
    v_lshlrev_b32 v214, 16, v135
    v_and_b32 v215, 0xffff0000, v135
    s_waitcnt lgkmcnt(0)
    v_fmac_f32 v64, v200, v208
    v_fmac_f32 v65, v200, v209
    v_fmac_f32 v66, v200, v210
    v_fmac_f32 v67, v200, v211
    v_fmac_f32 v68, v200, v212
    v_fmac_f32 v69, v200, v213
    v_fmac_f32 v70, v200, v214
    v_fmac_f32 v71, v200, v215
    v_fmac_f32 v72, v201, v208
    v_fmac_f32 v73, v201, v209
    v_fmac_f32 v74, v201, v210
    v_fmac_f32 v75, v201, v211
    v_fmac_f32 v76, v201, v212
    v_fmac_f32 v77, v201, v213
    v_fmac_f32 v78, v201, v214
    v_fmac_f32 v79, v201, v215
    v_fmac_f32 v80, v202, v208
    v_fmac_f32 v81, v202, v209
    v_fmac_f32 v82, v202, v210
    v_fmac_f32 v83, v202, v211
    v_fmac_f32 v84, v202, v212
    v_fmac_f32 v85, v202, v213
    v_fmac_f32 v86, v202, v214
    v_fmac_f32 v87, v202, v215
    v_fmac_f32 v88, v203, v208
    v_fmac_f32 v89, v203, v209
    v_fmac_f32 v90, v203, v210
    v_fmac_f32 v91, v203, v211
    v_fmac_f32 v92, v203, v212
    v_fmac_f32 v93, v203, v213
    v_fmac_f32 v94, v203, v214
    v_fmac_f32 v95, v203, v215
    v_fmac_f32 v96, v204, v208
    v_fmac_f32 v97, v204, v209
    v_fmac_f32 v98, v204, v210
    v_fmac_f32 v99, v204, v211
    v_fmac_f32 v100, v204, v212
    v_fmac_f32 v101, v204, v213
    v_fmac_f32 v102, v204, v214
    v_fmac_f32 v103, v204, v215
    v_fmac_f32 v104, v205, v208
    v_fmac_f32 v105, v205, v209
    v_fmac_f32 v106, v205, v210
    v_fmac_f32 v107, v205, v211
    v_fmac_f32 v108, v205, v212
    v_fmac_f32 v109, v205, v213
    v_fmac_f32 v110, v205, v214
    v_fmac_f32 v111, v205, v215
    v_fmac_f32 v112, v206, v208
    v_fmac_f32 v113, v206, v209
    v_fmac_f32 v114, v206, v210
    v_fmac_f32 v115, v206, v211
    v_fmac_f32 v116, v206, v212
    v_fmac_f32 v117, v206, v213
    v_fmac_f32 v118, v206, v214
    v_fmac_f32 v119, v206, v215
    v_fmac_f32 v120, v207, v208
    v_fmac_f32 v121, v207, v209
    v_fmac_f32 v122, v207, v210
    v_fmac_f32 v123, v207, v211
    v_fmac_f32 v124, v207, v212
    v_fmac_f32 v125, v207, v213
    v_fmac_f32 v126, v207, v214
    v_fmac_f32 v127, v207, v215
    ds_read_b128 v[200:203], v7 offset:2048
    ds_read_b128 v[204:207], v7 offset:2064
    v_lshlrev_b32 v208, 16, v136
    v_and_b32 v209, 0xffff0000, v136
    v_lshlrev_b32 v210, 16, v137
    v_and_b32 v211, 0xffff0000, v137
    v_lshlrev_b32 v212, 16, v138
    v_and_b32 v213, 0xffff0000, v138
    v_lshlrev_b32 v214, 16, v139
    v_and_b32 v215, 0xffff0000, v139
    s_waitcnt lgkmcnt(0)
    v_fmac_f32 v64, v200, v208
    v_fmac_f32 v65, v200, v209
    v_fmac_f32 v66, v200, v210
    v_fmac_f32 v67, v200, v211
    v_fmac_f32 v68, v200, v212
    v_fmac_f32 v69, v200, v213
    v_fmac_f32 v70, v200, v214
    v_fmac_f32 v71, v200, v215
    v_fmac_f32 v72, v201, v208
    v_fmac_f32 v73, v201, v209
    v_fmac_f32 v74, v201, v210
    v_fmac_f32 v75, v201, v211
    v_fmac_f32 v76, v201, v212
    v_fmac_f32 v77, v201, v213
    v_fmac_f32 v78, v201, v214
    v_fmac_f32 v79, v201, v215
    v_fmac_f32 v80, v202, v208
    v_fmac_f32 v81, v202, v209
    v_fmac_f32 v82, v202, v210
    v_fmac_f32 v83, v202, v211
    v_fmac_f32 v84, v202, v212
    v_fmac_f32 v85, v202, v213
    v_fmac_f32 v86, v202, v214
    v_fmac_f32 v87, v202, v215
    v_fmac_f32 v88, v203, v208
    v_fmac_f32 v89, v203, v209
    v_fmac_f32 v90, v203, v210
    v_fmac_f32 v91, v203, v211
    v_fmac_f32 v92, v203, v212
    v_fmac_f32 v93, v203, v213
    v_fmac_f32 v94, v203, v214
    v_fmac_f32 v95, v203, v215
    v_fmac_f32 v96, v204, v208
    v_fmac_f32 v97, v204, v209
    v_fmac_f32 v98, v204, v210
    v_fmac_f32 v99, v204, v211
    v_fmac_f32 v100, v204, v212
    v_fmac_f32 v101, v204, v213
    v_fmac_f32 v102, v204, v214
    v_fmac_f32 v103, v204, v215
    v_fmac_f32 v104, v205, v208
    v_fmac_f32 v105, v205, v209
    v_fmac_f32 v106, v205, v210
    v_fmac_f32 v107, v205, v211
    v_fmac_f32 v108, v205, v212
    v_fmac_f32 v109, v205, v213
    v_fmac_f32 v110, v205, v214
    v_fmac_f32 v111, v205, v215
    v_fmac_f32 v112, v206, v208
    v_fmac_f32 v113, v206, v209
    v_fmac_f32 v114, v206, v210
    v_fmac_f32 v115, v206, v211
    v_fmac_f32 v116, v206, v212
    v_fmac_f32 v117, v206, v213
    v_fmac_f32 v118, v206, v214
    v_fmac_f32 v119, v206, v215
    v_fmac_f32 v120, v207, v208
    v_fmac_f32 v121, v207, v209
    v_fmac_f32 v122, v207, v210
    v_fmac_f32 v123, v207, v211
    v_fmac_f32 v124, v207, v212
    v_fmac_f32 v125, v207, v213
    v_fmac_f32 v126, v207, v214
    v_fmac_f32 v127, v207, v215
    ds_read_b128 v[200:203], v7 offset:3072
    ds_read_b128 v[204:207], v7 offset:3088
    v_lshlrev_b32 v208, 16, v140
    v_and_b32 v209, 0xffff0000, v140
    v_lshlrev_b32 v210, 16, v141
    v_and_b32 v211, 0xffff0000, v141
    v_lshlrev_b32 v212, 16, v142
    v_and_b32 v213, 0xffff0000, v142
    v_lshlrev_b32 v214, 16, v143
    v_and_b32 v215, 0xffff0000, v143
    s_waitcnt lgkmcnt(0)
    v_fmac_f32 v64, v200, v208
    v_fmac_f32 v65, v200, v209
    v_fmac_f32 v66, v200, v210
    v_fmac_f32 v67, v200, v211
    v_fmac_f32 v68, v200, v212
    v_fmac_f32 v69, v200, v213
    v_fmac_f32 v70, v200, v214
    v_fmac_f32 v71, v200, v215
    v_fmac_f32 v72, v201, v208
    v_fmac_f32 v73, v201, v209
    v_fmac_f32 v74, v201, v210
    v_fmac_f32 v75, v201, v211
    v_fmac_f32 v76, v201, v212
    v_fmac_f32 v77, v201, v213
    v_fmac_f32 v78, v201, v214
    v_fmac_f32 v79, v201, v215
    v_fmac_f32 v80, v202, v208
    v_fmac_f32 v81, v202, v209
    v_fmac_f32 v82, v202, v210
    v_fmac_f32 v83, v202, v211
    v_fmac_f32 v84, v202, v212
    v_fmac_f32 v85, v202, v213
    v_fmac_f32 v86, v202, v214
    v_fmac_f32 v87, v202, v215
    v_fmac_f32 v88, v203, v208
    v_fmac_f32 v89, v203, v209
    v_fmac_f32 v90, v203, v210
    v_fmac_f32 v91, v203, v211
    v_fmac_f32 v92, v203, v212
    v_fmac_f32 v93, v203, v213
    v_fmac_f32 v94, v203, v214
    v_fmac_f32 v95, v203, v215
    v_fmac_f32 v96, v204, v208
    v_fmac_f32 v97, v204, v209
    v_fmac_f32 v98, v204, v210
    v_fmac_f32 v99, v204, v211
    v_fmac_f32 v100, v204, v212
    v_fmac_f32 v101, v204, v213
    v_fmac_f32 v102, v204, v214
    v_fmac_f32 v103, v204, v215
    v_fmac_f32 v104, v205, v208
    v_fmac_f32 v105, v205, v209
    v_fmac_f32 v106, v205, v210
    v_fmac_f32 v107, v205, v211
    v_fmac_f32 v108, v205, v212
    v_fmac_f32 v109, v205, v213
    v_fmac_f32 v110, v205, v214
    v_fmac_f32 v111, v205, v215
    v_fmac_f32 v112, v206, v208
    v_fmac_f32 v113, v206, v209
    v_fmac_f32 v114, v206, v210
    v_fmac_f32 v115, v206, v211
    v_fmac_f32 v116, v206, v212
    v_fmac_f32 v117, v206, v213
    v_fmac_f32 v118, v206, v214
    v_fmac_f32 v119, v206, v215
    v_fmac_f32 v120, v207, v208
    v_fmac_f32 v121, v207, v209
    v_fmac_f32 v122, v207, v210
    v_fmac_f32 v123, v207, v211
    v_fmac_f32 v124, v207, v212
    v_fmac_f32 v125, v207, v213
    v_fmac_f32 v126, v207, v214
    v_fmac_f32 v127, v207, v215
    ds_read_b128 v[200:203], v7 offset:4096
    ds_read_b128 v[204:207], v7 offset:4112
    v_lshlrev_b32 v208, 16, v144
    v_and_b32 v209, 0xffff0000, v144
    v_lshlrev_b32 v210, 16, v145
    v_and_b32 v211, 0xffff0000, v145
    v_lshlrev_b32 v212, 16, v146
    v_and_b32 v213, 0xffff0000, v146
    v_lshlrev_b32 v214, 16, v147
    v_and_b32 v215, 0xffff0000, v147
    s_waitcnt lgkmcnt(0)
    v_fmac_f32 v64, v200, v208
    v_fmac_f32 v65, v200, v209
    v_fmac_f32 v66, v200, v210
    v_fmac_f32 v67, v200, v211
    v_fmac_f32 v68, v200, v212
    v_fmac_f32 v69, v200, v213
    v_fmac_f32 v70, v200, v214
    v_fmac_f32 v71, v200, v215
    v_fmac_f32 v72, v201, v208
    v_fmac_f32 v73, v201, v209
    v_fmac_f32 v74, v201, v210
    v_fmac_f32 v75, v201, v211
    v_fmac_f32 v76, v201, v212
    v_fmac_f32 v77, v201, v213
    v_fmac_f32 v78, v201, v214
    v_fmac_f32 v79, v201, v215
    v_fmac_f32 v80, v202, v208
    v_fmac_f32 v81, v202, v209
    v_fmac_f32 v82, v202, v210
    v_fmac_f32 v83, v202, v211
    v_fmac_f32 v84, v202, v212
    v_fmac_f32 v85, v202, v213
    v_fmac_f32 v86, v202, v214
    v_fmac_f32 v87, v202, v215
    v_fmac_f32 v88, v203, v208
    v_fmac_f32 v89, v203, v209
    v_fmac_f32 v90, v203, v210
    v_fmac_f32 v91, v203, v211
    v_fmac_f32 v92, v203, v212
    v_fmac_f32 v93, v203, v213
    v_fmac_f32 v94, v203, v214
    v_fmac_f32 v95, v203, v215
    v_fmac_f32 v96, v204, v208
    v_fmac_f32 v97, v204, v209
    v_fmac_f32 v98, v204, v210
    v_fmac_f32 v99, v204, v211
    v_fmac_f32 v100, v204, v212
    v_fmac_f32 v101, v204, v213
    v_fmac_f32 v102, v204, v214
    v_fmac_f32 v103, v204, v215
    v_fmac_f32 v104, v205, v208
    v_fmac_f32 v105, v205, v209
    v_fmac_f32 v106, v205, v210
    v_fmac_f32 v107, v205, v211
    v_fmac_f32 v108, v205, v212
    v_fmac_f32 v109, v205, v213
    v_fmac_f32 v110, v205, v214
    v_fmac_f32 v111, v205, v215
    v_fmac_f32 v112, v206, v208
    v_fmac_f32 v113, v206, v209
    v_fmac_f32 v114, v206, v210
    v_fmac_f32 v115, v206, v211
    v_fmac_f32 v116, v206, v212
    v_fmac_f32 v117, v206, v213
    v_fmac_f32 v118, v206, v214
    v_fmac_f32 v119, v206, v215
    v_fmac_f32 v120, v207, v208
    v_fmac_f32 v121, v207, v209
    v_fmac_f32 v122, v207, v210
    v_fmac_f32 v123, v207, v211
    v_fmac_f32 v124, v207, v212
    v_fmac_f32 v125, v207, v213
    v_fmac_f32 v126, v207, v214
    v_fmac_f32 v127, v207, v215
    ds_read_b128 v[200:203], v7 offset:5120
    ds_read_b128 v[204:207], v7 offset:5136
    v_lshlrev_b32 v208, 16, v148
    v_and_b32 v209, 0xffff0000, v148
    v_lshlrev_b32 v210, 16, v149
    v_and_b32 v211, 0xffff0000, v149
    v_lshlrev_b32 v212, 16, v150
    v_and_b32 v213, 0xffff0000, v150
    v_lshlrev_b32 v214, 16, v151
    v_and_b32 v215, 0xffff0000, v151
    s_waitcnt lgkmcnt(0)
    v_fmac_f32 v64, v200, v208
    v_fmac_f32 v65, v200, v209
    v_fmac_f32 v66, v200, v210
    v_fmac_f32 v67, v200, v211
    v_fmac_f32 v68, v200, v212
    v_fmac_f32 v69, v200, v213
    v_fmac_f32 v70, v200, v214
    v_fmac_f32 v71, v200, v215
    v_fmac_f32 v72, v201, v208
    v_fmac_f32 v73, v201, v209
    v_fmac_f32 v74, v201, v210
    v_fmac_f32 v75, v201, v211
    v_fmac_f32 v76, v201, v212
    v_fmac_f32 v77, v201, v213
    v_fmac_f32 v78, v201, v214
    v_fmac_f32 v79, v201, v215
    v_fmac_f32 v80, v202, v208
    v_fmac_f32 v81, v202, v209
    v_fmac_f32 v82, v202, v210
    v_fmac_f32 v83, v202, v211
    v_fmac_f32 v84, v202, v212
    v_fmac_f32 v85, v202, v213
    v_fmac_f32 v86, v202, v214
    v_fmac_f32 v87, v202, v215
    v_fmac_f32 v88, v203, v208
    v_fmac_f32 v89, v203, v209
    v_fmac_f32 v90, v203, v210
    v_fmac_f32 v91, v203, v211
    v_fmac_f32 v92, v203, v212
    v_fmac_f32 v93, v203, v213
    v_fmac_f32 v94, v203, v214
    v_fmac_f32 v95, v203, v215
    v_fmac_f32 v96, v204, v208
    v_fmac_f32 v97, v204, v209
    v_fmac_f32 v98, v204, v210
    v_fmac_f32 v99, v204, v211
    v_fmac_f32 v100, v204, v212
    v_fmac_f32 v101, v204, v213
    v_fmac_f32 v102, v204, v214
    v_fmac_f32 v103, v204, v215
    v_fmac_f32 v104, v205, v208
    v_fmac_f32 v105, v205, v209
    v_fmac_f32 v106, v205, v210
    v_fmac_f32 v107, v205, v211
    v_fmac_f32 v108, v205, v212
    v_fmac_f32 v109, v205, v213
    v_fmac_f32 v110, v205, v214
    v_fmac_f32 v111, v205, v215
    v_fmac_f32 v112, v206, v208
    v_fmac_f32 v113, v206, v209
    v_fmac_f32 v114, v206, v210
    v_fmac_f32 v115, v206, v211
    v_fmac_f32 v116, v206, v212
    v_fmac_f32 v117, v206, v213
    v_fmac_f32 v118, v206, v214
    v_fmac_f32 v119, v206, v215
    v_fmac_f32 v120, v207, v208
    v_fmac_f32 v121, v207, v209
    v_fmac_f32 v122, v207, v210
    v_fmac_f32 v123, v207, v211
    v_fmac_f32 v124, v207, v212
    v_fmac_f32 v125, v207, v213
    v_fmac_f32 v126, v207, v214
    v_fmac_f32 v127, v207, v215
    ds_read_b128 v[200:203], v7 offset:6144
    ds_read_b128 v[204:207], v7 offset:6160
    v_lshlrev_b32 v208, 16, v152
    v_and_b32 v209, 0xffff0000, v152
    v_lshlrev_b32 v210, 16, v153
    v_and_b32 v211, 0xffff0000, v153
    v_lshlrev_b32 v212, 16, v154
    v_and_b32 v213, 0xffff0000, v154
    v_lshlrev_b32 v214, 16, v155
    v_and_b32 v215, 0xffff0000, v155
    s_waitcnt lgkmcnt(0)
    v_fmac_f32 v64, v200, v208
    v_fmac_f32 v65, v200, v209
    v_fmac_f32 v66, v200, v210
    v_fmac_f32 v67, v200, v211
    v_fmac_f32 v68, v200, v212
    v_fmac_f32 v69, v200, v213
    v_fmac_f32 v70, v200, v214
    v_fmac_f32 v71, v200, v215
    v_fmac_f32 v72, v201, v208
    v_fmac_f32 v73, v201, v209
    v_fmac_f32 v74, v201, v210
    v_fmac_f32 v75, v201, v211
    v_fmac_f32 v76, v201, v212
    v_fmac_f32 v77, v201, v213
    v_fmac_f32 v78, v201, v214
    v_fmac_f32 v79, v201, v215
    v_fmac_f32 v80, v202, v208
    v_fmac_f32 v81, v202, v209
    v_fmac_f32 v82, v202, v210
    v_fmac_f32 v83, v202, v211
    v_fmac_f32 v84, v202, v212
    v_fmac_f32 v85, v202, v213
    v_fmac_f32 v86, v202, v214
    v_fmac_f32 v87, v202, v215
    v_fmac_f32 v88, v203, v208
    v_fmac_f32 v89, v203, v209
    v_fmac_f32 v90, v203, v210
    v_fmac_f32 v91, v203, v211
    v_fmac_f32 v92, v203, v212
    v_fmac_f32 v93, v203, v213
    v_fmac_f32 v94, v203, v214
    v_fmac_f32 v95, v203, v215
    v_fmac_f32 v96, v204, v208
    v_fmac_f32 v97, v204, v209
    v_fmac_f32 v98, v204, v210
    v_fmac_f32 v99, v204, v211
    v_fmac_f32 v100, v204, v212
    v_fmac_f32 v101, v204, v213
    v_fmac_f32 v102, v204, v214
    v_fmac_f32 v103, v204, v215
    v_fmac_f32 v104, v205, v208
    v_fmac_f32 v105, v205, v209
    v_fmac_f32 v106, v205, v210
    v_fmac_f32 v107, v205, v211
    v_fmac_f32 v108, v205, v212
    v_fmac_f32 v109, v205, v213
    v_fmac_f32 v110, v205, v214
    v_fmac_f32 v111, v205, v215
    v_fmac_f32 v112, v206, v208
    v_fmac_f32 v113, v206, v209
    v_fmac_f32 v114, v206, v210
    v_fmac_f32 v115, v206, v211
    v_fmac_f32 v116, v206, v212
    v_fmac_f32 v117, v206, v213
    v_fmac_f32 v118, v206, v214
    v_fmac_f32 v119, v206, v215
    v_fmac_f32 v120, v207, v208
    v_fmac_f32 v121, v207, v209
    v_fmac_f32 v122, v207, v210
    v_fmac_f32 v123, v207, v211
    v_fmac_f32 v124, v207, v212
    v_fmac_f32 v125, v207, v213
    v_fmac_f32 v126, v207, v214
    v_fmac_f32 v127, v207, v215
    ds_read_b128 v[200:203], v7 offset:7168
    ds_read_b128 v[204:207], v7 offset:7184
    v_lshlrev_b32 v208, 16, v156
    v_and_b32 v209, 0xffff0000, v156
    v_lshlrev_b32 v210, 16, v157
    v_and_b32 v211, 0xffff0000, v157
    v_lshlrev_b32 v212, 16, v158
    v_and_b32 v213, 0xffff0000, v158
    v_lshlrev_b32 v214, 16, v159
    v_and_b32 v215, 0xffff0000, v159
    s_waitcnt lgkmcnt(0)
    v_fmac_f32 v64, v200, v208
    v_fmac_f32 v65, v200, v209
    v_fmac_f32 v66, v200, v210
    v_fmac_f32 v67, v200, v211
    v_fmac_f32 v68, v200, v212
    v_fmac_f32 v69, v200, v213
    v_fmac_f32 v70, v200, v214
    v_fmac_f32 v71, v200, v215
    v_fmac_f32 v72, v201, v208
    v_fmac_f32 v73, v201, v209
    v_fmac_f32 v74, v201, v210
    v_fmac_f32 v75, v201, v211
    v_fmac_f32 v76, v201, v212
    v_fmac_f32 v77, v201, v213
    v_fmac_f32 v78, v201, v214
    v_fmac_f32 v79, v201, v215
    v_fmac_f32 v80, v202, v208
    v_fmac_f32 v81, v202, v209
    v_fmac_f32 v82, v202, v210
    v_fmac_f32 v83, v202, v211
    v_fmac_f32 v84, v202, v212
    v_fmac_f32 v85, v202, v213
    v_fmac_f32 v86, v202, v214
    v_fmac_f32 v87, v202, v215
    v_fmac_f32 v88, v203, v208
    v_fmac_f32 v89, v203, v209
    v_fmac_f32 v90, v203, v210
    v_fmac_f32 v91, v203, v211
    v_fmac_f32 v92, v203, v212
    v_fmac_f32 v93, v203, v213
    v_fmac_f32 v94, v203, v214
    v_fmac_f32 v95, v203, v215
    v_fmac_f32 v96, v204, v208
    v_fmac_f32 v97, v204, v209
    v_fmac_f32 v98, v204, v210
    v_fmac_f32 v99, v204, v211
    v_fmac_f32 v100, v204, v212
    v_fmac_f32 v101, v204, v213
    v_fmac_f32 v102, v204, v214
    v_fmac_f32 v103, v204, v215
    v_fmac_f32 v104, v205, v208
    v_fmac_f32 v105, v205, v209
    v_fmac_f32 v106, v205, v210
    v_fmac_f32 v107, v205, v211
    v_fmac_f32 v108, v205, v212
    v_fmac_f32 v109, v205, v213
    v_fmac_f32 v110, v205, v214
    v_fmac_f32 v111, v205, v215
    v_fmac_f32 v112, v206, v208
    v_fmac_f32 v113, v206, v209
    v_fmac_f32 v114, v206, v210
    v_fmac_f32 v115, v206, v211
    v_fmac_f32 v116, v206, v212
    v_fmac_f32 v117, v206, v213
    v_fmac_f32 v118, v206, v214
    v_fmac_f32 v119, v206, v215
    v_fmac_f32 v120, v207, v208
    v_fmac_f32 v121, v207, v209
    v_fmac_f32 v122, v207, v210
    v_fmac_f32 v123, v207, v211
    v_fmac_f32 v124, v207, v212
    v_fmac_f32 v125, v207, v213
    v_fmac_f32 v126, v207, v214
    v_fmac_f32 v127, v207, v215
    ds_read_b128 v[200:203], v7 offset:8192
    ds_read_b128 v[204:207], v7 offset:8208
    v_lshlrev_b32 v208, 16, v160
    v_and_b32 v209, 0xffff0000, v160
    v_lshlrev_b32 v210, 16, v161
    v_and_b32 v211, 0xffff0000, v161
    v_lshlrev_b32 v212, 16, v162
    v_and_b32 v213, 0xffff0000, v162
    v_lshlrev_b32 v214, 16, v163
    v_and_b32 v215, 0xffff0000, v163
    s_waitcnt lgkmcnt(0)
    v_fmac_f32 v64, v200, v208
    v_fmac_f32 v65, v200, v209
    v_fmac_f32 v66, v200, v210
    v_fmac_f32 v67, v200, v211
    v_fmac_f32 v68, v200, v212
    v_fmac_f32 v69, v200, v213
    v_fmac_f32 v70, v200, v214
    v_fmac_f32 v71, v200, v215
    v_fmac_f32 v72, v201, v208
    v_fmac_f32 v73, v201, v209
    v_fmac_f32 v74, v201, v210
    v_fmac_f32 v75, v201, v211
    v_fmac_f32 v76, v201, v212
    v_fmac_f32 v77, v201, v213
    v_fmac_f32 v78, v201, v214
    v_fmac_f32 v79, v201, v215
    v_fmac_f32 v80, v202, v208
    v_fmac_f32 v81, v202, v209
    v_fmac_f32 v82, v202, v210
    v_fmac_f32 v83, v202, v211
    v_fmac_f32 v84, v202, v212
    v_fmac_f32 v85, v202, v213
    v_fmac_f32 v86, v202, v214
    v_fmac_f32 v87, v202, v215
    v_fmac_f32 v88, v203, v208
    v_fmac_f32 v89, v203, v209
    v_fmac_f32 v90, v203, v210
    v_fmac_f32 v91, v203, v211
    v_fmac_f32 v92, v203, v212
    v_fmac_f32 v93, v203, v213
    v_fmac_f32 v94, v203, v214
    v_fmac_f32 v95, v203, v215
    v_fmac_f32 v96, v204, v208
    v_fmac_f32 v97, v204, v209
    v_fmac_f32 v98, v204, v210
    v_fmac_f32 v99, v204, v211
    v_fmac_f32 v100, v204, v212
    v_fmac_f32 v101, v204, v213
    v_fmac_f32 v102, v204, v214
    v_fmac_f32 v103, v204, v215
    v_fmac_f32 v104, v205, v208
    v_fmac_f32 v105, v205, v209
    v_fmac_f32 v106, v205, v210
    v_fmac_f32 v107, v205, v211
    v_fmac_f32 v108, v205, v212
    v_fmac_f32 v109, v205, v213
    v_fmac_f32 v110, v205, v214
    v_fmac_f32 v111, v205, v215
    v_fmac_f32 v112, v206, v208
    v_fmac_f32 v113, v206, v209
    v_fmac_f32 v114, v206, v210
    v_fmac_f32 v115, v206, v211
    v_fmac_f32 v116, v206, v212
    v_fmac_f32 v117, v206, v213
    v_fmac_f32 v118, v206, v214
    v_fmac_f32 v119, v206, v215
    v_fmac_f32 v120, v207, v208
    v_fmac_f32 v121, v207, v209
    v_fmac_f32 v122, v207, v210
    v_fmac_f32 v123, v207, v211
    v_fmac_f32 v124, v207, v212
    v_fmac_f32 v125, v207, v213
    v_fmac_f32 v126, v207, v214
    v_fmac_f32 v127, v207, v215
    ds_read_b128 v[200:203], v7 offset:9216
    ds_read_b128 v[204:207], v7 offset:9232
    v_lshlrev_b32 v208, 16, v164
    v_and_b32 v209, 0xffff0000, v164
    v_lshlrev_b32 v210, 16, v165
    v_and_b32 v211, 0xffff0000, v165
    v_lshlrev_b32 v212, 16, v166
    v_and_b32 v213, 0xffff0000, v166
    v_lshlrev_b32 v214, 16, v167
    v_and_b32 v215, 0xffff0000, v167
    s_waitcnt lgkmcnt(0)
    v_fmac_f32 v64, v200, v208
    v_fmac_f32 v65, v200, v209
    v_fmac_f32 v66, v200, v210
    v_fmac_f32 v67, v200, v211
    v_fmac_f32 v68, v200, v212
    v_fmac_f32 v69, v200, v213
    v_fmac_f32 v70, v200, v214
    v_fmac_f32 v71, v200, v215
    v_fmac_f32 v72, v201, v208
    v_fmac_f32 v73, v201, v209
    v_fmac_f32 v74, v201, v210
    v_fmac_f32 v75, v201, v211
    v_fmac_f32 v76, v201, v212
    v_fmac_f32 v77, v201, v213
    v_fmac_f32 v78, v201, v214
    v_fmac_f32 v79, v201, v215
    v_fmac_f32 v80, v202, v208
    v_fmac_f32 v81, v202, v209
    v_fmac_f32 v82, v202, v210
    v_fmac_f32 v83, v202, v211
    v_fmac_f32 v84, v202, v212
    v_fmac_f32 v85, v202, v213
    v_fmac_f32 v86, v202, v214
    v_fmac_f32 v87, v202, v215
    v_fmac_f32 v88, v203, v208
    v_fmac_f32 v89, v203, v209
    v_fmac_f32 v90, v203, v210
    v_fmac_f32 v91, v203, v211
    v_fmac_f32 v92, v203, v212
    v_fmac_f32 v93, v203, v213
    v_fmac_f32 v94, v203, v214
    v_fmac_f32 v95, v203, v215
    v_fmac_f32 v96, v204, v208
    v_fmac_f32 v97, v204, v209
    v_fmac_f32 v98, v204, v210
    v_fmac_f32 v99, v204, v211
    v_fmac_f32 v100, v204, v212
    v_fmac_f32 v101, v204, v213
    v_fmac_f32 v102, v204, v214
    v_fmac_f32 v103, v204, v215
    v_fmac_f32 v104, v205, v208
    v_fmac_f32 v105, v205, v209
    v_fmac_f32 v106, v205, v210
    v_fmac_f32 v107, v205, v211
    v_fmac_f32 v108, v205, v212
    v_fmac_f32 v109, v205, v213
    v_fmac_f32 v110, v205, v214
    v_fmac_f32 v111, v205, v215
    v_fmac_f32 v112, v206, v208
    v_fmac_f32 v113, v206, v209
    v_fmac_f32 v114, v206, v210
    v_fmac_f32 v115, v206, v211
    v_fmac_f32 v116, v206, v212
    v_fmac_f32 v117, v206, v213
    v_fmac_f32 v118, v206, v214
    v_fmac_f32 v119, v206, v215
    v_fmac_f32 v120, v207, v208
    v_fmac_f32 v121, v207, v209
    v_fmac_f32 v122, v207, v210
    v_fmac_f32 v123, v207, v211
    v_fmac_f32 v124, v207, v212
    v_fmac_f32 v125, v207, v213
    v_fmac_f32 v126, v207, v214
    v_fmac_f32 v127, v207, v215
    ds_read_b128 v[200:203], v7 offset:10240
    ds_read_b128 v[204:207], v7 offset:10256
    v_lshlrev_b32 v208, 16, v168
    v_and_b32 v209, 0xffff0000, v168
    v_lshlrev_b32 v210, 16, v169
    v_and_b32 v211, 0xffff0000, v169
    v_lshlrev_b32 v212, 16, v170
    v_and_b32 v213, 0xffff0000, v170
    v_lshlrev_b32 v214, 16, v171
    v_and_b32 v215, 0xffff0000, v171
    s_waitcnt lgkmcnt(0)
    v_fmac_f32 v64, v200, v208
    v_fmac_f32 v65, v200, v209
    v_fmac_f32 v66, v200, v210
    v_fmac_f32 v67, v200, v211
    v_fmac_f32 v68, v200, v212
    v_fmac_f32 v69, v200, v213
    v_fmac_f32 v70, v200, v214
    v_fmac_f32 v71, v200, v215
    v_fmac_f32 v72, v201, v208
    v_fmac_f32 v73, v201, v209
    v_fmac_f32 v74, v201, v210
    v_fmac_f32 v75, v201, v211
    v_fmac_f32 v76, v201, v212
    v_fmac_f32 v77, v201, v213
    v_fmac_f32 v78, v201, v214
    v_fmac_f32 v79, v201, v215
    v_fmac_f32 v80, v202, v208
    v_fmac_f32 v81, v202, v209
    v_fmac_f32 v82, v202, v210
    v_fmac_f32 v83, v202, v211
    v_fmac_f32 v84, v202, v212
    v_fmac_f32 v85, v202, v213
    v_fmac_f32 v86, v202, v214
    v_fmac_f32 v87, v202, v215
    v_fmac_f32 v88, v203, v208
    v_fmac_f32 v89, v203, v209
    v_fmac_f32 v90, v203, v210
    v_fmac_f32 v91, v203, v211
    v_fmac_f32 v92, v203, v212
    v_fmac_f32 v93, v203, v213
    v_fmac_f32 v94, v203, v214
    v_fmac_f32 v95, v203, v215
    v_fmac_f32 v96, v204, v208
    v_fmac_f32 v97, v204, v209
    v_fmac_f32 v98, v204, v210
    v_fmac_f32 v99, v204, v211
    v_fmac_f32 v100, v204, v212
    v_fmac_f32 v101, v204, v213
    v_fmac_f32 v102, v204, v214
    v_fmac_f32 v103, v204, v215
    v_fmac_f32 v104, v205, v208
    v_fmac_f32 v105, v205, v209
    v_fmac_f32 v106, v205, v210
    v_fmac_f32 v107, v205, v211
    v_fmac_f32 v108, v205, v212
    v_fmac_f32 v109, v205, v213
    v_fmac_f32 v110, v205, v214
    v_fmac_f32 v111, v205, v215
    v_fmac_f32 v112, v206, v208
    v_fmac_f32 v113, v206, v209
    v_fmac_f32 v114, v206, v210
    v_fmac_f32 v115, v206, v211
    v_fmac_f32 v116, v206, v212
    v_fmac_f32 v117, v206, v213
    v_fmac_f32 v118, v206, v214
    v_fmac_f32 v119, v206, v215
    v_fmac_f32 v120, v207, v208
    v_fmac_f32 v121, v207, v209
    v_fmac_f32 v122, v207, v210
    v_fmac_f32 v123, v207, v211
    v_fmac_f32 v124, v207, v212
    v_fmac_f32 v125, v207, v213
    v_fmac_f32 v126, v207, v214
    v_fmac_f32 v127, v207, v215
    ds_read_b128 v[200:203], v7 offset:11264
    ds_read_b128 v[204:207], v7 offset:11280
    v_lshlrev_b32 v208, 16, v172
    v_and_b32 v209, 0xffff0000, v172
    v_lshlrev_b32 v210, 16, v173
    v_and_b32 v211, 0xffff0000, v173
    v_lshlrev_b32 v212, 16, v174
    v_and_b32 v213, 0xffff0000, v174
    v_lshlrev_b32 v214, 16, v175
    v_and_b32 v215, 0xffff0000, v175
    s_waitcnt lgkmcnt(0)
    v_fmac_f32 v64, v200, v208
    v_fmac_f32 v65, v200, v209
    v_fmac_f32 v66, v200, v210
    v_fmac_f32 v67, v200, v211
    v_fmac_f32 v68, v200, v212
    v_fmac_f32 v69, v200, v213
    v_fmac_f32 v70, v200, v214
    v_fmac_f32 v71, v200, v215
    v_fmac_f32 v72, v201, v208
    v_fmac_f32 v73, v201, v209
    v_fmac_f32 v74, v201, v210
    v_fmac_f32 v75, v201, v211
    v_fmac_f32 v76, v201, v212
    v_fmac_f32 v77, v201, v213
    v_fmac_f32 v78, v201, v214
    v_fmac_f32 v79, v201, v215
    v_fmac_f32 v80, v202, v208
    v_fmac_f32 v81, v202, v209
    v_fmac_f32 v82, v202, v210
    v_fmac_f32 v83, v202, v211
    v_fmac_f32 v84, v202, v212
    v_fmac_f32 v85, v202, v213
    v_fmac_f32 v86, v202, v214
    v_fmac_f32 v87, v202, v215
    v_fmac_f32 v88, v203, v208
    v_fmac_f32 v89, v203, v209
    v_fmac_f32 v90, v203, v210
    v_fmac_f32 v91, v203, v211
    v_fmac_f32 v92, v203, v212
    v_fmac_f32 v93, v203, v213
    v_fmac_f32 v94, v203, v214
    v_fmac_f32 v95, v203, v215
    v_fmac_f32 v96, v204, v208
    v_fmac_f32 v97, v204, v209
    v_fmac_f32 v98, v204, v210
    v_fmac_f32 v99, v204, v211
    v_fmac_f32 v100, v204, v212
    v_fmac_f32 v101, v204, v213
    v_fmac_f32 v102, v204, v214
    v_fmac_f32 v103, v204, v215
    v_fmac_f32 v104, v205, v208
    v_fmac_f32 v105, v205, v209
    v_fmac_f32 v106, v205, v210
    v_fmac_f32 v107, v205, v211
    v_fmac_f32 v108, v205, v212
    v_fmac_f32 v109, v205, v213
    v_fmac_f32 v110, v205, v214
    v_fmac_f32 v111, v205, v215
    v_fmac_f32 v112, v206, v208
    v_fmac_f32 v113, v206, v209
    v_fmac_f32 v114, v206, v210
    v_fmac_f32 v115, v206, v211
    v_fmac_f32 v116, v206, v212
    v_fmac_f32 v117, v206, v213
    v_fmac_f32 v118, v206, v214
    v_fmac_f32 v119, v206, v215
    v_fmac_f32 v120, v207, v208
    v_fmac_f32 v121, v207, v209
    v_fmac_f32 v122, v207, v210
    v_fmac_f32 v123, v207, v211
    v_fmac_f32 v124, v207, v212
    v_fmac_f32 v125, v207, v213
    v_fmac_f32 v126, v207, v214
    v_fmac_f32 v127, v207, v215
    ds_read_b128 v[200:203], v7 offset:12288
    ds_read_b128 v[204:207], v7 offset:12304
    v_lshlrev_b32 v208, 16, v176
    v_and_b32 v209, 0xffff0000, v176
    v_lshlrev_b32 v210, 16, v177
    v_and_b32 v211, 0xffff0000, v177
    v_lshlrev_b32 v212, 16, v178
    v_and_b32 v213, 0xffff0000, v178
    v_lshlrev_b32 v214, 16, v179
    v_and_b32 v215, 0xffff0000, v179
    s_waitcnt lgkmcnt(0)
    v_fmac_f32 v64, v200, v208
    v_fmac_f32 v65, v200, v209
    v_fmac_f32 v66, v200, v210
    v_fmac_f32 v67, v200, v211
    v_fmac_f32 v68, v200, v212
    v_fmac_f32 v69, v200, v213
    v_fmac_f32 v70, v200, v214
    v_fmac_f32 v71, v200, v215
    v_fmac_f32 v72, v201, v208
    v_fmac_f32 v73, v201, v209
    v_fmac_f32 v74, v201, v210
    v_fmac_f32 v75, v201, v211
    v_fmac_f32 v76, v201, v212
    v_fmac_f32 v77, v201, v213
    v_fmac_f32 v78, v201, v214
    v_fmac_f32 v79, v201, v215
    v_fmac_f32 v80, v202, v208
    v_fmac_f32 v81, v202, v209
    v_fmac_f32 v82, v202, v210
    v_fmac_f32 v83, v202, v211
    v_fmac_f32 v84, v202, v212
    v_fmac_f32 v85, v202, v213
    v_fmac_f32 v86, v202, v214
    v_fmac_f32 v87, v202, v215
    v_fmac_f32 v88, v203, v208
    v_fmac_f32 v89, v203, v209
    v_fmac_f32 v90, v203, v210
    v_fmac_f32 v91, v203, v211
    v_fmac_f32 v92, v203, v212
    v_fmac_f32 v93, v203, v213
    v_fmac_f32 v94, v203, v214
    v_fmac_f32 v95, v203, v215
    v_fmac_f32 v96, v204, v208
    v_fmac_f32 v97, v204, v209
    v_fmac_f32 v98, v204, v210
    v_fmac_f32 v99, v204, v211
    v_fmac_f32 v100, v204, v212
    v_fmac_f32 v101, v204, v213
    v_fmac_f32 v102, v204, v214
    v_fmac_f32 v103, v204, v215
    v_fmac_f32 v104, v205, v208
    v_fmac_f32 v105, v205, v209
    v_fmac_f32 v106, v205, v210
    v_fmac_f32 v107, v205, v211
    v_fmac_f32 v108, v205, v212
    v_fmac_f32 v109, v205, v213
    v_fmac_f32 v110, v205, v214
    v_fmac_f32 v111, v205, v215
    v_fmac_f32 v112, v206, v208
    v_fmac_f32 v113, v206, v209
    v_fmac_f32 v114, v206, v210
    v_fmac_f32 v115, v206, v211
    v_fmac_f32 v116, v206, v212
    v_fmac_f32 v117, v206, v213
    v_fmac_f32 v118, v206, v214
    v_fmac_f32 v119, v206, v215
    v_fmac_f32 v120, v207, v208
    v_fmac_f32 v121, v207, v209
    v_fmac_f32 v122, v207, v210
    v_fmac_f32 v123, v207, v211
    v_fmac_f32 v124, v207, v212
    v_fmac_f32 v125, v207, v213
    v_fmac_f32 v126, v207, v214
    v_fmac_f32 v127, v207, v215
    ds_read_b128 v[200:203], v7 offset:13312
    ds_read_b128 v[204:207], v7 offset:13328
    v_lshlrev_b32 v208, 16, v180
    v_and_b32 v209, 0xffff0000, v180
    v_lshlrev_b32 v210, 16, v181
    v_and_b32 v211, 0xffff0000, v181
    v_lshlrev_b32 v212, 16, v182
    v_and_b32 v213, 0xffff0000, v182
    v_lshlrev_b32 v214, 16, v183
    v_and_b32 v215, 0xffff0000, v183
    s_waitcnt lgkmcnt(0)
    v_fmac_f32 v64, v200, v208
    v_fmac_f32 v65, v200, v209
    v_fmac_f32 v66, v200, v210
    v_fmac_f32 v67, v200, v211
    v_fmac_f32 v68, v200, v212
    v_fmac_f32 v69, v200, v213
    v_fmac_f32 v70, v200, v214
    v_fmac_f32 v71, v200, v215
    v_fmac_f32 v72, v201, v208
    v_fmac_f32 v73, v201, v209
    v_fmac_f32 v74, v201, v210
    v_fmac_f32 v75, v201, v211
    v_fmac_f32 v76, v201, v212
    v_fmac_f32 v77, v201, v213
    v_fmac_f32 v78, v201, v214
    v_fmac_f32 v79, v201, v215
    v_fmac_f32 v80, v202, v208
    v_fmac_f32 v81, v202, v209
    v_fmac_f32 v82, v202, v210
    v_fmac_f32 v83, v202, v211
    v_fmac_f32 v84, v202, v212
    v_fmac_f32 v85, v202, v213
    v_fmac_f32 v86, v202, v214
    v_fmac_f32 v87, v202, v215
    v_fmac_f32 v88, v203, v208
    v_fmac_f32 v89, v203, v209
    v_fmac_f32 v90, v203, v210
    v_fmac_f32 v91, v203, v211
    v_fmac_f32 v92, v203, v212
    v_fmac_f32 v93, v203, v213
    v_fmac_f32 v94, v203, v214
    v_fmac_f32 v95, v203, v215
    v_fmac_f32 v96, v204, v208
    v_fmac_f32 v97, v204, v209
    v_fmac_f32 v98, v204, v210
    v_fmac_f32 v99, v204, v211
    v_fmac_f32 v100, v204, v212
    v_fmac_f32 v101, v204, v213
    v_fmac_f32 v102, v204, v214
    v_fmac_f32 v103, v204, v215
    v_fmac_f32 v104, v205, v208
    v_fmac_f32 v105, v205, v209
    v_fmac_f32 v106, v205, v210
    v_fmac_f32 v107, v205, v211
    v_fmac_f32 v108, v205, v212
    v_fmac_f32 v109, v205, v213
    v_fmac_f32 v110, v205, v214
    v_fmac_f32 v111, v205, v215
    v_fmac_f32 v112, v206, v208
    v_fmac_f32 v113, v206, v209
    v_fmac_f32 v114, v206, v210
    v_fmac_f32 v115, v206, v211
    v_fmac_f32 v116, v206, v212
    v_fmac_f32 v117, v206, v213
    v_fmac_f32 v118, v206, v214
    v_fmac_f32 v119, v206, v215
    v_fmac_f32 v120, v207, v208
    v_fmac_f32 v121, v207, v209
    v_fmac_f32 v122, v207, v210
    v_fmac_f32 v123, v207, v211
    v_fmac_f32 v124, v207, v212
    v_fmac_f32 v125, v207, v213
    v_fmac_f32 v126, v207, v214
    v_fmac_f32 v127, v207, v215
    ds_read_b128 v[200:203], v7 offset:14336
    ds_read_b128 v[204:207], v7 offset:14352
    v_lshlrev_b32 v208, 16, v184
    v_and_b32 v209, 0xffff0000, v184
    v_lshlrev_b32 v210, 16, v185
    v_and_b32 v211, 0xffff0000, v185
    v_lshlrev_b32 v212, 16, v186
    v_and_b32 v213, 0xffff0000, v186
    v_lshlrev_b32 v214, 16, v187
    v_and_b32 v215, 0xffff0000, v187
    s_waitcnt lgkmcnt(0)
    v_fmac_f32 v64, v200, v208
    v_fmac_f32 v65, v200, v209
    v_fmac_f32 v66, v200, v210
    v_fmac_f32 v67, v200, v211
    v_fmac_f32 v68, v200, v212
    v_fmac_f32 v69, v200, v213
    v_fmac_f32 v70, v200, v214
    v_fmac_f32 v71, v200, v215
    v_fmac_f32 v72, v201, v208
    v_fmac_f32 v73, v201, v209
    v_fmac_f32 v74, v201, v210
    v_fmac_f32 v75, v201, v211
    v_fmac_f32 v76, v201, v212
    v_fmac_f32 v77, v201, v213
    v_fmac_f32 v78, v201, v214
    v_fmac_f32 v79, v201, v215
    v_fmac_f32 v80, v202, v208
    v_fmac_f32 v81, v202, v209
    v_fmac_f32 v82, v202, v210
    v_fmac_f32 v83, v202, v211
    v_fmac_f32 v84, v202, v212
    v_fmac_f32 v85, v202, v213
    v_fmac_f32 v86, v202, v214
    v_fmac_f32 v87, v202, v215
    v_fmac_f32 v88, v203, v208
    v_fmac_f32 v89, v203, v209
    v_fmac_f32 v90, v203, v210
    v_fmac_f32 v91, v203, v211
    v_fmac_f32 v92, v203, v212
    v_fmac_f32 v93, v203, v213
    v_fmac_f32 v94, v203, v214
    v_fmac_f32 v95, v203, v215
    v_fmac_f32 v96, v204, v208
    v_fmac_f32 v97, v204, v209
    v_fmac_f32 v98, v204, v210
    v_fmac_f32 v99, v204, v211
    v_fmac_f32 v100, v204, v212
    v_fmac_f32 v101, v204, v213
    v_fmac_f32 v102, v204, v214
    v_fmac_f32 v103, v204, v215
    v_fmac_f32 v104, v205, v208
    v_fmac_f32 v105, v205, v209
    v_fmac_f32 v106, v205, v210
    v_fmac_f32 v107, v205, v211
    v_fmac_f32 v108, v205, v212
    v_fmac_f32 v109, v205, v213
    v_fmac_f32 v110, v205, v214
    v_fmac_f32 v111, v205, v215
    v_fmac_f32 v112, v206, v208
    v_fmac_f32 v113, v206, v209
    v_fmac_f32 v114, v206, v210
    v_fmac_f32 v115, v206, v211
    v_fmac_f32 v116, v206, v212
    v_fmac_f32 v117, v206, v213
    v_fmac_f32 v118, v206, v214
    v_fmac_f32 v119, v206, v215
    v_fmac_f32 v120, v207, v208
    v_fmac_f32 v121, v207, v209
    v_fmac_f32 v122, v207, v210
    v_fmac_f32 v123, v207, v211
    v_fmac_f32 v124, v207, v212
    v_fmac_f32 v125, v207, v213
    v_fmac_f32 v126, v207, v214
    v_fmac_f32 v127, v207, v215
    ds_read_b128 v[200:203], v7 offset:15360
    ds_read_b128 v[204:207], v7 offset:15376
    v_lshlrev_b32 v208, 16, v188
    v_and_b32 v209, 0xffff0000, v188
    v_lshlrev_b32 v210, 16, v189
    v_and_b32 v211, 0xffff0000, v189
    v_lshlrev_b32 v212, 16, v190
    v_and_b32 v213, 0xffff0000, v190
    v_lshlrev_b32 v214, 16, v191
    v_and_b32 v215, 0xffff0000, v191
    s_waitcnt lgkmcnt(0)
    v_fmac_f32 v64, v200, v208
    v_fmac_f32 v65, v200, v209
    v_fmac_f32 v66, v200, v210
    v_fmac_f32 v67, v200, v211
    v_fmac_f32 v68, v200, v212
    v_fmac_f32 v69, v200, v213
    v_fmac_f32 v70, v200, v214
    v_fmac_f32 v71, v200, v215
    v_fmac_f32 v72, v201, v208
    v_fmac_f32 v73, v201, v209
    v_fmac_f32 v74, v201, v210
    v_fmac_f32 v75, v201, v211
    v_fmac_f32 v76, v201, v212
    v_fmac_f32 v77, v201, v213
    v_fmac_f32 v78, v201, v214
    v_fmac_f32 v79, v201, v215
    v_fmac_f32 v80, v202, v208
    v_fmac_f32 v81, v202, v209
    v_fmac_f32 v82, v202, v210
    v_fmac_f32 v83, v202, v211
    v_fmac_f32 v84, v202, v212
    v_fmac_f32 v85, v202, v213
    v_fmac_f32 v86, v202, v214
    v_fmac_f32 v87, v202, v215
    v_fmac_f32 v88, v203, v208
    v_fmac_f32 v89, v203, v209
    v_fmac_f32 v90, v203, v210
    v_fmac_f32 v91, v203, v211
    v_fmac_f32 v92, v203, v212
    v_fmac_f32 v93, v203, v213
    v_fmac_f32 v94, v203, v214
    v_fmac_f32 v95, v203, v215
    v_fmac_f32 v96, v204, v208
    v_fmac_f32 v97, v204, v209
    v_fmac_f32 v98, v204, v210
    v_fmac_f32 v99, v204, v211
    v_fmac_f32 v100, v204, v212
    v_fmac_f32 v101, v204, v213
    v_fmac_f32 v102, v204, v214
    v_fmac_f32 v103, v204, v215
    v_fmac_f32 v104, v205, v208
    v_fmac_f32 v105, v205, v209
    v_fmac_f32 v106, v205, v210
    v_fmac_f32 v107, v205, v211
    v_fmac_f32 v108, v205, v212
    v_fmac_f32 v109, v205, v213
    v_fmac_f32 v110, v205, v214
    v_fmac_f32 v111, v205, v215
    v_fmac_f32 v112, v206, v208
    v_fmac_f32 v113, v206, v209
    v_fmac_f32 v114, v206, v210
    v_fmac_f32 v115, v206, v211
    v_fmac_f32 v116, v206, v212
    v_fmac_f32 v117, v206, v213
    v_fmac_f32 v118, v206, v214
    v_fmac_f32 v119, v206, v215
    v_fmac_f32 v120, v207, v208
    v_fmac_f32 v121, v207, v209
    v_fmac_f32 v122, v207, v210
    v_fmac_f32 v123, v207, v211
    v_fmac_f32 v124, v207, v212
    v_fmac_f32 v125, v207, v213
    v_fmac_f32 v126, v207, v214
    v_fmac_f32 v127, v207, v215
    ds_read_b128 v[200:203], v7 offset:16384
    ds_read_b128 v[204:207], v7 offset:16400
    v_lshlrev_b32 v208, 16, v192
    v_and_b32 v209, 0xffff0000, v192
    v_lshlrev_b32 v210, 16, v193
    v_and_b32 v211, 0xffff0000, v193
    v_lshlrev_b32 v212, 16, v194
    v_and_b32 v213, 0xffff0000, v194
    v_lshlrev_b32 v214, 16, v195
    v_and_b32 v215, 0xffff0000, v195
    s_waitcnt lgkmcnt(0)
    v_fmac_f32 v64, v200, v208
    v_fmac_f32 v65, v200, v209
    v_fmac_f32 v66, v200, v210
    v_fmac_f32 v67, v200, v211
    v_fmac_f32 v68, v200, v212
    v_fmac_f32 v69, v200, v213
    v_fmac_f32 v70, v200, v214
    v_fmac_f32 v71, v200, v215
    v_fmac_f32 v72, v201, v208
    v_fmac_f32 v73, v201, v209
    v_fmac_f32 v74, v201, v210
    v_fmac_f32 v75, v201, v211
    v_fmac_f32 v76, v201, v212
    v_fmac_f32 v77, v201, v213
    v_fmac_f32 v78, v201, v214
    v_fmac_f32 v79, v201, v215
    v_fmac_f32 v80, v202, v208
    v_fmac_f32 v81, v202, v209
    v_fmac_f32 v82, v202, v210
    v_fmac_f32 v83, v202, v211
    v_fmac_f32 v84, v202, v212
    v_fmac_f32 v85, v202, v213
    v_fmac_f32 v86, v202, v214
    v_fmac_f32 v87, v202, v215
    v_fmac_f32 v88, v203, v208
    v_fmac_f32 v89, v203, v209
    v_fmac_f32 v90, v203, v210
    v_fmac_f32 v91, v203, v211
    v_fmac_f32 v92, v203, v212
    v_fmac_f32 v93, v203, v213
    v_fmac_f32 v94, v203, v214
    v_fmac_f32 v95, v203, v215
    v_fmac_f32 v96, v204, v208
    v_fmac_f32 v97, v204, v209
    v_fmac_f32 v98, v204, v210
    v_fmac_f32 v99, v204, v211
    v_fmac_f32 v100, v204, v212
    v_fmac_f32 v101, v204, v213
    v_fmac_f32 v102, v204, v214
    v_fmac_f32 v103, v204, v215
    v_fmac_f32 v104, v205, v208
    v_fmac_f32 v105, v205, v209
    v_fmac_f32 v106, v205, v210
    v_fmac_f32 v107, v205, v211
    v_fmac_f32 v108, v205, v212
    v_fmac_f32 v109, v205, v213
    v_fmac_f32 v110, v205, v214
    v_fmac_f32 v111, v205, v215
    v_fmac_f32 v112, v206, v208
    v_fmac_f32 v113, v206, v209
    v_fmac_f32 v114, v206, v210
    v_fmac_f32 v115, v206, v211
    v_fmac_f32 v116, v206, v212
    v_fmac_f32 v117, v206, v213
    v_fmac_f32 v118, v206, v214
    v_fmac_f32 v119, v206, v215
    v_fmac_f32 v120, v207, v208
    v_fmac_f32 v121, v207, v209
    v_fmac_f32 v122, v207, v210
    v_fmac_f32 v123, v207, v211
    v_fmac_f32 v124, v207, v212
    v_fmac_f32 v125, v207, v213
    v_fmac_f32 v126, v207, v214
    v_fmac_f32 v127, v207, v215
    ds_read_b128 v[200:203], v7 offset:17408
    ds_read_b128 v[204:207], v7 offset:17424
    v_lshlrev_b32 v208, 16, v196
    v_and_b32 v209, 0xffff0000, v196
    v_lshlrev_b32 v210, 16, v197
    v_and_b32 v211, 0xffff0000, v197
    v_lshlrev_b32 v212, 16, v198
    v_and_b32 v213, 0xffff0000, v198
    v_lshlrev_b32 v214, 16, v199
    v_and_b32 v215, 0xffff0000, v199
    s_waitcnt lgkmcnt(0)
    v_fmac_f32 v64, v200, v208
    v_fmac_f32 v65, v200, v209
    v_fmac_f32 v66, v200, v210
    v_fmac_f32 v67, v200, v211
    v_fmac_f32 v68, v200, v212
    v_fmac_f32 v69, v200, v213
    v_fmac_f32 v70, v200, v214
    v_fmac_f32 v71, v200, v215
    v_fmac_f32 v72, v201, v208
    v_fmac_f32 v73, v201, v209
    v_fmac_f32 v74, v201, v210
    v_fmac_f32 v75, v201, v211
    v_fmac_f32 v76, v201, v212
    v_fmac_f32 v77, v201, v213
    v_fmac_f32 v78, v201, v214
    v_fmac_f32 v79, v201, v215
    v_fmac_f32 v80, v202, v208
    v_fmac_f32 v81, v202, v209
    v_fmac_f32 v82, v202, v210
    v_fmac_f32 v83, v202, v211
    v_fmac_f32 v84, v202, v212
    v_fmac_f32 v85, v202, v213
    v_fmac_f32 v86, v202, v214
    v_fmac_f32 v87, v202, v215
    v_fmac_f32 v88, v203, v208
    v_fmac_f32 v89, v203, v209
    v_fmac_f32 v90, v203, v210
    v_fmac_f32 v91, v203, v211
    v_fmac_f32 v92, v203, v212
    v_fmac_f32 v93, v203, v213
    v_fmac_f32 v94, v203, v214
    v_fmac_f32 v95, v203, v215
    v_fmac_f32 v96, v204, v208
    v_fmac_f32 v97, v204, v209
    v_fmac_f32 v98, v204, v210
    v_fmac_f32 v99, v204, v211
    v_fmac_f32 v100, v204, v212
    v_fmac_f32 v101, v204, v213
    v_fmac_f32 v102, v204, v214
    v_fmac_f32 v103, v204, v215
    v_fmac_f32 v104, v205, v208
    v_fmac_f32 v105, v205, v209
    v_fmac_f32 v106, v205, v210
    v_fmac_f32 v107, v205, v211
    v_fmac_f32 v108, v205, v212
    v_fmac_f32 v109, v205, v213
    v_fmac_f32 v110, v205, v214
    v_fmac_f32 v111, v205, v215
    v_fmac_f32 v112, v206, v208
    v_fmac_f32 v113, v206, v209
    v_fmac_f32 v114, v206, v210
    v_fmac_f32 v115, v206, v211
    v_fmac_f32 v116, v206, v212
    v_fmac_f32 v117, v206, v213
    v_fmac_f32 v118, v206, v214
    v_fmac_f32 v119, v206, v215
    v_fmac_f32 v120, v207, v208
    v_fmac_f32 v121, v207, v209
    v_fmac_f32 v122, v207, v210
    v_fmac_f32 v123, v207, v211
    v_fmac_f32 v124, v207, v212
    v_fmac_f32 v125, v207, v213
    v_fmac_f32 v126, v207, v214
    v_fmac_f32 v127, v207, v215
    v_lshlrev_b32 v8, 11, v5
    v_lshl_add_u32 v8, v4, 5, v8
    v_add_u32 v8, 18432, v8
    ds_write_b128 v8, v[64:67] offset:0
    ds_write_b128 v8, v[68:71] offset:16
    ds_write_b128 v8, v[72:75] offset:256
    ds_write_b128 v8, v[76:79] offset:272
    ds_write_b128 v8, v[80:83] offset:512
    ds_write_b128 v8, v[84:87] offset:528
    ds_write_b128 v8, v[88:91] offset:768
    ds_write_b128 v8, v[92:95] offset:784
    ds_write_b128 v8, v[96:99] offset:1024
    ds_write_b128 v8, v[100:103] offset:1040
    ds_write_b128 v8, v[104:107] offset:1280
    ds_write_b128 v8, v[108:111] offset:1296
    ds_write_b128 v8, v[112:115] offset:1536
    ds_write_b128 v8, v[116:119] offset:1552
    ds_write_b128 v8, v[120:123] offset:1792
    ds_write_b128 v8, v[124:127] offset:1808
    s_waitcnt lgkmcnt(0)
    s_barrier
    v_lshrrev_b32 v9, 5, v0
    v_and_b32 v10, 31, v0
    v_lshlrev_b32 v11, 8, v9
    v_lshl_add_u32 v11, v10, 3, v11
    v_add_u32 v11, 18432, v11
    ds_read_b64 v[64:65], v11 offset:0
    ds_read_b64 v[66:67], v11 offset:2048
    ds_read_b64 v[68:69], v11 offset:4096
    ds_read_b64 v[70:71], v11 offset:6144
    ds_read_b64 v[72:73], v11 offset:8192
    ds_read_b64 v[74:75], v11 offset:10240
    ds_read_b64 v[76:77], v11 offset:12288
    ds_read_b64 v[78:79], v11 offset:14336
    ds_read_b64 v[80:81], v11 offset:16384
    ds_read_b64 v[82:83], v11 offset:18432
    ds_read_b64 v[84:85], v11 offset:20480
    ds_read_b64 v[86:87], v11 offset:22528
    ds_read_b64 v[88:89], v11 offset:24576
    ds_read_b64 v[90:91], v11 offset:26624
    ds_read_b64 v[92:93], v11 offset:28672
    ds_read_b64 v[94:95], v11 offset:30720
    ds_read_b64 v[96:97], v11 offset:32768
    ds_read_b64 v[98:99], v11 offset:34816
    ds_read_b64 v[100:101], v11 offset:36864
    ds_read_b64 v[102:103], v11 offset:38912
    ds_read_b64 v[104:105], v11 offset:40960
    ds_read_b64 v[106:107], v11 offset:43008
    ds_read_b64 v[108:109], v11 offset:45056
    ds_read_b64 v[110:111], v11 offset:47104
    ds_read_b64 v[112:113], v11 offset:49152
    ds_read_b64 v[114:115], v11 offset:51200
    ds_read_b64 v[116:117], v11 offset:53248
    ds_read_b64 v[118:119], v11 offset:55296
    ds_read_b64 v[120:121], v11 offset:57344
    ds_read_b64 v[122:123], v11 offset:59392
    ds_read_b64 v[124:125], v11 offset:61440
    ds_read_b64 v[126:127], v11 offset:63488
    s_waitcnt lgkmcnt(0)
    v_add_f32 v64, v64, v66
    v_add_f32 v65, v65, v67
    v_add_f32 v64, v64, v68
    v_add_f32 v65, v65, v69
    v_add_f32 v64, v64, v70
    v_add_f32 v65, v65, v71
    v_add_f32 v64, v64, v72
    v_add_f32 v65, v65, v73
    v_add_f32 v64, v64, v74
    v_add_f32 v65, v65, v75
    v_add_f32 v64, v64, v76
    v_add_f32 v65, v65, v77
    v_add_f32 v64, v64, v78
    v_add_f32 v65, v65, v79
    v_add_f32 v64, v64, v80
    v_add_f32 v65, v65, v81
    v_add_f32 v64, v64, v82
    v_add_f32 v65, v65, v83
    v_add_f32 v64, v64, v84
    v_add_f32 v65, v65, v85
    v_add_f32 v64, v64, v86
    v_add_f32 v65, v65, v87
    v_add_f32 v64, v64, v88
    v_add_f32 v65, v65, v89
    v_add_f32 v64, v64, v90
    v_add_f32 v65, v65, v91
    v_add_f32 v64, v64, v92
    v_add_f32 v65, v65, v93
    v_add_f32 v64, v64, v94
    v_add_f32 v65, v65, v95
    v_add_f32 v64, v64, v96
    v_add_f32 v65, v65, v97
    v_add_f32 v64, v64, v98
    v_add_f32 v65, v65, v99
    v_add_f32 v64, v64, v100
    v_add_f32 v65, v65, v101
    v_add_f32 v64, v64, v102
    v_add_f32 v65, v65, v103
    v_add_f32 v64, v64, v104
    v_add_f32 v65, v65, v105
    v_add_f32 v64, v64, v106
    v_add_f32 v65, v65, v107
    v_add_f32 v64, v64, v108
    v_add_f32 v65, v65, v109
    v_add_f32 v64, v64, v110
    v_add_f32 v65, v65, v111
    v_add_f32 v64, v64, v112
    v_add_f32 v65, v65, v113
    v_add_f32 v64, v64, v114
    v_add_f32 v65, v65, v115
    v_add_f32 v64, v64, v116
    v_add_f32 v65, v65, v117
    v_add_f32 v64, v64, v118
    v_add_f32 v65, v65, v119
    v_add_f32 v64, v64, v120
    v_add_f32 v65, v65, v121
    v_add_f32 v64, v64, v122
    v_add_f32 v65, v65, v123
    v_add_f32 v64, v64, v124
    v_add_f32 v65, v65, v125
    v_add_f32 v64, v64, v126
    v_add_f32 v65, v65, v127
    s_lshl_b32 s40, s30, 7
    s_add_u32 s40, s40, 131072
    v_lshlrev_b32 v12, 13, v9
    v_lshl_add_u32 v12, v10, 2, v12
    v_cvt_pk_bf16_f32 v64, v64, v65
    buffer_store_dword v64, v12, s[12:15], s40 offen
    s_waitcnt vmcnt(0)
L_end_kb_kernel:
    s_endpgm
.globl kc_kernel
.p2align 8
.type kc_kernel,@function
kc_kernel:
    s_cmp_ge_u32 s2, 1024
    s_cbranch_scc1 L_end_kc_kernel
    s_load_dwordx2 s[28:29], s[0:1], 8
    s_load_dwordx2 s[34:35], s[0:1], 16
    s_load_dwordx2 s[36:37], s[0:1], 104
    s_waitcnt lgkmcnt(0)
    s_mov_b32 s8, s28
    s_and_b32 s9, s29, 0xffff
    s_mov_b32 s10, 0x10000000
    s_mov_b32 s11, 0x20000
    s_mov_b32 s16, s34
    s_and_b32 s17, s35, 0xffff
    s_mov_b32 s18, 0x10000000
    s_mov_b32 s19, 0x20000
    s_mov_b32 s12, s36
    s_and_b32 s13, s37, 0xffff
    s_mov_b32 s14, 0x40000000
    s_mov_b32 s15, 0x20000
    v_and_b32 v1, 63, v0
    v_lshrrev_b32 v2, 6, v0
    v_lshlrev_b32 v3, 4, v1
    v_readfirstlane_b32 s33, v2
    s_lshl_b32 s32, s2, 18
    s_nop 0
    s_lshl_b32 s33, s33, 16
    s_add_u32 s32, s32, s33
    buffer_load_dwordx4 v[64:67], v3, s[8:11], s32 offen nt
    buffer_load_dwordx4 v[68:71], v3, s[8:11], s32 offen offset:1024 nt
    buffer_load_dwordx4 v[72:75], v3, s[16:19], s32 offen nt
    buffer_load_dwordx4 v[76:79], v3, s[16:19], s32 offen offset:1024 nt
    s_add_u32 s32, s32, 2048
    buffer_load_dwordx4 v[80:83], v3, s[8:11], s32 offen nt
    buffer_load_dwordx4 v[84:87], v3, s[8:11], s32 offen offset:1024 nt
    buffer_load_dwordx4 v[88:91], v3, s[16:19], s32 offen nt
    buffer_load_dwordx4 v[92:95], v3, s[16:19], s32 offen offset:1024 nt
    s_add_u32 s32, s32, 2048
    buffer_load_dwordx4 v[96:99], v3, s[8:11], s32 offen nt
    buffer_load_dwordx4 v[100:103], v3, s[8:11], s32 offen offset:1024 nt
    buffer_load_dwordx4 v[104:107], v3, s[16:19], s32 offen nt
    buffer_load_dwordx4 v[108:111], v3, s[16:19], s32 offen offset:1024 nt
    s_add_u32 s32, s32, 2048
    buffer_load_dwordx4 v[112:115], v3, s[8:11], s32 offen nt
    buffer_load_dwordx4 v[116:119], v3, s[8:11], s32 offen offset:1024 nt
    buffer_load_dwordx4 v[120:123], v3, s[16:19], s32 offen nt
    buffer_load_dwordx4 v[124:127], v3, s[16:19], s32 offen offset:1024 nt
    s_add_u32 s32, s32, 2048
    s_lshr_b32 s43, s2, 3
    s_lshl_b32 s43, s43, 9
    s_add_u32 s43, s43, 131072
    v_and_b32 v4, 15, v1
    v_lshlrev_b32 v4, 4, v4
    buffer_load_dwordx4 v[16:19], v4, s[12:15], s43 offen
    buffer_load_dwordx4 v[20:23], v4, s[12:15], s43 offen offset:256
    s_mov_b32 s40, 0x3e0293ee
    s_mov_b32 s41, 0x05040100
    s_mov_b32 s42, 0x07060302
    v_mov_b32 v24, 0xff61b1e6
    v_mov_b32 v25, 0xff61b1e6
    v_mov_b32 v26, 0
    v_mov_b32 v27, 0
    v_mov_b32 v32, 0
    v_mov_b32 v33, 0
    v_mov_b32 v34, 0
    v_mov_b32 v35, 0
    v_mov_b32 v36, 0
    v_mov_b32 v37, 0
    v_mov_b32 v38, 0
    v_mov_b32 v39, 0
    v_mov_b32 v40, 0
    v_mov_b32 v41, 0
    v_mov_b32 v42, 0
    v_mov_b32 v43, 0
    v_mov_b32 v44, 0
    v_mov_b32 v45, 0
    v_mov_b32 v46, 0
    v_mov_b32 v47, 0
    s_waitcnt vmcnt(0)
    s_mov_b32 s44, 0
L_att_loop:
    s_waitcnt vmcnt(12)
    v_dot2_f32_bf16 v48, v64, v16, 0
    v_dot2_f32_bf16 v49, v64, v20, 0
    v_dot2_f32_bf16 v50, v68, v16, 0
    v_dot2_f32_bf16 v51, v68, v20, 0
    v_dot2_f32_bf16 v48, v65, v17, v48
    v_dot2_f32_bf16 v49, v65, v21, v49
    v_dot2_f32_bf16 v50, v69, v17, v50
    v_dot2_f32_bf16 v51, v69, v21, v51
    v_dot2_f32_bf16 v48, v66, v18, v48
    v_dot2_f32_bf16 v49, v66, v22, v49
    v_dot2_f32_bf16 v50, v70, v18, v50
    v_dot2_f32_bf16 v51, v70, v22, v51
    v_dot2_f32_bf16 v48, v67, v19, v48
    v_dot2_f32_bf16 v49, v67, v23, v49
    v_dot2_f32_bf16 v50, v71, v19, v50
    v_dot2_f32_bf16 v51, v71, v23, v51
    v_add_f32_dpp v48, v48, v48 row_ror:8 row_mask:0xf bank_mask:0xf
    v_add_f32_dpp v49, v49, v49 row_ror:8 row_mask:0xf bank_mask:0xf
    v_add_f32_dpp v50, v50, v50 row_ror:8 row_mask:0xf bank_mask:0xf
    v_add_f32_dpp v51, v51, v51 row_ror:8 row_mask:0xf bank_mask:0xf
    v_add_f32_dpp v48, v48, v48 row_ror:4 row_mask:0xf bank_mask:0xf
    v_add_f32_dpp v49, v49, v49 row_ror:4 row_mask:0xf bank_mask:0xf
    v_add_f32_dpp v50, v50, v50 row_ror:4 row_mask:0xf bank_mask:0xf
    v_add_f32_dpp v51, v51, v51 row_ror:4 row_mask:0xf bank_mask:0xf
    v_add_f32_dpp v48, v48, v48 row_ror:2 row_mask:0xf bank_mask:0xf
    v_add_f32_dpp v49, v49, v49 row_ror:2 row_mask:0xf bank_mask:0xf
    v_add_f32_dpp v50, v50, v50 row_ror:2 row_mask:0xf bank_mask:0xf
    v_add_f32_dpp v51, v51, v51 row_ror:2 row_mask:0xf bank_mask:0xf
    v_add_f32_dpp v48, v48, v48 row_ror:1 row_mask:0xf bank_mask:0xf
    v_add_f32_dpp v49, v49, v49 row_ror:1 row_mask:0xf bank_mask:0xf
    v_add_f32_dpp v50, v50, v50 row_ror:1 row_mask:0xf bank_mask:0xf
    v_add_f32_dpp v51, v51, v51 row_ror:1 row_mask:0xf bank_mask:0xf
    v_mul_f32 v48, s40, v48
    v_mul_f32 v49, s40, v49
    v_mul_f32 v50, s40, v50
    v_mul_f32 v51, s40, v51
    v_max3_f32 v52, v24, v48, v50
    v_sub_f32 v53, v24, v52
    v_sub_f32 v54, v48, v52
    v_sub_f32 v55, v50, v52
    v_exp_f32 v53, v53
    v_exp_f32 v54, v54
    v_exp_f32 v55, v55
    v_mov_b32 v24, v52
    v_fma_f32 v26, v26, v53, v54
    v_add_f32 v26, v26, v55
    v_cvt_pk_bf16_f32 v56, v54, v55
    v_mul_f32 v32, v32, v53
    v_mul_f32 v33, v33, v53
    v_mul_f32 v34, v34, v53
    v_mul_f32 v35, v35, v53
    v_mul_f32 v36, v36, v53
    v_mul_f32 v37, v37, v53
    v_mul_f32 v38, v38, v53
    v_mul_f32 v39, v39, v53
    v_max3_f32 v52, v25, v49, v51
    v_sub_f32 v53, v25, v52
    v_sub_f32 v54, v49, v52
    v_sub_f32 v55, v51, v52
    v_exp_f32 v53, v53
    v_exp_f32 v54, v54
    v_exp_f32 v55, v55
    v_mov_b32 v25, v52
    v_fma_f32 v27, v27, v53, v54
    v_add_f32 v27, v27, v55
    v_cvt_pk_bf16_f32 v57, v54, v55
    v_mul_f32 v40, v40, v53
    v_mul_f32 v41, v41, v53
    v_mul_f32 v42, v42, v53
    v_mul_f32 v43, v43, v53
    v_mul_f32 v44, v44, v53
    v_mul_f32 v45, v45, v53
    v_mul_f32 v46, v46, v53
    v_mul_f32 v47, v47, v53
    v_perm_b32 v58, v76, v72, s41
    v_perm_b32 v59, v76, v72, s42
    v_dot2_f32_bf16 v32, v56, v58, v32
    v_dot2_f32_bf16 v33, v56, v59, v33
    v_dot2_f32_bf16 v40, v57, v58, v40
    v_dot2_f32_bf16 v41, v57, v59, v41
    v_perm_b32 v58, v77, v73, s41
    v_perm_b32 v59, v77, v73, s42
    v_dot2_f32_bf16 v34, v56, v58, v34
    v_dot2_f32_bf16 v35, v56, v59, v35
    v_dot2_f32_bf16 v42, v57, v58, v42
    v_dot2_f32_bf16 v43, v57, v59, v43
    v_perm_b32 v58, v78, v74, s41
    v_perm_b32 v59, v78, v74, s42
    v_dot2_f32_bf16 v36, v56, v58, v36
    v_dot2_f32_bf16 v37, v56, v59, v37
    v_dot2_f32_bf16 v44, v57, v58, v44
    v_dot2_f32_bf16 v45, v57, v59, v45
    v_perm_b32 v58, v79, v75, s41
    v_perm_b32 v59, v79, v75, s42
    v_dot2_f32_bf16 v38, v56, v58, v38
    v_dot2_f32_bf16 v39, v56, v59, v39
    v_dot2_f32_bf16 v46, v57, v58, v46
    v_dot2_f32_bf16 v47, v57, v59, v47
    buffer_load_dwordx4 v[64:67], v3, s[8:11], s32 offen nt
    buffer_load_dwordx4 v[68:71], v3, s[8:11], s32 offen offset:1024 nt
    buffer_load_dwordx4 v[72:75], v3, s[16:19], s32 offen nt
    buffer_load_dwordx4 v[76:79], v3, s[16:19], s32 offen offset:1024 nt
    s_add_u32 s32, s32, 2048
    s_waitcnt vmcnt(12)
    v_dot2_f32_bf16 v48, v80, v16, 0
    v_dot2_f32_bf16 v49, v80, v20, 0
    v_dot2_f32_bf16 v50, v84, v16, 0
    v_dot2_f32_bf16 v51, v84, v20, 0
    v_dot2_f32_bf16 v48, v81, v17, v48
    v_dot2_f32_bf16 v49, v81, v21, v49
    v_dot2_f32_bf16 v50, v85, v17, v50
    v_dot2_f32_bf16 v51, v85, v21, v51
    v_dot2_f32_bf16 v48, v82, v18, v48
    v_dot2_f32_bf16 v49, v82, v22, v49
    v_dot2_f32_bf16 v50, v86, v18, v50
    v_dot2_f32_bf16 v51, v86, v22, v51
    v_dot2_f32_bf16 v48, v83, v19, v48
    v_dot2_f32_bf16 v49, v83, v23, v49
    v_dot2_f32_bf16 v50, v87, v19, v50
    v_dot2_f32_bf16 v51, v87, v23, v51
    v_add_f32_dpp v48, v48, v48 row_ror:8 row_mask:0xf bank_mask:0xf
    v_add_f32_dpp v49, v49, v49 row_ror:8 row_mask:0xf bank_mask:0xf
    v_add_f32_dpp v50, v50, v50 row_ror:8 row_mask:0xf bank_mask:0xf
    v_add_f32_dpp v51, v51, v51 row_ror:8 row_mask:0xf bank_mask:0xf
    v_add_f32_dpp v48, v48, v48 row_ror:4 row_mask:0xf bank_mask:0xf
    v_add_f32_dpp v49, v49, v49 row_ror:4 row_mask:0xf bank_mask:0xf
    v_add_f32_dpp v50, v50, v50 row_ror:4 row_mask:0xf bank_mask:0xf
    v_add_f32_dpp v51, v51, v51 row_ror:4 row_mask:0xf bank_mask:0xf
    v_add_f32_dpp v48, v48, v48 row_ror:2 row_mask:0xf bank_mask:0xf
    v_add_f32_dpp v49, v49, v49 row_ror:2 row_mask:0xf bank_mask:0xf
    v_add_f32_dpp v50, v50, v50 row_ror:2 row_mask:0xf bank_mask:0xf
    v_add_f32_dpp v51, v51, v51 row_ror:2 row_mask:0xf bank_mask:0xf
    v_add_f32_dpp v48, v48, v48 row_ror:1 row_mask:0xf bank_mask:0xf
    v_add_f32_dpp v49, v49, v49 row_ror:1 row_mask:0xf bank_mask:0xf
    v_add_f32_dpp v50, v50, v50 row_ror:1 row_mask:0xf bank_mask:0xf
    v_add_f32_dpp v51, v51, v51 row_ror:1 row_mask:0xf bank_mask:0xf
    v_mul_f32 v48, s40, v48
    v_mul_f32 v49, s40, v49
    v_mul_f32 v50, s40, v50
    v_mul_f32 v51, s40, v51
    v_max3_f32 v52, v24, v48, v50
    v_sub_f32 v53, v24, v52
    v_sub_f32 v54, v48, v52
    v_sub_f32 v55, v50, v52
    v_exp_f32 v53, v53
    v_exp_f32 v54, v54
    v_exp_f32 v55, v55
    v_mov_b32 v24, v52
    v_fma_f32 v26, v26, v53, v54
    v_add_f32 v26, v26, v55
    v_cvt_pk_bf16_f32 v56, v54, v55
    v_mul_f32 v32, v32, v53
    v_mul_f32 v33, v33, v53
    v_mul_f32 v34, v34, v53
    v_mul_f32 v35, v35, v53
    v_mul_f32 v36, v36, v53
    v_mul_f32 v37, v37, v53
    v_mul_f32 v38, v38, v53
    v_mul_f32 v39, v39, v53
    v_max3_f32 v52, v25, v49, v51
    v_sub_f32 v53, v25, v52
    v_sub_f32 v54, v49, v52
    v_sub_f32 v55, v51, v52
    v_exp_f32 v53, v53
    v_exp_f32 v54, v54
    v_exp_f32 v55, v55
    v_mov_b32 v25, v52
    v_fma_f32 v27, v27, v53, v54
    v_add_f32 v27, v27, v55
    v_cvt_pk_bf16_f32 v57, v54, v55
    v_mul_f32 v40, v40, v53
    v_mul_f32 v41, v41, v53
    v_mul_f32 v42, v42, v53
    v_mul_f32 v43, v43, v53
    v_mul_f32 v44, v44, v53
    v_mul_f32 v45, v45, v53
    v_mul_f32 v46, v46, v53
    v_mul_f32 v47, v47, v53
    v_perm_b32 v58, v92, v88, s41
    v_perm_b32 v59, v92, v88, s42
    v_dot2_f32_bf16 v32, v56, v58, v32
    v_dot2_f32_bf16 v33, v56, v59, v33
    v_dot2_f32_bf16 v40, v57, v58, v40
    v_dot2_f32_bf16 v41, v57, v59, v41
    v_perm_b32 v58, v93, v89, s41
    v_perm_b32 v59, v93, v89, s42
    v_dot2_f32_bf16 v34, v56, v58, v34
    v_dot2_f32_bf16 v35, v56, v59, v35
    v_dot2_f32_bf16 v42, v57, v58, v42
    v_dot2_f32_bf16 v43, v57, v59, v43
    v_perm_b32 v58, v94, v90, s41
    v_perm_b32 v59, v94, v90, s42
    v_dot2_f32_bf16 v36, v56, v58, v36
    v_dot2_f32_bf16 v37, v56, v59, v37
    v_dot2_f32_bf16 v44, v57, v58, v44
    v_dot2_f32_bf16 v45, v57, v59, v45
    v_perm_b32 v58, v95, v91, s41
    v_perm_b32 v59, v95, v91, s42
    v_dot2_f32_bf16 v38, v56, v58, v38
    v_dot2_f32_bf16 v39, v56, v59, v39
    v_dot2_f32_bf16 v46, v57, v58, v46
    v_dot2_f32_bf16 v47, v57, v59, v47
    buffer_load_dwordx4 v[80:83], v3, s[8:11], s32 offen nt
    buffer_load_dwordx4 v[84:87], v3, s[8:11], s32 offen offset:1024 nt
    buffer_load_dwordx4 v[88:91], v3, s[16:19], s32 offen nt
    buffer_load_dwordx4 v[92:95], v3, s[16:19], s32 offen offset:1024 nt
    s_add_u32 s32, s32, 2048
    s_waitcnt vmcnt(12)
    v_dot2_f32_bf16 v48, v96, v16, 0
    v_dot2_f32_bf16 v49, v96, v20, 0
    v_dot2_f32_bf16 v50, v100, v16, 0
    v_dot2_f32_bf16 v51, v100, v20, 0
    v_dot2_f32_bf16 v48, v97, v17, v48
    v_dot2_f32_bf16 v49, v97, v21, v49
    v_dot2_f32_bf16 v50, v101, v17, v50
    v_dot2_f32_bf16 v51, v101, v21, v51
    v_dot2_f32_bf16 v48, v98, v18, v48
    v_dot2_f32_bf16 v49, v98, v22, v49
    v_dot2_f32_bf16 v50, v102, v18, v50
    v_dot2_f32_bf16 v51, v102, v22, v51
    v_dot2_f32_bf16 v48, v99, v19, v48
    v_dot2_f32_bf16 v49, v99, v23, v49
    v_dot2_f32_bf16 v50, v103, v19, v50
    v_dot2_f32_bf16 v51, v103, v23, v51
    v_add_f32_dpp v48, v48, v48 row_ror:8 row_mask:0xf bank_mask:0xf
    v_add_f32_dpp v49, v49, v49 row_ror:8 row_mask:0xf bank_mask:0xf
    v_add_f32_dpp v50, v50, v50 row_ror:8 row_mask:0xf bank_mask:0xf
    v_add_f32_dpp v51, v51, v51 row_ror:8 row_mask:0xf bank_mask:0xf
    v_add_f32_dpp v48, v48, v48 row_ror:4 row_mask:0xf bank_mask:0xf
    v_add_f32_dpp v49, v49, v49 row_ror:4 row_mask:0xf bank_mask:0xf
    v_add_f32_dpp v50, v50, v50 row_ror:4 row_mask:0xf bank_mask:0xf
    v_add_f32_dpp v51, v51, v51 row_ror:4 row_mask:0xf bank_mask:0xf
    v_add_f32_dpp v48, v48, v48 row_ror:2 row_mask:0xf bank_mask:0xf
    v_add_f32_dpp v49, v49, v49 row_ror:2 row_mask:0xf bank_mask:0xf
    v_add_f32_dpp v50, v50, v50 row_ror:2 row_mask:0xf bank_mask:0xf
    v_add_f32_dpp v51, v51, v51 row_ror:2 row_mask:0xf bank_mask:0xf
    v_add_f32_dpp v48, v48, v48 row_ror:1 row_mask:0xf bank_mask:0xf
    v_add_f32_dpp v49, v49, v49 row_ror:1 row_mask:0xf bank_mask:0xf
    v_add_f32_dpp v50, v50, v50 row_ror:1 row_mask:0xf bank_mask:0xf
    v_add_f32_dpp v51, v51, v51 row_ror:1 row_mask:0xf bank_mask:0xf
    v_mul_f32 v48, s40, v48
    v_mul_f32 v49, s40, v49
    v_mul_f32 v50, s40, v50
    v_mul_f32 v51, s40, v51
    v_max3_f32 v52, v24, v48, v50
    v_sub_f32 v53, v24, v52
    v_sub_f32 v54, v48, v52
    v_sub_f32 v55, v50, v52
    v_exp_f32 v53, v53
    v_exp_f32 v54, v54
    v_exp_f32 v55, v55
    v_mov_b32 v24, v52
    v_fma_f32 v26, v26, v53, v54
    v_add_f32 v26, v26, v55
    v_cvt_pk_bf16_f32 v56, v54, v55
    v_mul_f32 v32, v32, v53
    v_mul_f32 v33, v33, v53
    v_mul_f32 v34, v34, v53
    v_mul_f32 v35, v35, v53
    v_mul_f32 v36, v36, v53
    v_mul_f32 v37, v37, v53
    v_mul_f32 v38, v38, v53
    v_mul_f32 v39, v39, v53
    v_max3_f32 v52, v25, v49, v51
    v_sub_f32 v53, v25, v52
    v_sub_f32 v54, v49, v52
    v_sub_f32 v55, v51, v52
    v_exp_f32 v53, v53
    v_exp_f32 v54, v54
    v_exp_f32 v55, v55
    v_mov_b32 v25, v52
    v_fma_f32 v27, v27, v53, v54
    v_add_f32 v27, v27, v55
    v_cvt_pk_bf16_f32 v57, v54, v55
    v_mul_f32 v40, v40, v53
    v_mul_f32 v41, v41, v53
    v_mul_f32 v42, v42, v53
    v_mul_f32 v43, v43, v53
    v_mul_f32 v44, v44, v53
    v_mul_f32 v45, v45, v53
    v_mul_f32 v46, v46, v53
    v_mul_f32 v47, v47, v53
    v_perm_b32 v58, v108, v104, s41
    v_perm_b32 v59, v108, v104, s42
    v_dot2_f32_bf16 v32, v56, v58, v32
    v_dot2_f32_bf16 v33, v56, v59, v33
    v_dot2_f32_bf16 v40, v57, v58, v40
    v_dot2_f32_bf16 v41, v57, v59, v41
    v_perm_b32 v58, v109, v105, s41
    v_perm_b32 v59, v109, v105, s42
    v_dot2_f32_bf16 v34, v56, v58, v34
    v_dot2_f32_bf16 v35, v56, v59, v35
    v_dot2_f32_bf16 v42, v57, v58, v42
    v_dot2_f32_bf16 v43, v57, v59, v43
    v_perm_b32 v58, v110, v106, s41
    v_perm_b32 v59, v110, v106, s42
    v_dot2_f32_bf16 v36, v56, v58, v36
    v_dot2_f32_bf16 v37, v56, v59, v37
    v_dot2_f32_bf16 v44, v57, v58, v44
    v_dot2_f32_bf16 v45, v57, v59, v45
    v_perm_b32 v58, v111, v107, s41
    v_perm_b32 v59, v111, v107, s42
    v_dot2_f32_bf16 v38, v56, v58, v38
    v_dot2_f32_bf16 v39, v56, v59, v39
    v_dot2_f32_bf16 v46, v57, v58, v46
    v_dot2_f32_bf16 v47, v57, v59, v47
    buffer_load_dwordx4 v[96:99], v3, s[8:11], s32 offen nt
    buffer_load_dwordx4 v[100:103], v3, s[8:11], s32 offen offset:1024 nt
    buffer_load_dwordx4 v[104:107], v3, s[16:19], s32 offen nt
    buffer_load_dwordx4 v[108:111], v3, s[16:19], s32 offen offset:1024 nt
    s_add_u32 s32, s32, 2048
    s_waitcnt vmcnt(12)
    v_dot2_f32_bf16 v48, v112, v16, 0
    v_dot2_f32_bf16 v49, v112, v20, 0
    v_dot2_f32_bf16 v50, v116, v16, 0
    v_dot2_f32_bf16 v51, v116, v20, 0
    v_dot2_f32_bf16 v48, v113, v17, v48
    v_dot2_f32_bf16 v49, v113, v21, v49
    v_dot2_f32_bf16 v50, v117, v17, v50
    v_dot2_f32_bf16 v51, v117, v21, v51
    v_dot2_f32_bf16 v48, v114, v18, v48
    v_dot2_f32_bf16 v49, v114, v22, v49
    v_dot2_f32_bf16 v50, v118, v18, v50
    v_dot2_f32_bf16 v51, v118, v22, v51
    v_dot2_f32_bf16 v48, v115, v19, v48
    v_dot2_f32_bf16 v49, v115, v23, v49
    v_dot2_f32_bf16 v50, v119, v19, v50
    v_dot2_f32_bf16 v51, v119, v23, v51
    v_add_f32_dpp v48, v48, v48 row_ror:8 row_mask:0xf bank_mask:0xf
    v_add_f32_dpp v49, v49, v49 row_ror:8 row_mask:0xf bank_mask:0xf
    v_add_f32_dpp v50, v50, v50 row_ror:8 row_mask:0xf bank_mask:0xf
    v_add_f32_dpp v51, v51, v51 row_ror:8 row_mask:0xf bank_mask:0xf
    v_add_f32_dpp v48, v48, v48 row_ror:4 row_mask:0xf bank_mask:0xf
    v_add_f32_dpp v49, v49, v49 row_ror:4 row_mask:0xf bank_mask:0xf
    v_add_f32_dpp v50, v50, v50 row_ror:4 row_mask:0xf bank_mask:0xf
    v_add_f32_dpp v51, v51, v51 row_ror:4 row_mask:0xf bank_mask:0xf
    v_add_f32_dpp v48, v48, v48 row_ror:2 row_mask:0xf bank_mask:0xf
    v_add_f32_dpp v49, v49, v49 row_ror:2 row_mask:0xf bank_mask:0xf
    v_add_f32_dpp v50, v50, v50 row_ror:2 row_mask:0xf bank_mask:0xf
    v_add_f32_dpp v51, v51, v51 row_ror:2 row_mask:0xf bank_mask:0xf
    v_add_f32_dpp v48, v48, v48 row_ror:1 row_mask:0xf bank_mask:0xf
    v_add_f32_dpp v49, v49, v49 row_ror:1 row_mask:0xf bank_mask:0xf
    v_add_f32_dpp v50, v50, v50 row_ror:1 row_mask:0xf bank_mask:0xf
    v_add_f32_dpp v51, v51, v51 row_ror:1 row_mask:0xf bank_mask:0xf
    v_mul_f32 v48, s40, v48
    v_mul_f32 v49, s40, v49
    v_mul_f32 v50, s40, v50
    v_mul_f32 v51, s40, v51
    v_max3_f32 v52, v24, v48, v50
    v_sub_f32 v53, v24, v52
    v_sub_f32 v54, v48, v52
    v_sub_f32 v55, v50, v52
    v_exp_f32 v53, v53
    v_exp_f32 v54, v54
    v_exp_f32 v55, v55
    v_mov_b32 v24, v52
    v_fma_f32 v26, v26, v53, v54
    v_add_f32 v26, v26, v55
    v_cvt_pk_bf16_f32 v56, v54, v55
    v_mul_f32 v32, v32, v53
    v_mul_f32 v33, v33, v53
    v_mul_f32 v34, v34, v53
    v_mul_f32 v35, v35, v53
    v_mul_f32 v36, v36, v53
    v_mul_f32 v37, v37, v53
    v_mul_f32 v38, v38, v53
    v_mul_f32 v39, v39, v53
    v_max3_f32 v52, v25, v49, v51
    v_sub_f32 v53, v25, v52
    v_sub_f32 v54, v49, v52
    v_sub_f32 v55, v51, v52
    v_exp_f32 v53, v53
    v_exp_f32 v54, v54
    v_exp_f32 v55, v55
    v_mov_b32 v25, v52
    v_fma_f32 v27, v27, v53, v54
    v_add_f32 v27, v27, v55
    v_cvt_pk_bf16_f32 v57, v54, v55
    v_mul_f32 v40, v40, v53
    v_mul_f32 v41, v41, v53
    v_mul_f32 v42, v42, v53
    v_mul_f32 v43, v43, v53
    v_mul_f32 v44, v44, v53
    v_mul_f32 v45, v45, v53
    v_mul_f32 v46, v46, v53
    v_mul_f32 v47, v47, v53
    v_perm_b32 v58, v124, v120, s41
    v_perm_b32 v59, v124, v120, s42
    v_dot2_f32_bf16 v32, v56, v58, v32
    v_dot2_f32_bf16 v33, v56, v59, v33
    v_dot2_f32_bf16 v40, v57, v58, v40
    v_dot2_f32_bf16 v41, v57, v59, v41
    v_perm_b32 v58, v125, v121, s41
    v_perm_b32 v59, v125, v121, s42
    v_dot2_f32_bf16 v34, v56, v58, v34
    v_dot2_f32_bf16 v35, v56, v59, v35
    v_dot2_f32_bf16 v42, v57, v58, v42
    v_dot2_f32_bf16 v43, v57, v59, v43
    v_perm_b32 v58, v126, v122, s41
    v_perm_b32 v59, v126, v122, s42
    v_dot2_f32_bf16 v36, v56, v58, v36
    v_dot2_f32_bf16 v37, v56, v59, v37
    v_dot2_f32_bf16 v44, v57, v58, v44
    v_dot2_f32_bf16 v45, v57, v59, v45
    v_perm_b32 v58, v127, v123, s41
    v_perm_b32 v59, v127, v123, s42
    v_dot2_f32_bf16 v38, v56, v58, v38
    v_dot2_f32_bf16 v39, v56, v59, v39
    v_dot2_f32_bf16 v46, v57, v58, v46
    v_dot2_f32_bf16 v47, v57, v59, v47
    buffer_load_dwordx4 v[112:115], v3, s[8:11], s32 offen nt
    buffer_load_dwordx4 v[116:119], v3, s[8:11], s32 offen offset:1024 nt
    buffer_load_dwordx4 v[120:123], v3, s[16:19], s32 offen nt
    buffer_load_dwordx4 v[124:127], v3, s[16:19], s32 offen offset:1024 nt
    s_add_u32 s32, s32, 2048
    s_add_u32 s44, s44, 1
    s_cmp_lt_u32 s44, 7
    s_nop 2
    s_cbranch_scc1 L_att_loop
    s_waitcnt vmcnt(12)
    v_dot2_f32_bf16 v48, v64, v16, 0
    v_dot2_f32_bf16 v49, v64, v20, 0
    v_dot2_f32_bf16 v50, v68, v16, 0
    v_dot2_f32_bf16 v51, v68, v20, 0
    v_dot2_f32_bf16 v48, v65, v17, v48
    v_dot2_f32_bf16 v49, v65, v21, v49
    v_dot2_f32_bf16 v50, v69, v17, v50
    v_dot2_f32_bf16 v51, v69, v21, v51
    v_dot2_f32_bf16 v48, v66, v18, v48
    v_dot2_f32_bf16 v49, v66, v22, v49
    v_dot2_f32_bf16 v50, v70, v18, v50
    v_dot2_f32_bf16 v51, v70, v22, v51
    v_dot2_f32_bf16 v48, v67, v19, v48
    v_dot2_f32_bf16 v49, v67, v23, v49
    v_dot2_f32_bf16 v50, v71, v19, v50
    v_dot2_f32_bf16 v51, v71, v23, v51
    v_add_f32_dpp v48, v48, v48 row_ror:8 row_mask:0xf bank_mask:0xf
    v_add_f32_dpp v49, v49, v49 row_ror:8 row_mask:0xf bank_mask:0xf
    v_add_f32_dpp v50, v50, v50 row_ror:8 row_mask:0xf bank_mask:0xf
    v_add_f32_dpp v51, v51, v51 row_ror:8 row_mask:0xf bank_mask:0xf
    v_add_f32_dpp v48, v48, v48 row_ror:4 row_mask:0xf bank_mask:0xf
    v_add_f32_dpp v49, v49, v49 row_ror:4 row_mask:0xf bank_mask:0xf
    v_add_f32_dpp v50, v50, v50 row_ror:4 row_mask:0xf bank_mask:0xf
    v_add_f32_dpp v51, v51, v51 row_ror:4 row_mask:0xf bank_mask:0xf
    v_add_f32_dpp v48, v48, v48 row_ror:2 row_mask:0xf bank_mask:0xf
    v_add_f32_dpp v49, v49, v49 row_ror:2 row_mask:0xf bank_mask:0xf
    v_add_f32_dpp v50, v50, v50 row_ror:2 row_mask:0xf bank_mask:0xf
    v_add_f32_dpp v51, v51, v51 row_ror:2 row_mask:0xf bank_mask:0xf
    v_add_f32_dpp v48, v48, v48 row_ror:1 row_mask:0xf bank_mask:0xf
    v_add_f32_dpp v49, v49, v49 row_ror:1 row_mask:0xf bank_mask:0xf
    v_add_f32_dpp v50, v50, v50 row_ror:1 row_mask:0xf bank_mask:0xf
    v_add_f32_dpp v51, v51, v51 row_ror:1 row_mask:0xf bank_mask:0xf
    v_mul_f32 v48, s40, v48
    v_mul_f32 v49, s40, v49
    v_mul_f32 v50, s40, v50
    v_mul_f32 v51, s40, v51
    v_max3_f32 v52, v24, v48, v50
    v_sub_f32 v53, v24, v52
    v_sub_f32 v54, v48, v52
    v_sub_f32 v55, v50, v52
    v_exp_f32 v53, v53
    v_exp_f32 v54, v54
    v_exp_f32 v55, v55
    v_mov_b32 v24, v52
    v_fma_f32 v26, v26, v53, v54
    v_add_f32 v26, v26, v55
    v_cvt_pk_bf16_f32 v56, v54, v55
    v_mul_f32 v32, v32, v53
    v_mul_f32 v33, v33, v53
    v_mul_f32 v34, v34, v53
    v_mul_f32 v35, v35, v53
    v_mul_f32 v36, v36, v53
    v_mul_f32 v37, v37, v53
    v_mul_f32 v38, v38, v53
    v_mul_f32 v39, v39, v53
    v_max3_f32 v52, v25, v49, v51
    v_sub_f32 v53, v25, v52
    v_sub_f32 v54, v49, v52
    v_sub_f32 v55, v51, v52
    v_exp_f32 v53, v53
    v_exp_f32 v54, v54
    v_exp_f32 v55, v55
    v_mov_b32 v25, v52
    v_fma_f32 v27, v27, v53, v54
    v_add_f32 v27, v27, v55
    v_cvt_pk_bf16_f32 v57, v54, v55
    v_mul_f32 v40, v40, v53
    v_mul_f32 v41, v41, v53
    v_mul_f32 v42, v42, v53
    v_mul_f32 v43, v43, v53
    v_mul_f32 v44, v44, v53
    v_mul_f32 v45, v45, v53
    v_mul_f32 v46, v46, v53
    v_mul_f32 v47, v47, v53
    v_perm_b32 v58, v76, v72, s41
    v_perm_b32 v59, v76, v72, s42
    v_dot2_f32_bf16 v32, v56, v58, v32
    v_dot2_f32_bf16 v33, v56, v59, v33
    v_dot2_f32_bf16 v40, v57, v58, v40
    v_dot2_f32_bf16 v41, v57, v59, v41
    v_perm_b32 v58, v77, v73, s41
    v_perm_b32 v59, v77, v73, s42
    v_dot2_f32_bf16 v34, v56, v58, v34
    v_dot2_f32_bf16 v35, v56, v59, v35
    v_dot2_f32_bf16 v42, v57, v58, v42
    v_dot2_f32_bf16 v43, v57, v59, v43
    v_perm_b32 v58, v78, v74, s41
    v_perm_b32 v59, v78, v74, s42
    v_dot2_f32_bf16 v36, v56, v58, v36
    v_dot2_f32_bf16 v37, v56, v59, v37
    v_dot2_f32_bf16 v44, v57, v58, v44
    v_dot2_f32_bf16 v45, v57, v59, v45
    v_perm_b32 v58, v79, v75, s41
    v_perm_b32 v59, v79, v75, s42
    v_dot2_f32_bf16 v38, v56, v58, v38
    v_dot2_f32_bf16 v39, v56, v59, v39
    v_dot2_f32_bf16 v46, v57, v58, v46
    v_dot2_f32_bf16 v47, v57, v59, v47
    s_waitcnt vmcnt(8)
    v_dot2_f32_bf16 v48, v80, v16, 0
    v_dot2_f32_bf16 v49, v80, v20, 0
    v_dot2_f32_bf16 v50, v84, v16, 0
    v_dot2_f32_bf16 v51, v84, v20, 0
    v_dot2_f32_bf16 v48, v81, v17, v48
    v_dot2_f32_bf16 v49, v81, v21, v49
    v_dot2_f32_bf16 v50, v85, v17, v50
    v_dot2_f32_bf16 v51, v85, v21, v51
    v_dot2_f32_bf16 v48, v82, v18, v48
    v_dot2_f32_bf16 v49, v82, v22, v49
    v_dot2_f32_bf16 v50, v86, v18, v50
    v_dot2_f32_bf16 v51, v86, v22, v51
    v_dot2_f32_bf16 v48, v83, v19, v48
    v_dot2_f32_bf16 v49, v83, v23, v49
    v_dot2_f32_bf16 v50, v87, v19, v50
    v_dot2_f32_bf16 v51, v87, v23, v51
    v_add_f32_dpp v48, v48, v48 row_ror:8 row_mask:0xf bank_mask:0xf
    v_add_f32_dpp v49, v49, v49 row_ror:8 row_mask:0xf bank_mask:0xf
    v_add_f32_dpp v50, v50, v50 row_ror:8 row_mask:0xf bank_mask:0xf
    v_add_f32_dpp v51, v51, v51 row_ror:8 row_mask:0xf bank_mask:0xf
    v_add_f32_dpp v48, v48, v48 row_ror:4 row_mask:0xf bank_mask:0xf
    v_add_f32_dpp v49, v49, v49 row_ror:4 row_mask:0xf bank_mask:0xf
    v_add_f32_dpp v50, v50, v50 row_ror:4 row_mask:0xf bank_mask:0xf
    v_add_f32_dpp v51, v51, v51 row_ror:4 row_mask:0xf bank_mask:0xf
    v_add_f32_dpp v48, v48, v48 row_ror:2 row_mask:0xf bank_mask:0xf
    v_add_f32_dpp v49, v49, v49 row_ror:2 row_mask:0xf bank_mask:0xf
    v_add_f32_dpp v50, v50, v50 row_ror:2 row_mask:0xf bank_mask:0xf
    v_add_f32_dpp v51, v51, v51 row_ror:2 row_mask:0xf bank_mask:0xf
    v_add_f32_dpp v48, v48, v48 row_ror:1 row_mask:0xf bank_mask:0xf
    v_add_f32_dpp v49, v49, v49 row_ror:1 row_mask:0xf bank_mask:0xf
    v_add_f32_dpp v50, v50, v50 row_ror:1 row_mask:0xf bank_mask:0xf
    v_add_f32_dpp v51, v51, v51 row_ror:1 row_mask:0xf bank_mask:0xf
    v_mul_f32 v48, s40, v48
    v_mul_f32 v49, s40, v49
    v_mul_f32 v50, s40, v50
    v_mul_f32 v51, s40, v51
    v_max3_f32 v52, v24, v48, v50
    v_sub_f32 v53, v24, v52
    v_sub_f32 v54, v48, v52
    v_sub_f32 v55, v50, v52
    v_exp_f32 v53, v53
    v_exp_f32 v54, v54
    v_exp_f32 v55, v55
    v_mov_b32 v24, v52
    v_fma_f32 v26, v26, v53, v54
    v_add_f32 v26, v26, v55
    v_cvt_pk_bf16_f32 v56, v54, v55
    v_mul_f32 v32, v32, v53
    v_mul_f32 v33, v33, v53
    v_mul_f32 v34, v34, v53
    v_mul_f32 v35, v35, v53
    v_mul_f32 v36, v36, v53
    v_mul_f32 v37, v37, v53
    v_mul_f32 v38, v38, v53
    v_mul_f32 v39, v39, v53
    v_max3_f32 v52, v25, v49, v51
    v_sub_f32 v53, v25, v52
    v_sub_f32 v54, v49, v52
    v_sub_f32 v55, v51, v52
    v_exp_f32 v53, v53
    v_exp_f32 v54, v54
    v_exp_f32 v55, v55
    v_mov_b32 v25, v52
    v_fma_f32 v27, v27, v53, v54
    v_add_f32 v27, v27, v55
    v_cvt_pk_bf16_f32 v57, v54, v55
    v_mul_f32 v40, v40, v53
    v_mul_f32 v41, v41, v53
    v_mul_f32 v42, v42, v53
    v_mul_f32 v43, v43, v53
    v_mul_f32 v44, v44, v53
    v_mul_f32 v45, v45, v53
    v_mul_f32 v46, v46, v53
    v_mul_f32 v47, v47, v53
    v_perm_b32 v58, v92, v88, s41
    v_perm_b32 v59, v92, v88, s42
    v_dot2_f32_bf16 v32, v56, v58, v32
    v_dot2_f32_bf16 v33, v56, v59, v33
    v_dot2_f32_bf16 v40, v57, v58, v40
    v_dot2_f32_bf16 v41, v57, v59, v41
    v_perm_b32 v58, v93, v89, s41
    v_perm_b32 v59, v93, v89, s42
    v_dot2_f32_bf16 v34, v56, v58, v34
    v_dot2_f32_bf16 v35, v56, v59, v35
    v_dot2_f32_bf16 v42, v57, v58, v42
    v_dot2_f32_bf16 v43, v57, v59, v43
    v_perm_b32 v58, v94, v90, s41
    v_perm_b32 v59, v94, v90, s42
    v_dot2_f32_bf16 v36, v56, v58, v36
    v_dot2_f32_bf16 v37, v56, v59, v37
    v_dot2_f32_bf16 v44, v57, v58, v44
    v_dot2_f32_bf16 v45, v57, v59, v45
    v_perm_b32 v58, v95, v91, s41
    v_perm_b32 v59, v95, v91, s42
    v_dot2_f32_bf16 v38, v56, v58, v38
    v_dot2_f32_bf16 v39, v56, v59, v39
    v_dot2_f32_bf16 v46, v57, v58, v46
    v_dot2_f32_bf16 v47, v57, v59, v47
    s_waitcnt vmcnt(4)
    v_dot2_f32_bf16 v48, v96, v16, 0
    v_dot2_f32_bf16 v49, v96, v20, 0
    v_dot2_f32_bf16 v50, v100, v16, 0
    v_dot2_f32_bf16 v51, v100, v20, 0
    v_dot2_f32_bf16 v48, v97, v17, v48
    v_dot2_f32_bf16 v49, v97, v21, v49
    v_dot2_f32_bf16 v50, v101, v17, v50
    v_dot2_f32_bf16 v51, v101, v21, v51
    v_dot2_f32_bf16 v48, v98, v18, v48
    v_dot2_f32_bf16 v49, v98, v22, v49
    v_dot2_f32_bf16 v50, v102, v18, v50
    v_dot2_f32_bf16 v51, v102, v22, v51
    v_dot2_f32_bf16 v48, v99, v19, v48
    v_dot2_f32_bf16 v49, v99, v23, v49
    v_dot2_f32_bf16 v50, v103, v19, v50
    v_dot2_f32_bf16 v51, v103, v23, v51
    v_add_f32_dpp v48, v48, v48 row_ror:8 row_mask:0xf bank_mask:0xf
    v_add_f32_dpp v49, v49, v49 row_ror:8 row_mask:0xf bank_mask:0xf
    v_add_f32_dpp v50, v50, v50 row_ror:8 row_mask:0xf bank_mask:0xf
    v_add_f32_dpp v51, v51, v51 row_ror:8 row_mask:0xf bank_mask:0xf
    v_add_f32_dpp v48, v48, v48 row_ror:4 row_mask:0xf bank_mask:0xf
    v_add_f32_dpp v49, v49, v49 row_ror:4 row_mask:0xf bank_mask:0xf
    v_add_f32_dpp v50, v50, v50 row_ror:4 row_mask:0xf bank_mask:0xf
    v_add_f32_dpp v51, v51, v51 row_ror:4 row_mask:0xf bank_mask:0xf
    v_add_f32_dpp v48, v48, v48 row_ror:2 row_mask:0xf bank_mask:0xf
    v_add_f32_dpp v49, v49, v49 row_ror:2 row_mask:0xf bank_mask:0xf
    v_add_f32_dpp v50, v50, v50 row_ror:2 row_mask:0xf bank_mask:0xf
    v_add_f32_dpp v51, v51, v51 row_ror:2 row_mask:0xf bank_mask:0xf
    v_add_f32_dpp v48, v48, v48 row_ror:1 row_mask:0xf bank_mask:0xf
    v_add_f32_dpp v49, v49, v49 row_ror:1 row_mask:0xf bank_mask:0xf
    v_add_f32_dpp v50, v50, v50 row_ror:1 row_mask:0xf bank_mask:0xf
    v_add_f32_dpp v51, v51, v51 row_ror:1 row_mask:0xf bank_mask:0xf
    v_mul_f32 v48, s40, v48
    v_mul_f32 v49, s40, v49
    v_mul_f32 v50, s40, v50
    v_mul_f32 v51, s40, v51
    v_max3_f32 v52, v24, v48, v50
    v_sub_f32 v53, v24, v52
    v_sub_f32 v54, v48, v52
    v_sub_f32 v55, v50, v52
    v_exp_f32 v53, v53
    v_exp_f32 v54, v54
    v_exp_f32 v55, v55
    v_mov_b32 v24, v52
    v_fma_f32 v26, v26, v53, v54
    v_add_f32 v26, v26, v55
    v_cvt_pk_bf16_f32 v56, v54, v55
    v_mul_f32 v32, v32, v53
    v_mul_f32 v33, v33, v53
    v_mul_f32 v34, v34, v53
    v_mul_f32 v35, v35, v53
    v_mul_f32 v36, v36, v53
    v_mul_f32 v37, v37, v53
    v_mul_f32 v38, v38, v53
    v_mul_f32 v39, v39, v53
    v_max3_f32 v52, v25, v49, v51
    v_sub_f32 v53, v25, v52
    v_sub_f32 v54, v49, v52
    v_sub_f32 v55, v51, v52
    v_exp_f32 v53, v53
    v_exp_f32 v54, v54
    v_exp_f32 v55, v55
    v_mov_b32 v25, v52
    v_fma_f32 v27, v27, v53, v54
    v_add_f32 v27, v27, v55
    v_cvt_pk_bf16_f32 v57, v54, v55
    v_mul_f32 v40, v40, v53
    v_mul_f32 v41, v41, v53
    v_mul_f32 v42, v42, v53
    v_mul_f32 v43, v43, v53
    v_mul_f32 v44, v44, v53
    v_mul_f32 v45, v45, v53
    v_mul_f32 v46, v46, v53
    v_mul_f32 v47, v47, v53
    v_perm_b32 v58, v108, v104, s41
    v_perm_b32 v59, v108, v104, s42
    v_dot2_f32_bf16 v32, v56, v58, v32
    v_dot2_f32_bf16 v33, v56, v59, v33
    v_dot2_f32_bf16 v40, v57, v58, v40
    v_dot2_f32_bf16 v41, v57, v59, v41
    v_perm_b32 v58, v109, v105, s41
    v_perm_b32 v59, v109, v105, s42
    v_dot2_f32_bf16 v34, v56, v58, v34
    v_dot2_f32_bf16 v35, v56, v59, v35
    v_dot2_f32_bf16 v42, v57, v58, v42
    v_dot2_f32_bf16 v43, v57, v59, v43
    v_perm_b32 v58, v110, v106, s41
    v_perm_b32 v59, v110, v106, s42
    v_dot2_f32_bf16 v36, v56, v58, v36
    v_dot2_f32_bf16 v37, v56, v59, v37
    v_dot2_f32_bf16 v44, v57, v58, v44
    v_dot2_f32_bf16 v45, v57, v59, v45
    v_perm_b32 v58, v111, v107, s41
    v_perm_b32 v59, v111, v107, s42
    v_dot2_f32_bf16 v38, v56, v58, v38
    v_dot2_f32_bf16 v39, v56, v59, v39
    v_dot2_f32_bf16 v46, v57, v58, v46
    v_dot2_f32_bf16 v47, v57, v59, v47
    s_waitcnt vmcnt(0)
    v_dot2_f32_bf16 v48, v112, v16, 0
    v_dot2_f32_bf16 v49, v112, v20, 0
    v_dot2_f32_bf16 v50, v116, v16, 0
    v_dot2_f32_bf16 v51, v116, v20, 0
    v_dot2_f32_bf16 v48, v113, v17, v48
    v_dot2_f32_bf16 v49, v113, v21, v49
    v_dot2_f32_bf16 v50, v117, v17, v50
    v_dot2_f32_bf16 v51, v117, v21, v51
    v_dot2_f32_bf16 v48, v114, v18, v48
    v_dot2_f32_bf16 v49, v114, v22, v49
    v_dot2_f32_bf16 v50, v118, v18, v50
    v_dot2_f32_bf16 v51, v118, v22, v51
    v_dot2_f32_bf16 v48, v115, v19, v48
    v_dot2_f32_bf16 v49, v115, v23, v49
    v_dot2_f32_bf16 v50, v119, v19, v50
    v_dot2_f32_bf16 v51, v119, v23, v51
    v_add_f32_dpp v48, v48, v48 row_ror:8 row_mask:0xf bank_mask:0xf
    v_add_f32_dpp v49, v49, v49 row_ror:8 row_mask:0xf bank_mask:0xf
    v_add_f32_dpp v50, v50, v50 row_ror:8 row_mask:0xf bank_mask:0xf
    v_add_f32_dpp v51, v51, v51 row_ror:8 row_mask:0xf bank_mask:0xf
    v_add_f32_dpp v48, v48, v48 row_ror:4 row_mask:0xf bank_mask:0xf
    v_add_f32_dpp v49, v49, v49 row_ror:4 row_mask:0xf bank_mask:0xf
    v_add_f32_dpp v50, v50, v50 row_ror:4 row_mask:0xf bank_mask:0xf
    v_add_f32_dpp v51, v51, v51 row_ror:4 row_mask:0xf bank_mask:0xf
    v_add_f32_dpp v48, v48, v48 row_ror:2 row_mask:0xf bank_mask:0xf
    v_add_f32_dpp v49, v49, v49 row_ror:2 row_mask:0xf bank_mask:0xf
    v_add_f32_dpp v50, v50, v50 row_ror:2 row_mask:0xf bank_mask:0xf
    v_add_f32_dpp v51, v51, v51 row_ror:2 row_mask:0xf bank_mask:0xf
    v_add_f32_dpp v48, v48, v48 row_ror:1 row_mask:0xf bank_mask:0xf
    v_add_f32_dpp v49, v49, v49 row_ror:1 row_mask:0xf bank_mask:0xf
    v_add_f32_dpp v50, v50, v50 row_ror:1 row_mask:0xf bank_mask:0xf
    v_add_f32_dpp v51, v51, v51 row_ror:1 row_mask:0xf bank_mask:0xf
    v_mul_f32 v48, s40, v48
    v_mul_f32 v49, s40, v49
    v_mul_f32 v50, s40, v50
    v_mul_f32 v51, s40, v51
    v_max3_f32 v52, v24, v48, v50
    v_sub_f32 v53, v24, v52
    v_sub_f32 v54, v48, v52
    v_sub_f32 v55, v50, v52
    v_exp_f32 v53, v53
    v_exp_f32 v54, v54
    v_exp_f32 v55, v55
    v_mov_b32 v24, v52
    v_fma_f32 v26, v26, v53, v54
    v_add_f32 v26, v26, v55
    v_cvt_pk_bf16_f32 v56, v54, v55
    v_mul_f32 v32, v32, v53
    v_mul_f32 v33, v33, v53
    v_mul_f32 v34, v34, v53
    v_mul_f32 v35, v35, v53
    v_mul_f32 v36, v36, v53
    v_mul_f32 v37, v37, v53
    v_mul_f32 v38, v38, v53
    v_mul_f32 v39, v39, v53
    v_max3_f32 v52, v25, v49, v51
    v_sub_f32 v53, v25, v52
    v_sub_f32 v54, v49, v52
    v_sub_f32 v55, v51, v52
    v_exp_f32 v53, v53
    v_exp_f32 v54, v54
    v_exp_f32 v55, v55
    v_mov_b32 v25, v52
    v_fma_f32 v27, v27, v53, v54
    v_add_f32 v27, v27, v55
    v_cvt_pk_bf16_f32 v57, v54, v55
    v_mul_f32 v40, v40, v53
    v_mul_f32 v41, v41, v53
    v_mul_f32 v42, v42, v53
    v_mul_f32 v43, v43, v53
    v_mul_f32 v44, v44, v53
    v_mul_f32 v45, v45, v53
    v_mul_f32 v46, v46, v53
    v_mul_f32 v47, v47, v53
    v_perm_b32 v58, v124, v120, s41
    v_perm_b32 v59, v124, v120, s42
    v_dot2_f32_bf16 v32, v56, v58, v32
    v_dot2_f32_bf16 v33, v56, v59, v33
    v_dot2_f32_bf16 v40, v57, v58, v40
    v_dot2_f32_bf16 v41, v57, v59, v41
    v_perm_b32 v58, v125, v121, s41
    v_perm_b32 v59, v125, v121, s42
    v_dot2_f32_bf16 v34, v56, v58, v34
    v_dot2_f32_bf16 v35, v56, v59, v35
    v_dot2_f32_bf16 v42, v57, v58, v42
    v_dot2_f32_bf16 v43, v57, v59, v43
    v_perm_b32 v58, v126, v122, s41
    v_perm_b32 v59, v126, v122, s42
    v_dot2_f32_bf16 v36, v56, v58, v36
    v_dot2_f32_bf16 v37, v56, v59, v37
    v_dot2_f32_bf16 v44, v57, v58, v44
    v_dot2_f32_bf16 v45, v57, v59, v45
    v_perm_b32 v58, v127, v123, s41
    v_perm_b32 v59, v127, v123, s42
    v_dot2_f32_bf16 v38, v56, v58, v38
    v_dot2_f32_bf16 v39, v56, v59, v39
    v_dot2_f32_bf16 v46, v57, v58, v46
    v_dot2_f32_bf16 v47, v57, v59, v47
    v_lshrrev_b32 v5, 4, v0
    v_lshlrev_b32 v6, 9, v5
    v_lshl_add_u32 v6, v4, 1, v6
    ds_write_b128 v6, v[32:35] offset:0
    ds_write_b128 v6, v[36:39] offset:16
    ds_write_b128 v6, v[40:43] offset:8192
    ds_write_b128 v6, v[44:47] offset:8208
    v_lshlrev_b32 v7, 3, v5
    v_mov_b32 v28, v24
    v_mov_b32 v29, v26
    v_mov_b32 v30, v25
    v_mov_b32 v31, v27
    ds_write_b64 v7, v[28:29] offset:16384
    ds_write_b64 v7, v[30:31] offset:16512
    s_waitcnt lgkmcnt(0)
    s_barrier
    v_lshrrev_b32 v8, 7, v0
    v_and_b32 v9, 127, v0
    v_lshlrev_b32 v10, 7, v8
    v_lshlrev_b32 v11, 13, v8
    v_lshl_add_u32 v11, v9, 2, v11
    ds_read_b64 v[64:65], v10 offset:16384
    ds_read_b32 v96, v11 offset:0
    ds_read_b64 v[66:67], v10 offset:16392
    ds_read_b32 v97, v11 offset:512
    ds_read_b64 v[68:69], v10 offset:16400
    ds_read_b32 v98, v11 offset:1024
    ds_read_b64 v[70:71], v10 offset:16408
    ds_read_b32 v99, v11 offset:1536
    ds_read_b64 v[72:73], v10 offset:16416
    ds_read_b32 v100, v11 offset:2048
    ds_read_b64 v[74:75], v10 offset:16424
    ds_read_b32 v101, v11 offset:2560
    ds_read_b64 v[76:77], v10 offset:16432
    ds_read_b32 v102, v11 offset:3072
    ds_read_b64 v[78:79], v10 offset:16440
    ds_read_b32 v103, v11 offset:3584
    ds_read_b64 v[80:81], v10 offset:16448
    ds_read_b32 v104, v11 offset:4096
    ds_read_b64 v[82:83], v10 offset:16456
    ds_read_b32 v105, v11 offset:4608
    ds_read_b64 v[84:85], v10 offset:16464
    ds_read_b32 v106, v11 offset:5120
    ds_read_b64 v[86:87], v10 offset:16472
    ds_read_b32 v107, v11 offset:5632
    ds_read_b64 v[88:89], v10 offset:16480
    ds_read_b32 v108, v11 offset:6144
    ds_read_b64 v[90:91], v10 offset:16488
    ds_read_b32 v109, v11 offset:6656
    ds_read_b64 v[92:93], v10 offset:16496
    ds_read_b32 v110, v11 offset:7168
    ds_read_b64 v[94:95], v10 offset:16504
    ds_read_b32 v111, v11 offset:7680
    s_waitcnt lgkmcnt(0)
    v_max3_f32 v12, v64, v66, v68
    v_max3_f32 v12, v12, v70, v72
    v_max3_f32 v12, v12, v74, v76
    v_max3_f32 v12, v12, v78, v80
    v_max3_f32 v12, v12, v82, v84
    v_max3_f32 v12, v12, v86, v88
    v_max3_f32 v12, v12, v90, v92
    v_max3_f32 v12, v12, v94, v94
    v_mov_b32 v13, 0
    v_mov_b32 v14, 0
    v_sub_f32 v15, v64, v12
    v_exp_f32 v15, v15
    s_nop 0
    v_fmac_f32 v13, v15, v65
    v_fmac_f32 v14, v15, v96
    v_sub_f32 v15, v66, v12
    v_exp_f32 v15, v15
    s_nop 0
    v_fmac_f32 v13, v15, v67
    v_fmac_f32 v14, v15, v97
    v_sub_f32 v15, v68, v12
    v_exp_f32 v15, v15
    s_nop 0
    v_fmac_f32 v13, v15, v69
    v_fmac_f32 v14, v15, v98
    v_sub_f32 v15, v70, v12
    v_exp_f32 v15, v15
    s_nop 0
    v_fmac_f32 v13, v15, v71
    v_fmac_f32 v14, v15, v99
    v_sub_f32 v15, v72, v12
    v_exp_f32 v15, v15
    s_nop 0
    v_fmac_f32 v13, v15, v73
    v_fmac_f32 v14, v15, v100
    v_sub_f32 v15, v74, v12
    v_exp_f32 v15, v15
    s_nop 0
    v_fmac_f32 v13, v15, v75
    v_fmac_f32 v14, v15, v101
    v_sub_f32 v15, v76, v12
    v_exp_f32 v15, v15
    s_nop 0
    v_fmac_f32 v13, v15, v77
    v_fmac_f32 v14, v15, v102
    v_sub_f32 v15, v78, v12
    v_exp_f32 v15, v15
    s_nop 0
    v_fmac_f32 v13, v15, v79
    v_fmac_f32 v14, v15, v103
    v_sub_f32 v15, v80, v12
    v_exp_f32 v15, v15
    s_nop 0
    v_fmac_f32 v13, v15, v81
    v_fmac_f32 v14, v15, v104
    v_sub_f32 v15, v82, v12
    v_exp_f32 v15, v15
    s_nop 0
    v_fmac_f32 v13, v15, v83
    v_fmac_f32 v14, v15, v105
    v_sub_f32 v15, v84, v12
    v_exp_f32 v15, v15
    s_nop 0
    v_fmac_f32 v13, v15, v85
    v_fmac_f32 v14, v15, v106
    v_sub_f32 v15, v86, v12
    v_exp_f32 v15, v15
    s_nop 0
    v_fmac_f32 v13, v15, v87
    v_fmac_f32 v14, v15, v107
    v_sub_f32 v15, v88, v12
    v_exp_f32 v15, v15
    s_nop 0
    v_fmac_f32 v13, v15, v89
    v_fmac_f32 v14, v15, v108
    v_sub_f32 v15, v90, v12
    v_exp_f32 v15, v15
    s_nop 0
    v_fmac_f32 v13, v15, v91
    v_fmac_f32 v14, v15, v109
    v_sub_f32 v15, v92, v12
    v_exp_f32 v15, v15
    s_nop 0
    v_fmac_f32 v13, v15, v93
    v_fmac_f32 v14, v15, v110
    v_sub_f32 v15, v94, v12
    v_exp_f32 v15, v15
    s_nop 0
    v_fmac_f32 v13, v15, v95
    v_fmac_f32 v14, v15, v111
    s_lshl_b32 s43, s2, 10
    s_add_u32 s43, s43, 262144
    v_lshlrev_b32 v11, 9, v8
    v_lshl_add_u32 v11, v9, 2, v11
    buffer_store_dword v14, v11, s[12:15], s43 offen
    s_lshl_b32 s43, s2, 4
    s_add_u32 s43, s43, 1310720
    v_lshlrev_b32 v10, 3, v8
    v_cmp_eq_u32 vcc, 0, v9
    s_nop 1
    s_and_saveexec_b64 s[46:47], vcc
    buffer_store_dwordx2 v[12:13], v10, s[12:15], s43 offen
    s_mov_b64 exec, s[46:47]
    s_waitcnt vmcnt(0)
L_end_kc_kernel:
    s_endpgm
.globl kd_kernel
.p2align 8
.type kd_kernel,@function
kd_kernel:
    s_cmp_ge_u32 s2, 72
    s_cbranch_scc1 L_end_kd_kernel
    s_load_dwordx2 s[28:29], s[0:1], 32
    s_load_dwordx2 s[36:37], s[0:1], 104
    s_waitcnt lgkmcnt(0)
    s_mov_b32 s40, 477218589
    s_mul_hi_u32 s31, s2, s40
    s_mul_i32 s40, s31, 9
    s_sub_u32 s30, s2, s40
    s_mov_b32 s45, 0
    s_mov_b32 s8, s28
    s_and_b32 s9, s29, 0xffff
    s_mov_b32 s10, 0x480000
    s_mov_b32 s11, 0x20000
    s_mov_b32 s12, s36
    s_and_b32 s13, s37, 0xffff
    s_mov_b32 s14, 0x40000000
    s_mov_b32 s15, 0x20000
    v_and_b32 v1, 63, v0
    v_lshrrev_b32 v2, 6, v0
    v_lshrrev_b32 v3, 3, v1
    v_and_b32 v4, 7, v1
    v_lshl_add_u32 v5, v2, 3, v3
    s_mov_b32 s33, 1152
    v_mul_lo_u32 v6, v5, s33
    v_lshl_add_u32 v6, v4, 4, v6
    v_lshlrev_b32 v7, 5, v5
    s_lshl_b32 s32, s30, 7
    s_mul_i32 s34, s31, 589824
    s_add_u32 s32, s32, s34
    buffer_load_dwordx4 v[128:131], v6, s[8:11], s32 offen
    s_add_u32 s32, s32, 36864
    buffer_load_dwordx4 v[132:135], v6, s[8:11], s32 offen
    s_add_u32 s32, s32, 36864
    buffer_load_dwordx4 v[136:139], v6, s[8:11], s32 offen
    s_add_u32 s32, s32, 36864
    buffer_load_dwordx4 v[140:143], v6, s[8:11], s32 offen
    s_add_u32 s32, s32, 36864
    buffer_load_dwordx4 v[144:147], v6, s[8:11], s32 offen
    s_add_u32 s32, s32, 36864
    buffer_load_dwordx4 v[148:151], v6, s[8:11], s32 offen
    s_add_u32 s32, s32, 36864
    buffer_load_dwordx4 v[152:155], v6, s[8:11], s32 offen
    s_add_u32 s32, s32, 36864
    buffer_load_dwordx4 v[156:159], v6, s[8:11], s32 offen
    s_add_u32 s32, s32, 36864
    buffer_load_dwordx4 v[160:163], v6, s[8:11], s32 offen
    s_add_u32 s32, s32, 36864
    buffer_load_dwordx4 v[164:167], v6, s[8:11], s32 offen
    s_add_u32 s32, s32, 36864
    buffer_load_dwordx4 v[168:171], v6, s[8:11], s32 offen
    s_add_u32 s32, s32, 36864
    buffer_load_dwordx4 v[172:175], v6, s[8:11], s32 offen
    s_add_u32 s32, s32, 36864
    buffer_load_dwordx4 v[176:179], v6, s[8:11], s32 offen
    s_add_u32 s32, s32, 36864
    buffer_load_dwordx4 v[180:183], v6, s[8:11], s32 offen
    s_add_u32 s32, s32, 36864
    buffer_load_dwordx4 v[184:187], v6, s[8:11], s32 offen
    s_add_u32 s32, s32, 36864
    buffer_load_dwordx4 v[188:191], v6, s[8:11], s32 offen
    v_lshrrev_b32 v216, 5, v0
    v_bfe_u32 v217, v0, 3, 2
    v_and_b32 v218, 7, v0
    s_lshl_b32 s40, s31, 2
    v_add_u32 v219, s40, v217
    v_lshrrev_b32 v220, 1, v219
    v_and_b32 v221, 1, v219
    v_lshl_add_u32 v220, v216, 4, v220
    v_lshlrev_b32 v222, 13, v220
    v_lshl_add_u32 v222, v221, 9, v222
    v_lshl_add_u32 v222, v218, 6, v222
    v_add_u32 v222, 262144, v222
    v_add_u32 v223, 4096, v222
    v_lshlrev_b32 v215, 7, v220
    v_lshl_add_u32 v215, v221, 3, v215
    v_add_u32 v215, 1310720, v215
    buffer_load_dwordx4 v[64:67], v222, s[12:15], 0 offen offset:0
    buffer_load_dwordx4 v[68:71], v222, s[12:15], 0 offen offset:16
    buffer_load_dwordx4 v[72:75], v222, s[12:15], 0 offen offset:32
    buffer_load_dwordx4 v[76:79], v222, s[12:15], 0 offen offset:48
    buffer_load_dwordx2 v[8:9], v215, s[12:15], 0 offen offset:0
    buffer_load_dwordx4 v[80:83], v222, s[12:15], 0 offen offset:1024
    buffer_load_dwordx4 v[84:87], v222, s[12:15], 0 offen offset:1040
    buffer_load_dwordx4 v[88:91], v222, s[12:15], 0 offen offset:1056
    buffer_load_dwordx4 v[92:95], v222, s[12:15], 0 offen offset:1072
    buffer_load_dwordx2 v[10:11], v215, s[12:15], 0 offen offset:16
    buffer_load_dwordx4 v[96:99], v222, s[12:15], 0 offen offset:2048
    buffer_load_dwordx4 v[100:103], v222, s[12:15], 0 offen offset:2064
    buffer_load_dwordx4 v[104:107], v222, s[12:15], 0 offen offset:2080
    buffer_load_dwordx4 v[108:111], v222, s[12:15], 0 offen offset:2096
    buffer_load_dwordx2 v[12:13], v215, s[12:15], 0 offen offset:32
    buffer_load_dwordx4 v[112:115], v222, s[12:15], 0 offen offset:3072
    buffer_load_dwordx4 v[116:119], v222, s[12:15], 0 offen offset:3088
    buffer_load_dwordx4 v[120:123], v222, s[12:15], 0 offen offset:3104
    buffer_load_dwordx4 v[124:127], v222, s[12:15], 0 offen offset:3120
    buffer_load_dwordx2 v[14:15], v215, s[12:15], 0 offen offset:48
    buffer_load_dwordx4 v[192:195], v223, s[12:15], 0 offen offset:0
    buffer_load_dwordx4 v[196:199], v223, s[12:15], 0 offen offset:16
    buffer_load_dwordx4 v[200:203], v223, s[12:15], 0 offen offset:32
    buffer_load_dwordx4 v[204:207], v223, s[12:15], 0 offen offset:48
    buffer_load_dwordx2 v[16:17], v215, s[12:15], 0 offen offset:64
    buffer_load_dwordx4 v[208:211], v223, s[12:15], 0 offen offset:1024
    buffer_load_dwordx4 v[212:215], v223, s[12:15], 0 offen offset:1040
    buffer_load_dwordx4 v[216:219], v223, s[12:15], 0 offen offset:1056
    buffer_load_dwordx4 v[220:223], v223, s[12:15], 0 offen offset:1072
    buffer_load_dwordx2 v[18:19], v215, s[12:15], 0 offen offset:80
    buffer_load_dwordx4 v[224:227], v223, s[12:15], 0 offen offset:2048
    buffer_load_dwordx4 v[228:231], v223, s[12:15], 0 offen offset:2064
    buffer_load_dwordx4 v[232:235], v223, s[12:15], 0 offen offset:2080
    buffer_load_dwordx4 v[236:239], v223, s[12:15], 0 offen offset:2096
    buffer_load_dwordx2 v[20:21], v215, s[12:15], 0 offen offset:96
    buffer_load_dwordx4 v[240:243], v223, s[12:15], 0 offen offset:3072
    buffer_load_dwordx4 v[244:247], v223, s[12:15], 0 offen offset:3088
    buffer_load_dwordx4 v[248:251], v223, s[12:15], 0 offen offset:3104
    buffer_load_dwordx4 v[252:255], v223, s[12:15], 0 offen offset:3120
    buffer_load_dwordx2 v[22:23], v215, s[12:15], 0 offen offset:112
    v_lshlrev_b32 v24, 12, v217
    v_lshl_add_u32 v24, v218, 9, v24
    v_lshl_add_u32 v24, v216, 2, v24
    s_waitcnt vmcnt(0)
    v_max3_f32 v25, v8, v10, v12
    v_max3_f32 v25, v25, v14, v16
    v_max3_f32 v25, v25, v18, v20
    v_max_f32 v25, v25, v22
    v_mov_b32 v26, 0
    v_sub_f32 v8, v8, v25
    v_exp_f32 v8, v8
    s_nop 0
    v_fmac_f32 v26, v8, v9
    v_sub_f32 v10, v10, v25
    v_exp_f32 v10, v10
    s_nop 0
    v_fmac_f32 v26, v10, v11
    v_sub_f32 v12, v12, v25
    v_exp_f32 v12, v12
    s_nop 0
    v_fmac_f32 v26, v12, v13
    v_sub_f32 v14, v14, v25
    v_exp_f32 v14, v14
    s_nop 0
    v_fmac_f32 v26, v14, v15
    v_sub_f32 v16, v16, v25
    v_exp_f32 v16, v16
    s_nop 0
    v_fmac_f32 v26, v16, v17
    v_sub_f32 v18, v18, v25
    v_exp_f32 v18, v18
    s_nop 0
    v_fmac_f32 v26, v18, v19
    v_sub_f32 v20, v20, v25
    v_exp_f32 v20, v20
    s_nop 0
    v_fmac_f32 v26, v20, v21
    v_sub_f32 v22, v22, v25
    v_exp_f32 v22, v22
    s_nop 0
    v_fmac_f32 v26, v22, v23
    v_rcp_f32 v26, v26
    v_mul_f32 v27, v8, v64
    v_fmac_f32 v27, v10, v80
    v_fmac_f32 v27, v12, v96
    v_fmac_f32 v27, v14, v112
    v_fmac_f32 v27, v16, v192
    v_fmac_f32 v27, v18, v208
    v_fmac_f32 v27, v20, v224
    v_fmac_f32 v27, v22, v240
    v_mul_f32 v28, v27, v26
    ds_write_b32 v24, v28 offset:0
    v_mul_f32 v27, v8, v65
    v_fmac_f32 v27, v10, v81
    v_fmac_f32 v27, v12, v97
    v_fmac_f32 v27, v14, v113
    v_fmac_f32 v27, v16, v193
    v_fmac_f32 v27, v18, v209
    v_fmac_f32 v27, v20, v225
    v_fmac_f32 v27, v22, v241
    v_mul_f32 v29, v27, v26
    ds_write_b32 v24, v29 offset:32
    v_mul_f32 v27, v8, v66
    v_fmac_f32 v27, v10, v82
    v_fmac_f32 v27, v12, v98
    v_fmac_f32 v27, v14, v114
    v_fmac_f32 v27, v16, v194
    v_fmac_f32 v27, v18, v210
    v_fmac_f32 v27, v20, v226
    v_fmac_f32 v27, v22, v242
    v_mul_f32 v30, v27, v26
    ds_write_b32 v24, v30 offset:64
    v_mul_f32 v27, v8, v67
    v_fmac_f32 v27, v10, v83
    v_fmac_f32 v27, v12, v99
    v_fmac_f32 v27, v14, v115
    v_fmac_f32 v27, v16, v195
    v_fmac_f32 v27, v18, v211
    v_fmac_f32 v27, v20, v227
    v_fmac_f32 v27, v22, v243
    v_mul_f32 v31, v27, v26
    ds_write_b32 v24, v31 offset:96
    v_mul_f32 v27, v8, v68
    v_fmac_f32 v27, v10, v84
    v_fmac_f32 v27, v12, v100
    v_fmac_f32 v27, v14, v116
    v_fmac_f32 v27, v16, v196
    v_fmac_f32 v27, v18, v212
    v_fmac_f32 v27, v20, v228
    v_fmac_f32 v27, v22, v244
    v_mul_f32 v32, v27, v26
    ds_write_b32 v24, v32 offset:128
    v_mul_f32 v27, v8, v69
    v_fmac_f32 v27, v10, v85
    v_fmac_f32 v27, v12, v101
    v_fmac_f32 v27, v14, v117
    v_fmac_f32 v27, v16, v197
    v_fmac_f32 v27, v18, v213
    v_fmac_f32 v27, v20, v229
    v_fmac_f32 v27, v22, v245
    v_mul_f32 v33, v27, v26
    ds_write_b32 v24, v33 offset:160
    v_mul_f32 v27, v8, v70
    v_fmac_f32 v27, v10, v86
    v_fmac_f32 v27, v12, v102
    v_fmac_f32 v27, v14, v118
    v_fmac_f32 v27, v16, v198
    v_fmac_f32 v27, v18, v214
    v_fmac_f32 v27, v20, v230
    v_fmac_f32 v27, v22, v246
    v_mul_f32 v34, v27, v26
    ds_write_b32 v24, v34 offset:192
    v_mul_f32 v27, v8, v71
    v_fmac_f32 v27, v10, v87
    v_fmac_f32 v27, v12, v103
    v_fmac_f32 v27, v14, v119
    v_fmac_f32 v27, v16, v199
    v_fmac_f32 v27, v18, v215
    v_fmac_f32 v27, v20, v231
    v_fmac_f32 v27, v22, v247
    v_mul_f32 v35, v27, v26
    ds_write_b32 v24, v35 offset:224
    v_mul_f32 v27, v8, v72
    v_fmac_f32 v27, v10, v88
    v_fmac_f32 v27, v12, v104
    v_fmac_f32 v27, v14, v120
    v_fmac_f32 v27, v16, v200
    v_fmac_f32 v27, v18, v216
    v_fmac_f32 v27, v20, v232
    v_fmac_f32 v27, v22, v248
    v_mul_f32 v36, v27, v26
    ds_write_b32 v24, v36 offset:256
    v_mul_f32 v27, v8, v73
    v_fmac_f32 v27, v10, v89
    v_fmac_f32 v27, v12, v105
    v_fmac_f32 v27, v14, v121
    v_fmac_f32 v27, v16, v201
    v_fmac_f32 v27, v18, v217
    v_fmac_f32 v27, v20, v233
    v_fmac_f32 v27, v22, v249
    v_mul_f32 v37, v27, v26
    ds_write_b32 v24, v37 offset:288
    v_mul_f32 v27, v8, v74
    v_fmac_f32 v27, v10, v90
    v_fmac_f32 v27, v12, v106
    v_fmac_f32 v27, v14, v122
    v_fmac_f32 v27, v16, v202
    v_fmac_f32 v27, v18, v218
    v_fmac_f32 v27, v20, v234
    v_fmac_f32 v27, v22, v250
    v_mul_f32 v38, v27, v26
    ds_write_b32 v24, v38 offset:320
    v_mul_f32 v27, v8, v75
    v_fmac_f32 v27, v10, v91
    v_fmac_f32 v27, v12, v107
    v_fmac_f32 v27, v14, v123
    v_fmac_f32 v27, v16, v203
    v_fmac_f32 v27, v18, v219
    v_fmac_f32 v27, v20, v235
    v_fmac_f32 v27, v22, v251
    v_mul_f32 v39, v27, v26
    ds_write_b32 v24, v39 offset:352
    v_mul_f32 v27, v8, v76
    v_fmac_f32 v27, v10, v92
    v_fmac_f32 v27, v12, v108
    v_fmac_f32 v27, v14, v124
    v_fmac_f32 v27, v16, v204
    v_fmac_f32 v27, v18, v220
    v_fmac_f32 v27, v20, v236
    v_fmac_f32 v27, v22, v252
    v_mul_f32 v40, v27, v26
    ds_write_b32 v24, v40 offset:384
    v_mul_f32 v27, v8, v77
    v_fmac_f32 v27, v10, v93
    v_fmac_f32 v27, v12, v109
    v_fmac_f32 v27, v14, v125
    v_fmac_f32 v27, v16, v205
    v_fmac_f32 v27, v18, v221
    v_fmac_f32 v27, v20, v237
    v_fmac_f32 v27, v22, v253
    v_mul_f32 v41, v27, v26
    ds_write_b32 v24, v41 offset:416
    v_mul_f32 v27, v8, v78
    v_fmac_f32 v27, v10, v94
    v_fmac_f32 v27, v12, v110
    v_fmac_f32 v27, v14, v126
    v_fmac_f32 v27, v16, v206
    v_fmac_f32 v27, v18, v222
    v_fmac_f32 v27, v20, v238
    v_fmac_f32 v27, v22, v254
    v_mul_f32 v42, v27, v26
    ds_write_b32 v24, v42 offset:448
    v_mul_f32 v27, v8, v79
    v_fmac_f32 v27, v10, v95
    v_fmac_f32 v27, v12, v111
    v_fmac_f32 v27, v14, v127
    v_fmac_f32 v27, v16, v207
    v_fmac_f32 v27, v18, v223
    v_fmac_f32 v27, v20, v239
    v_fmac_f32 v27, v22, v255
    v_mul_f32 v43, v27, v26
    ds_write_b32 v24, v43 offset:480
    s_waitcnt vmcnt(0) lgkmcnt(0)
    s_barrier
    v_mov_b32 v64, 0
    v_mov_b32 v65, 0
    v_mov_b32 v66, 0
    v_mov_b32 v67, 0
    v_mov_b32 v68, 0
    v_mov_b32 v69, 0
    v_mov_b32 v70, 0
    v_mov_b32 v71, 0
    v_mov_b32 v72, 0
    v_mov_b32 v73, 0
    v_mov_b32 v74, 0
    v_mov_b32 v75, 0
    v_mov_b32 v76, 0
    v_mov_b32 v77, 0
    v_mov_b32 v78, 0
    v_mov_b32 v79, 0
    v_mov_b32 v80, 0
    v_mov_b32 v81, 0
    v_mov_b32 v82, 0
    v_mov_b32 v83, 0
    v_mov_b32 v84, 0
    v_mov_b32 v85, 0
    v_mov_b32 v86, 0
    v_mov_b32 v87, 0
    v_mov_b32 v88, 0
    v_mov_b32 v89, 0
    v_mov_b32 v90, 0
    v_mov_b32 v91, 0
    v_mov_b32 v92, 0
    v_mov_b32 v93, 0
    v_mov_b32 v94, 0
    v_mov_b32 v95, 0
    v_mov_b32 v96, 0
    v_mov_b32 v97, 0
    v_mov_b32 v98, 0
    v_mov_b32 v99, 0
    v_mov_b32 v100, 0
    v_mov_b32 v101, 0
    v_mov_b32 v102, 0
    v_mov_b32 v103, 0
    v_mov_b32 v104, 0
    v_mov_b32 v105, 0
    v_mov_b32 v106, 0
    v_mov_b32 v107, 0
    v_mov_b32 v108, 0
    v_mov_b32 v109, 0
    v_mov_b32 v110, 0
    v_mov_b32 v111, 0
    v_mov_b32 v112, 0
    v_mov_b32 v113, 0
    v_mov_b32 v114, 0
    v_mov_b32 v115, 0
    v_mov_b32 v116, 0
    v_mov_b32 v117, 0
    v_mov_b32 v118, 0
    v_mov_b32 v119, 0
    v_mov_b32 v120, 0
    v_mov_b32 v121, 0
    v_mov_b32 v122, 0
    v_mov_b32 v123, 0
    v_mov_b32 v124, 0
    v_mov_b32 v125, 0
    v_mov_b32 v126, 0
    v_mov_b32 v127, 0
    ds_read_b128 v[200:203], v7 offset:0
    ds_read_b128 v[204:207], v7 offset:16
    v_lshlrev_b32 v208, 16, v128
    v_and_b32 v209, 0xffff0000, v128
    v_lshlrev_b32 v210, 16, v129
    v_and_b32 v211, 0xffff0000, v129
    v_lshlrev_b32 v212, 16, v130
    v_and_b32 v213, 0xffff0000, v130
    v_lshlrev_b32 v214, 16, v131
    v_and_b32 v215, 0xffff0000, v131
    s_waitcnt lgkmcnt(0)
    v_fmac_f32 v64, v200, v208
    v_fmac_f32 v65, v200, v209
    v_fmac_f32 v66, v200, v210
    v_fmac_f32 v67, v200, v211
    v_fmac_f32 v68, v200, v212
    v_fmac_f32 v69, v200, v213
    v_fmac_f32 v70, v200, v214
    v_fmac_f32 v71, v200, v215
    v_fmac_f32 v72, v201, v208
    v_fmac_f32 v73, v201, v209
    v_fmac_f32 v74, v201, v210
    v_fmac_f32 v75, v201, v211
    v_fmac_f32 v76, v201, v212
    v_fmac_f32 v77, v201, v213
    v_fmac_f32 v78, v201, v214
    v_fmac_f32 v79, v201, v215
    v_fmac_f32 v80, v202, v208
    v_fmac_f32 v81, v202, v209
    v_fmac_f32 v82, v202, v210
    v_fmac_f32 v83, v202, v211
    v_fmac_f32 v84, v202, v212
    v_fmac_f32 v85, v202, v213
    v_fmac_f32 v86, v202, v214
    v_fmac_f32 v87, v202, v215
    v_fmac_f32 v88, v203, v208
    v_fmac_f32 v89, v203, v209
    v_fmac_f32 v90, v203, v210
    v_fmac_f32 v91, v203, v211
    v_fmac_f32 v92, v203, v212
    v_fmac_f32 v93, v203, v213
    v_fmac_f32 v94, v203, v214
    v_fmac_f32 v95, v203, v215
    v_fmac_f32 v96, v204, v208
    v_fmac_f32 v97, v204, v209
    v_fmac_f32 v98, v204, v210
    v_fmac_f32 v99, v204, v211
    v_fmac_f32 v100, v204, v212
    v_fmac_f32 v101, v204, v213
    v_fmac_f32 v102, v204, v214
    v_fmac_f32 v103, v204, v215
    v_fmac_f32 v104, v205, v208
    v_fmac_f32 v105, v205, v209
    v_fmac_f32 v106, v205, v210
    v_fmac_f32 v107, v205, v211
    v_fmac_f32 v108, v205, v212
    v_fmac_f32 v109, v205, v213
    v_fmac_f32 v110, v205, v214
    v_fmac_f32 v111, v205, v215
    v_fmac_f32 v112, v206, v208
    v_fmac_f32 v113, v206, v209
    v_fmac_f32 v114, v206, v210
    v_fmac_f32 v115, v206, v211
    v_fmac_f32 v116, v206, v212
    v_fmac_f32 v117, v206, v213
    v_fmac_f32 v118, v206, v214
    v_fmac_f32 v119, v206, v215
    v_fmac_f32 v120, v207, v208
    v_fmac_f32 v121, v207, v209
    v_fmac_f32 v122, v207, v210
    v_fmac_f32 v123, v207, v211
    v_fmac_f32 v124, v207, v212
    v_fmac_f32 v125, v207, v213
    v_fmac_f32 v126, v207, v214
    v_fmac_f32 v127, v207, v215
    ds_read_b128 v[200:203], v7 offset:1024
    ds_read_b128 v[204:207], v7 offset:1040
    v_lshlrev_b32 v208, 16, v132
    v_and_b32 v209, 0xffff0000, v132
    v_lshlrev_b32 v210, 16, v133
    v_and_b32 v211, 0xffff0000, v133
    v_lshlrev_b32 v212, 16, v134
    v_and_b32 v213, 0xffff0000, v134
    v_lshlrev_b32 v214, 16, v135
    v_and_b32 v215, 0xffff0000, v135
    s_waitcnt lgkmcnt(0)
    v_fmac_f32 v64, v200, v208
    v_fmac_f32 v65, v200, v209
    v_fmac_f32 v66, v200, v210
    v_fmac_f32 v67, v200, v211
    v_fmac_f32 v68, v200, v212
    v_fmac_f32 v69, v200, v213
    v_fmac_f32 v70, v200, v214
    v_fmac_f32 v71, v200, v215
    v_fmac_f32 v72, v201, v208
    v_fmac_f32 v73, v201, v209
    v_fmac_f32 v74, v201, v210
    v_fmac_f32 v75, v201, v211
    v_fmac_f32 v76, v201, v212
    v_fmac_f32 v77, v201, v213
    v_fmac_f32 v78, v201, v214
    v_fmac_f32 v79, v201, v215
    v_fmac_f32 v80, v202, v208
    v_fmac_f32 v81, v202, v209
    v_fmac_f32 v82, v202, v210
    v_fmac_f32 v83, v202, v211
    v_fmac_f32 v84, v202, v212
    v_fmac_f32 v85, v202, v213
    v_fmac_f32 v86, v202, v214
    v_fmac_f32 v87, v202, v215
    v_fmac_f32 v88, v203, v208
    v_fmac_f32 v89, v203, v209
    v_fmac_f32 v90, v203, v210
    v_fmac_f32 v91, v203, v211
    v_fmac_f32 v92, v203, v212
    v_fmac_f32 v93, v203, v213
    v_fmac_f32 v94, v203, v214
    v_fmac_f32 v95, v203, v215
    v_fmac_f32 v96, v204, v208
    v_fmac_f32 v97, v204, v209
    v_fmac_f32 v98, v204, v210
    v_fmac_f32 v99, v204, v211
    v_fmac_f32 v100, v204, v212
    v_fmac_f32 v101, v204, v213
    v_fmac_f32 v102, v204, v214
    v_fmac_f32 v103, v204, v215
    v_fmac_f32 v104, v205, v208
    v_fmac_f32 v105, v205, v209
    v_fmac_f32 v106, v205, v210
    v_fmac_f32 v107, v205, v211
    v_fmac_f32 v108, v205, v212
    v_fmac_f32 v109, v205, v213
    v_fmac_f32 v110, v205, v214
    v_fmac_f32 v111, v205, v215
    v_fmac_f32 v112, v206, v208
    v_fmac_f32 v113, v206, v209
    v_fmac_f32 v114, v206, v210
    v_fmac_f32 v115, v206, v211
    v_fmac_f32 v116, v206, v212
    v_fmac_f32 v117, v206, v213
    v_fmac_f32 v118, v206, v214
    v_fmac_f32 v119, v206, v215
    v_fmac_f32 v120, v207, v208
    v_fmac_f32 v121, v207, v209
    v_fmac_f32 v122, v207, v210
    v_fmac_f32 v123, v207, v211
    v_fmac_f32 v124, v207, v212
    v_fmac_f32 v125, v207, v213
    v_fmac_f32 v126, v207, v214
    v_fmac_f32 v127, v207, v215
    ds_read_b128 v[200:203], v7 offset:2048
    ds_read_b128 v[204:207], v7 offset:2064
    v_lshlrev_b32 v208, 16, v136
    v_and_b32 v209, 0xffff0000, v136
    v_lshlrev_b32 v210, 16, v137
    v_and_b32 v211, 0xffff0000, v137
    v_lshlrev_b32 v212, 16, v138
    v_and_b32 v213, 0xffff0000, v138
    v_lshlrev_b32 v214, 16, v139
    v_and_b32 v215, 0xffff0000, v139
    s_waitcnt lgkmcnt(0)
    v_fmac_f32 v64, v200, v208
    v_fmac_f32 v65, v200, v209
    v_fmac_f32 v66, v200, v210
    v_fmac_f32 v67, v200, v211
    v_fmac_f32 v68, v200, v212
    v_fmac_f32 v69, v200, v213
    v_fmac_f32 v70, v200, v214
    v_fmac_f32 v71, v200, v215
    v_fmac_f32 v72, v201, v208
    v_fmac_f32 v73, v201, v209
    v_fmac_f32 v74, v201, v210
    v_fmac_f32 v75, v201, v211
    v_fmac_f32 v76, v201, v212
    v_fmac_f32 v77, v201, v213
    v_fmac_f32 v78, v201, v214
    v_fmac_f32 v79, v201, v215
    v_fmac_f32 v80, v202, v208
    v_fmac_f32 v81, v202, v209
    v_fmac_f32 v82, v202, v210
    v_fmac_f32 v83, v202, v211
    v_fmac_f32 v84, v202, v212
    v_fmac_f32 v85, v202, v213
    v_fmac_f32 v86, v202, v214
    v_fmac_f32 v87, v202, v215
    v_fmac_f32 v88, v203, v208
    v_fmac_f32 v89, v203, v209
    v_fmac_f32 v90, v203, v210
    v_fmac_f32 v91, v203, v211
    v_fmac_f32 v92, v203, v212
    v_fmac_f32 v93, v203, v213
    v_fmac_f32 v94, v203, v214
    v_fmac_f32 v95, v203, v215
    v_fmac_f32 v96, v204, v208
    v_fmac_f32 v97, v204, v209
    v_fmac_f32 v98, v204, v210
    v_fmac_f32 v99, v204, v211
    v_fmac_f32 v100, v204, v212
    v_fmac_f32 v101, v204, v213
    v_fmac_f32 v102, v204, v214
    v_fmac_f32 v103, v204, v215
    v_fmac_f32 v104, v205, v208
    v_fmac_f32 v105, v205, v209
    v_fmac_f32 v106, v205, v210
    v_fmac_f32 v107, v205, v211
    v_fmac_f32 v108, v205, v212
    v_fmac_f32 v109, v205, v213
    v_fmac_f32 v110, v205, v214
    v_fmac_f32 v111, v205, v215
    v_fmac_f32 v112, v206, v208
    v_fmac_f32 v113, v206, v209
    v_fmac_f32 v114, v206, v210
    v_fmac_f32 v115, v206, v211
    v_fmac_f32 v116, v206, v212
    v_fmac_f32 v117, v206, v213
    v_fmac_f32 v118, v206, v214
    v_fmac_f32 v119, v206, v215
    v_fmac_f32 v120, v207, v208
    v_fmac_f32 v121, v207, v209
    v_fmac_f32 v122, v207, v210
    v_fmac_f32 v123, v207, v211
    v_fmac_f32 v124, v207, v212
    v_fmac_f32 v125, v207, v213
    v_fmac_f32 v126, v207, v214
    v_fmac_f32 v127, v207, v215
    ds_read_b128 v[200:203], v7 offset:3072
    ds_read_b128 v[204:207], v7 offset:3088
    v_lshlrev_b32 v208, 16, v140
    v_and_b32 v209, 0xffff0000, v140
    v_lshlrev_b32 v210, 16, v141
    v_and_b32 v211, 0xffff0000, v141
    v_lshlrev_b32 v212, 16, v142
    v_and_b32 v213, 0xffff0000, v142
    v_lshlrev_b32 v214, 16, v143
    v_and_b32 v215, 0xffff0000, v143
    s_waitcnt lgkmcnt(0)
    v_fmac_f32 v64, v200, v208
    v_fmac_f32 v65, v200, v209
    v_fmac_f32 v66, v200, v210
    v_fmac_f32 v67, v200, v211
    v_fmac_f32 v68, v200, v212
    v_fmac_f32 v69, v200, v213
    v_fmac_f32 v70, v200, v214
    v_fmac_f32 v71, v200, v215
    v_fmac_f32 v72, v201, v208
    v_fmac_f32 v73, v201, v209
    v_fmac_f32 v74, v201, v210
    v_fmac_f32 v75, v201, v211
    v_fmac_f32 v76, v201, v212
    v_fmac_f32 v77, v201, v213
    v_fmac_f32 v78, v201, v214
    v_fmac_f32 v79, v201, v215
    v_fmac_f32 v80, v202, v208
    v_fmac_f32 v81, v202, v209
    v_fmac_f32 v82, v202, v210
    v_fmac_f32 v83, v202, v211
    v_fmac_f32 v84, v202, v212
    v_fmac_f32 v85, v202, v213
    v_fmac_f32 v86, v202, v214
    v_fmac_f32 v87, v202, v215
    v_fmac_f32 v88, v203, v208
    v_fmac_f32 v89, v203, v209
    v_fmac_f32 v90, v203, v210
    v_fmac_f32 v91, v203, v211
    v_fmac_f32 v92, v203, v212
    v_fmac_f32 v93, v203, v213
    v_fmac_f32 v94, v203, v214
    v_fmac_f32 v95, v203, v215
    v_fmac_f32 v96, v204, v208
    v_fmac_f32 v97, v204, v209
    v_fmac_f32 v98, v204, v210
    v_fmac_f32 v99, v204, v211
    v_fmac_f32 v100, v204, v212
    v_fmac_f32 v101, v204, v213
    v_fmac_f32 v102, v204, v214
    v_fmac_f32 v103, v204, v215
    v_fmac_f32 v104, v205, v208
    v_fmac_f32 v105, v205, v209
    v_fmac_f32 v106, v205, v210
    v_fmac_f32 v107, v205, v211
    v_fmac_f32 v108, v205, v212
    v_fmac_f32 v109, v205, v213
    v_fmac_f32 v110, v205, v214
    v_fmac_f32 v111, v205, v215
    v_fmac_f32 v112, v206, v208
    v_fmac_f32 v113, v206, v209
    v_fmac_f32 v114, v206, v210
    v_fmac_f32 v115, v206, v211
    v_fmac_f32 v116, v206, v212
    v_fmac_f32 v117, v206, v213
    v_fmac_f32 v118, v206, v214
    v_fmac_f32 v119, v206, v215
    v_fmac_f32 v120, v207, v208
    v_fmac_f32 v121, v207, v209
    v_fmac_f32 v122, v207, v210
    v_fmac_f32 v123, v207, v211
    v_fmac_f32 v124, v207, v212
    v_fmac_f32 v125, v207, v213
    v_fmac_f32 v126, v207, v214
    v_fmac_f32 v127, v207, v215
    ds_read_b128 v[200:203], v7 offset:4096
    ds_read_b128 v[204:207], v7 offset:4112
    v_lshlrev_b32 v208, 16, v144
    v_and_b32 v209, 0xffff0000, v144
    v_lshlrev_b32 v210, 16, v145
    v_and_b32 v211, 0xffff0000, v145
    v_lshlrev_b32 v212, 16, v146
    v_and_b32 v213, 0xffff0000, v146
    v_lshlrev_b32 v214, 16, v147
    v_and_b32 v215, 0xffff0000, v147
    s_waitcnt lgkmcnt(0)
    v_fmac_f32 v64, v200, v208
    v_fmac_f32 v65, v200, v209
    v_fmac_f32 v66, v200, v210
    v_fmac_f32 v67, v200, v211
    v_fmac_f32 v68, v200, v212
    v_fmac_f32 v69, v200, v213
    v_fmac_f32 v70, v200, v214
    v_fmac_f32 v71, v200, v215
    v_fmac_f32 v72, v201, v208
    v_fmac_f32 v73, v201, v209
    v_fmac_f32 v74, v201, v210
    v_fmac_f32 v75, v201, v211
    v_fmac_f32 v76, v201, v212
    v_fmac_f32 v77, v201, v213
    v_fmac_f32 v78, v201, v214
    v_fmac_f32 v79, v201, v215
    v_fmac_f32 v80, v202, v208
    v_fmac_f32 v81, v202, v209
    v_fmac_f32 v82, v202, v210
    v_fmac_f32 v83, v202, v211
    v_fmac_f32 v84, v202, v212
    v_fmac_f32 v85, v202, v213
    v_fmac_f32 v86, v202, v214
    v_fmac_f32 v87, v202, v215
    v_fmac_f32 v88, v203, v208
    v_fmac_f32 v89, v203, v209
    v_fmac_f32 v90, v203, v210
    v_fmac_f32 v91, v203, v211
    v_fmac_f32 v92, v203, v212
    v_fmac_f32 v93, v203, v213
    v_fmac_f32 v94, v203, v214
    v_fmac_f32 v95, v203, v215
    v_fmac_f32 v96, v204, v208
    v_fmac_f32 v97, v204, v209
    v_fmac_f32 v98, v204, v210
    v_fmac_f32 v99, v204, v211
    v_fmac_f32 v100, v204, v212
    v_fmac_f32 v101, v204, v213
    v_fmac_f32 v102, v204, v214
    v_fmac_f32 v103, v204, v215
    v_fmac_f32 v104, v205, v208
    v_fmac_f32 v105, v205, v209
    v_fmac_f32 v106, v205, v210
    v_fmac_f32 v107, v205, v211
    v_fmac_f32 v108, v205, v212
    v_fmac_f32 v109, v205, v213
    v_fmac_f32 v110, v205, v214
    v_fmac_f32 v111, v205, v215
    v_fmac_f32 v112, v206, v208
    v_fmac_f32 v113, v206, v209
    v_fmac_f32 v114, v206, v210
    v_fmac_f32 v115, v206, v211
    v_fmac_f32 v116, v206, v212
    v_fmac_f32 v117, v206, v213
    v_fmac_f32 v118, v206, v214
    v_fmac_f32 v119, v206, v215
    v_fmac_f32 v120, v207, v208
    v_fmac_f32 v121, v207, v209
    v_fmac_f32 v122, v207, v210
    v_fmac_f32 v123, v207, v211
    v_fmac_f32 v124, v207, v212
    v_fmac_f32 v125, v207, v213
    v_fmac_f32 v126, v207, v214
    v_fmac_f32 v127, v207, v215
    ds_read_b128 v[200:203], v7 offset:5120
    ds_read_b128 v[204:207], v7 offset:5136
    v_lshlrev_b32 v208, 16, v148
    v_and_b32 v209, 0xffff0000, v148
    v_lshlrev_b32 v210, 16, v149
    v_and_b32 v211, 0xffff0000, v149
    v_lshlrev_b32 v212, 16, v150
    v_and_b32 v213, 0xffff0000, v150
    v_lshlrev_b32 v214, 16, v151
    v_and_b32 v215, 0xffff0000, v151
    s_waitcnt lgkmcnt(0)
    v_fmac_f32 v64, v200, v208
    v_fmac_f32 v65, v200, v209
    v_fmac_f32 v66, v200, v210
    v_fmac_f32 v67, v200, v211
    v_fmac_f32 v68, v200, v212
    v_fmac_f32 v69, v200, v213
    v_fmac_f32 v70, v200, v214
    v_fmac_f32 v71, v200, v215
    v_fmac_f32 v72, v201, v208
    v_fmac_f32 v73, v201, v209
    v_fmac_f32 v74, v201, v210
    v_fmac_f32 v75, v201, v211
    v_fmac_f32 v76, v201, v212
    v_fmac_f32 v77, v201, v213
    v_fmac_f32 v78, v201, v214
    v_fmac_f32 v79, v201, v215
    v_fmac_f32 v80, v202, v208
    v_fmac_f32 v81, v202, v209
    v_fmac_f32 v82, v202, v210
    v_fmac_f32 v83, v202, v211
    v_fmac_f32 v84, v202, v212
    v_fmac_f32 v85, v202, v213
    v_fmac_f32 v86, v202, v214
    v_fmac_f32 v87, v202, v215
    v_fmac_f32 v88, v203, v208
    v_fmac_f32 v89, v203, v209
    v_fmac_f32 v90, v203, v210
    v_fmac_f32 v91, v203, v211
    v_fmac_f32 v92, v203, v212
    v_fmac_f32 v93, v203, v213
    v_fmac_f32 v94, v203, v214
    v_fmac_f32 v95, v203, v215
    v_fmac_f32 v96, v204, v208
    v_fmac_f32 v97, v204, v209
    v_fmac_f32 v98, v204, v210
    v_fmac_f32 v99, v204, v211
    v_fmac_f32 v100, v204, v212
    v_fmac_f32 v101, v204, v213
    v_fmac_f32 v102, v204, v214
    v_fmac_f32 v103, v204, v215
    v_fmac_f32 v104, v205, v208
    v_fmac_f32 v105, v205, v209
    v_fmac_f32 v106, v205, v210
    v_fmac_f32 v107, v205, v211
    v_fmac_f32 v108, v205, v212
    v_fmac_f32 v109, v205, v213
    v_fmac_f32 v110, v205, v214
    v_fmac_f32 v111, v205, v215
    v_fmac_f32 v112, v206, v208
    v_fmac_f32 v113, v206, v209
    v_fmac_f32 v114, v206, v210
    v_fmac_f32 v115, v206, v211
    v_fmac_f32 v116, v206, v212
    v_fmac_f32 v117, v206, v213
    v_fmac_f32 v118, v206, v214
    v_fmac_f32 v119, v206, v215
    v_fmac_f32 v120, v207, v208
    v_fmac_f32 v121, v207, v209
    v_fmac_f32 v122, v207, v210
    v_fmac_f32 v123, v207, v211
    v_fmac_f32 v124, v207, v212
    v_fmac_f32 v125, v207, v213
    v_fmac_f32 v126, v207, v214
    v_fmac_f32 v127, v207, v215
    ds_read_b128 v[200:203], v7 offset:6144
    ds_read_b128 v[204:207], v7 offset:6160
    v_lshlrev_b32 v208, 16, v152
    v_and_b32 v209, 0xffff0000, v152
    v_lshlrev_b32 v210, 16, v153
    v_and_b32 v211, 0xffff0000, v153
    v_lshlrev_b32 v212, 16, v154
    v_and_b32 v213, 0xffff0000, v154
    v_lshlrev_b32 v214, 16, v155
    v_and_b32 v215, 0xffff0000, v155
    s_waitcnt lgkmcnt(0)
    v_fmac_f32 v64, v200, v208
    v_fmac_f32 v65, v200, v209
    v_fmac_f32 v66, v200, v210
    v_fmac_f32 v67, v200, v211
    v_fmac_f32 v68, v200, v212
    v_fmac_f32 v69, v200, v213
    v_fmac_f32 v70, v200, v214
    v_fmac_f32 v71, v200, v215
    v_fmac_f32 v72, v201, v208
    v_fmac_f32 v73, v201, v209
    v_fmac_f32 v74, v201, v210
    v_fmac_f32 v75, v201, v211
    v_fmac_f32 v76, v201, v212
    v_fmac_f32 v77, v201, v213
    v_fmac_f32 v78, v201, v214
    v_fmac_f32 v79, v201, v215
    v_fmac_f32 v80, v202, v208
    v_fmac_f32 v81, v202, v209
    v_fmac_f32 v82, v202, v210
    v_fmac_f32 v83, v202, v211
    v_fmac_f32 v84, v202, v212
    v_fmac_f32 v85, v202, v213
    v_fmac_f32 v86, v202, v214
    v_fmac_f32 v87, v202, v215
    v_fmac_f32 v88, v203, v208
    v_fmac_f32 v89, v203, v209
    v_fmac_f32 v90, v203, v210
    v_fmac_f32 v91, v203, v211
    v_fmac_f32 v92, v203, v212
    v_fmac_f32 v93, v203, v213
    v_fmac_f32 v94, v203, v214
    v_fmac_f32 v95, v203, v215
    v_fmac_f32 v96, v204, v208
    v_fmac_f32 v97, v204, v209
    v_fmac_f32 v98, v204, v210
    v_fmac_f32 v99, v204, v211
    v_fmac_f32 v100, v204, v212
    v_fmac_f32 v101, v204, v213
    v_fmac_f32 v102, v204, v214
    v_fmac_f32 v103, v204, v215
    v_fmac_f32 v104, v205, v208
    v_fmac_f32 v105, v205, v209
    v_fmac_f32 v106, v205, v210
    v_fmac_f32 v107, v205, v211
    v_fmac_f32 v108, v205, v212
    v_fmac_f32 v109, v205, v213
    v_fmac_f32 v110, v205, v214
    v_fmac_f32 v111, v205, v215
    v_fmac_f32 v112, v206, v208
    v_fmac_f32 v113, v206, v209
    v_fmac_f32 v114, v206, v210
    v_fmac_f32 v115, v206, v211
    v_fmac_f32 v116, v206, v212
    v_fmac_f32 v117, v206, v213
    v_fmac_f32 v118, v206, v214
    v_fmac_f32 v119, v206, v215
    v_fmac_f32 v120, v207, v208
    v_fmac_f32 v121, v207, v209
    v_fmac_f32 v122, v207, v210
    v_fmac_f32 v123, v207, v211
    v_fmac_f32 v124, v207, v212
    v_fmac_f32 v125, v207, v213
    v_fmac_f32 v126, v207, v214
    v_fmac_f32 v127, v207, v215
    ds_read_b128 v[200:203], v7 offset:7168
    ds_read_b128 v[204:207], v7 offset:7184
    v_lshlrev_b32 v208, 16, v156
    v_and_b32 v209, 0xffff0000, v156
    v_lshlrev_b32 v210, 16, v157
    v_and_b32 v211, 0xffff0000, v157
    v_lshlrev_b32 v212, 16, v158
    v_and_b32 v213, 0xffff0000, v158
    v_lshlrev_b32 v214, 16, v159
    v_and_b32 v215, 0xffff0000, v159
    s_waitcnt lgkmcnt(0)
    v_fmac_f32 v64, v200, v208
    v_fmac_f32 v65, v200, v209
    v_fmac_f32 v66, v200, v210
    v_fmac_f32 v67, v200, v211
    v_fmac_f32 v68, v200, v212
    v_fmac_f32 v69, v200, v213
    v_fmac_f32 v70, v200, v214
    v_fmac_f32 v71, v200, v215
    v_fmac_f32 v72, v201, v208
    v_fmac_f32 v73, v201, v209
    v_fmac_f32 v74, v201, v210
    v_fmac_f32 v75, v201, v211
    v_fmac_f32 v76, v201, v212
    v_fmac_f32 v77, v201, v213
    v_fmac_f32 v78, v201, v214
    v_fmac_f32 v79, v201, v215
    v_fmac_f32 v80, v202, v208
    v_fmac_f32 v81, v202, v209
    v_fmac_f32 v82, v202, v210
    v_fmac_f32 v83, v202, v211
    v_fmac_f32 v84, v202, v212
    v_fmac_f32 v85, v202, v213
    v_fmac_f32 v86, v202, v214
    v_fmac_f32 v87, v202, v215
    v_fmac_f32 v88, v203, v208
    v_fmac_f32 v89, v203, v209
    v_fmac_f32 v90, v203, v210
    v_fmac_f32 v91, v203, v211
    v_fmac_f32 v92, v203, v212
    v_fmac_f32 v93, v203, v213
    v_fmac_f32 v94, v203, v214
    v_fmac_f32 v95, v203, v215
    v_fmac_f32 v96, v204, v208
    v_fmac_f32 v97, v204, v209
    v_fmac_f32 v98, v204, v210
    v_fmac_f32 v99, v204, v211
    v_fmac_f32 v100, v204, v212
    v_fmac_f32 v101, v204, v213
    v_fmac_f32 v102, v204, v214
    v_fmac_f32 v103, v204, v215
    v_fmac_f32 v104, v205, v208
    v_fmac_f32 v105, v205, v209
    v_fmac_f32 v106, v205, v210
    v_fmac_f32 v107, v205, v211
    v_fmac_f32 v108, v205, v212
    v_fmac_f32 v109, v205, v213
    v_fmac_f32 v110, v205, v214
    v_fmac_f32 v111, v205, v215
    v_fmac_f32 v112, v206, v208
    v_fmac_f32 v113, v206, v209
    v_fmac_f32 v114, v206, v210
    v_fmac_f32 v115, v206, v211
    v_fmac_f32 v116, v206, v212
    v_fmac_f32 v117, v206, v213
    v_fmac_f32 v118, v206, v214
    v_fmac_f32 v119, v206, v215
    v_fmac_f32 v120, v207, v208
    v_fmac_f32 v121, v207, v209
    v_fmac_f32 v122, v207, v210
    v_fmac_f32 v123, v207, v211
    v_fmac_f32 v124, v207, v212
    v_fmac_f32 v125, v207, v213
    v_fmac_f32 v126, v207, v214
    v_fmac_f32 v127, v207, v215
    ds_read_b128 v[200:203], v7 offset:8192
    ds_read_b128 v[204:207], v7 offset:8208
    v_lshlrev_b32 v208, 16, v160
    v_and_b32 v209, 0xffff0000, v160
    v_lshlrev_b32 v210, 16, v161
    v_and_b32 v211, 0xffff0000, v161
    v_lshlrev_b32 v212, 16, v162
    v_and_b32 v213, 0xffff0000, v162
    v_lshlrev_b32 v214, 16, v163
    v_and_b32 v215, 0xffff0000, v163
    s_waitcnt lgkmcnt(0)
    v_fmac_f32 v64, v200, v208
    v_fmac_f32 v65, v200, v209
    v_fmac_f32 v66, v200, v210
    v_fmac_f32 v67, v200, v211
    v_fmac_f32 v68, v200, v212
    v_fmac_f32 v69, v200, v213
    v_fmac_f32 v70, v200, v214
    v_fmac_f32 v71, v200, v215
    v_fmac_f32 v72, v201, v208
    v_fmac_f32 v73, v201, v209
    v_fmac_f32 v74, v201, v210
    v_fmac_f32 v75, v201, v211
    v_fmac_f32 v76, v201, v212
    v_fmac_f32 v77, v201, v213
    v_fmac_f32 v78, v201, v214
    v_fmac_f32 v79, v201, v215
    v_fmac_f32 v80, v202, v208
    v_fmac_f32 v81, v202, v209
    v_fmac_f32 v82, v202, v210
    v_fmac_f32 v83, v202, v211
    v_fmac_f32 v84, v202, v212
    v_fmac_f32 v85, v202, v213
    v_fmac_f32 v86, v202, v214
    v_fmac_f32 v87, v202, v215
    v_fmac_f32 v88, v203, v208
    v_fmac_f32 v89, v203, v209
    v_fmac_f32 v90, v203, v210
    v_fmac_f32 v91, v203, v211
    v_fmac_f32 v92, v203, v212
    v_fmac_f32 v93, v203, v213
    v_fmac_f32 v94, v203, v214
    v_fmac_f32 v95, v203, v215
    v_fmac_f32 v96, v204, v208
    v_fmac_f32 v97, v204, v209
    v_fmac_f32 v98, v204, v210
    v_fmac_f32 v99, v204, v211
    v_fmac_f32 v100, v204, v212
    v_fmac_f32 v101, v204, v213
    v_fmac_f32 v102, v204, v214
    v_fmac_f32 v103, v204, v215
    v_fmac_f32 v104, v205, v208
    v_fmac_f32 v105, v205, v209
    v_fmac_f32 v106, v205, v210
    v_fmac_f32 v107, v205, v211
    v_fmac_f32 v108, v205, v212
    v_fmac_f32 v109, v205, v213
    v_fmac_f32 v110, v205, v214
    v_fmac_f32 v111, v205, v215
    v_fmac_f32 v112, v206, v208
    v_fmac_f32 v113, v206, v209
    v_fmac_f32 v114, v206, v210
    v_fmac_f32 v115, v206, v211
    v_fmac_f32 v116, v206, v212
    v_fmac_f32 v117, v206, v213
    v_fmac_f32 v118, v206, v214
    v_fmac_f32 v119, v206, v215
    v_fmac_f32 v120, v207, v208
    v_fmac_f32 v121, v207, v209
    v_fmac_f32 v122, v207, v210
    v_fmac_f32 v123, v207, v211
    v_fmac_f32 v124, v207, v212
    v_fmac_f32 v125, v207, v213
    v_fmac_f32 v126, v207, v214
    v_fmac_f32 v127, v207, v215
    ds_read_b128 v[200:203], v7 offset:9216
    ds_read_b128 v[204:207], v7 offset:9232
    v_lshlrev_b32 v208, 16, v164
    v_and_b32 v209, 0xffff0000, v164
    v_lshlrev_b32 v210, 16, v165
    v_and_b32 v211, 0xffff0000, v165
    v_lshlrev_b32 v212, 16, v166
    v_and_b32 v213, 0xffff0000, v166
    v_lshlrev_b32 v214, 16, v167
    v_and_b32 v215, 0xffff0000, v167
    s_waitcnt lgkmcnt(0)
    v_fmac_f32 v64, v200, v208
    v_fmac_f32 v65, v200, v209
    v_fmac_f32 v66, v200, v210
    v_fmac_f32 v67, v200, v211
    v_fmac_f32 v68, v200, v212
    v_fmac_f32 v69, v200, v213
    v_fmac_f32 v70, v200, v214
    v_fmac_f32 v71, v200, v215
    v_fmac_f32 v72, v201, v208
    v_fmac_f32 v73, v201, v209
    v_fmac_f32 v74, v201, v210
    v_fmac_f32 v75, v201, v211
    v_fmac_f32 v76, v201, v212
    v_fmac_f32 v77, v201, v213
    v_fmac_f32 v78, v201, v214
    v_fmac_f32 v79, v201, v215
    v_fmac_f32 v80, v202, v208
    v_fmac_f32 v81, v202, v209
    v_fmac_f32 v82, v202, v210
    v_fmac_f32 v83, v202, v211
    v_fmac_f32 v84, v202, v212
    v_fmac_f32 v85, v202, v213
    v_fmac_f32 v86, v202, v214
    v_fmac_f32 v87, v202, v215
    v_fmac_f32 v88, v203, v208
    v_fmac_f32 v89, v203, v209
    v_fmac_f32 v90, v203, v210
    v_fmac_f32 v91, v203, v211
    v_fmac_f32 v92, v203, v212
    v_fmac_f32 v93, v203, v213
    v_fmac_f32 v94, v203, v214
    v_fmac_f32 v95, v203, v215
    v_fmac_f32 v96, v204, v208
    v_fmac_f32 v97, v204, v209
    v_fmac_f32 v98, v204, v210
    v_fmac_f32 v99, v204, v211
    v_fmac_f32 v100, v204, v212
    v_fmac_f32 v101, v204, v213
    v_fmac_f32 v102, v204, v214
    v_fmac_f32 v103, v204, v215
    v_fmac_f32 v104, v205, v208
    v_fmac_f32 v105, v205, v209
    v_fmac_f32 v106, v205, v210
    v_fmac_f32 v107, v205, v211
    v_fmac_f32 v108, v205, v212
    v_fmac_f32 v109, v205, v213
    v_fmac_f32 v110, v205, v214
    v_fmac_f32 v111, v205, v215
    v_fmac_f32 v112, v206, v208
    v_fmac_f32 v113, v206, v209
    v_fmac_f32 v114, v206, v210
    v_fmac_f32 v115, v206, v211
    v_fmac_f32 v116, v206, v212
    v_fmac_f32 v117, v206, v213
    v_fmac_f32 v118, v206, v214
    v_fmac_f32 v119, v206, v215
    v_fmac_f32 v120, v207, v208
    v_fmac_f32 v121, v207, v209
    v_fmac_f32 v122, v207, v210
    v_fmac_f32 v123, v207, v211
    v_fmac_f32 v124, v207, v212
    v_fmac_f32 v125, v207, v213
    v_fmac_f32 v126, v207, v214
    v_fmac_f32 v127, v207, v215
    ds_read_b128 v[200:203], v7 offset:10240
    ds_read_b128 v[204:207], v7 offset:10256
    v_lshlrev_b32 v208, 16, v168
    v_and_b32 v209, 0xffff0000, v168
    v_lshlrev_b32 v210, 16, v169
    v_and_b32 v211, 0xffff0000, v169
    v_lshlrev_b32 v212, 16, v170
    v_and_b32 v213, 0xffff0000, v170
    v_lshlrev_b32 v214, 16, v171
    v_and_b32 v215, 0xffff0000, v171
    s_waitcnt lgkmcnt(0)
    v_fmac_f32 v64, v200, v208
    v_fmac_f32 v65, v200, v209
    v_fmac_f32 v66, v200, v210
    v_fmac_f32 v67, v200, v211
    v_fmac_f32 v68, v200, v212
    v_fmac_f32 v69, v200, v213
    v_fmac_f32 v70, v200, v214
    v_fmac_f32 v71, v200, v215
    v_fmac_f32 v72, v201, v208
    v_fmac_f32 v73, v201, v209
    v_fmac_f32 v74, v201, v210
    v_fmac_f32 v75, v201, v211
    v_fmac_f32 v76, v201, v212
    v_fmac_f32 v77, v201, v213
    v_fmac_f32 v78, v201, v214
    v_fmac_f32 v79, v201, v215
    v_fmac_f32 v80, v202, v208
    v_fmac_f32 v81, v202, v209
    v_fmac_f32 v82, v202, v210
    v_fmac_f32 v83, v202, v211
    v_fmac_f32 v84, v202, v212
    v_fmac_f32 v85, v202, v213
    v_fmac_f32 v86, v202, v214
    v_fmac_f32 v87, v202, v215
    v_fmac_f32 v88, v203, v208
    v_fmac_f32 v89, v203, v209
    v_fmac_f32 v90, v203, v210
    v_fmac_f32 v91, v203, v211
    v_fmac_f32 v92, v203, v212
    v_fmac_f32 v93, v203, v213
    v_fmac_f32 v94, v203, v214
    v_fmac_f32 v95, v203, v215
    v_fmac_f32 v96, v204, v208
    v_fmac_f32 v97, v204, v209
    v_fmac_f32 v98, v204, v210
    v_fmac_f32 v99, v204, v211
    v_fmac_f32 v100, v204, v212
    v_fmac_f32 v101, v204, v213
    v_fmac_f32 v102, v204, v214
    v_fmac_f32 v103, v204, v215
    v_fmac_f32 v104, v205, v208
    v_fmac_f32 v105, v205, v209
    v_fmac_f32 v106, v205, v210
    v_fmac_f32 v107, v205, v211
    v_fmac_f32 v108, v205, v212
    v_fmac_f32 v109, v205, v213
    v_fmac_f32 v110, v205, v214
    v_fmac_f32 v111, v205, v215
    v_fmac_f32 v112, v206, v208
    v_fmac_f32 v113, v206, v209
    v_fmac_f32 v114, v206, v210
    v_fmac_f32 v115, v206, v211
    v_fmac_f32 v116, v206, v212
    v_fmac_f32 v117, v206, v213
    v_fmac_f32 v118, v206, v214
    v_fmac_f32 v119, v206, v215
    v_fmac_f32 v120, v207, v208
    v_fmac_f32 v121, v207, v209
    v_fmac_f32 v122, v207, v210
    v_fmac_f32 v123, v207, v211
    v_fmac_f32 v124, v207, v212
    v_fmac_f32 v125, v207, v213
    v_fmac_f32 v126, v207, v214
    v_fmac_f32 v127, v207, v215
    ds_read_b128 v[200:203], v7 offset:11264
    ds_read_b128 v[204:207], v7 offset:11280
    v_lshlrev_b32 v208, 16, v172
    v_and_b32 v209, 0xffff0000, v172
    v_lshlrev_b32 v210, 16, v173
    v_and_b32 v211, 0xffff0000, v173
    v_lshlrev_b32 v212, 16, v174
    v_and_b32 v213, 0xffff0000, v174
    v_lshlrev_b32 v214, 16, v175
    v_and_b32 v215, 0xffff0000, v175
    s_waitcnt lgkmcnt(0)
    v_fmac_f32 v64, v200, v208
    v_fmac_f32 v65, v200, v209
    v_fmac_f32 v66, v200, v210
    v_fmac_f32 v67, v200, v211
    v_fmac_f32 v68, v200, v212
    v_fmac_f32 v69, v200, v213
    v_fmac_f32 v70, v200, v214
    v_fmac_f32 v71, v200, v215
    v_fmac_f32 v72, v201, v208
    v_fmac_f32 v73, v201, v209
    v_fmac_f32 v74, v201, v210
    v_fmac_f32 v75, v201, v211
    v_fmac_f32 v76, v201, v212
    v_fmac_f32 v77, v201, v213
    v_fmac_f32 v78, v201, v214
    v_fmac_f32 v79, v201, v215
    v_fmac_f32 v80, v202, v208
    v_fmac_f32 v81, v202, v209
    v_fmac_f32 v82, v202, v210
    v_fmac_f32 v83, v202, v211
    v_fmac_f32 v84, v202, v212
    v_fmac_f32 v85, v202, v213
    v_fmac_f32 v86, v202, v214
    v_fmac_f32 v87, v202, v215
    v_fmac_f32 v88, v203, v208
    v_fmac_f32 v89, v203, v209
    v_fmac_f32 v90, v203, v210
    v_fmac_f32 v91, v203, v211
    v_fmac_f32 v92, v203, v212
    v_fmac_f32 v93, v203, v213
    v_fmac_f32 v94, v203, v214
    v_fmac_f32 v95, v203, v215
    v_fmac_f32 v96, v204, v208
    v_fmac_f32 v97, v204, v209
    v_fmac_f32 v98, v204, v210
    v_fmac_f32 v99, v204, v211
    v_fmac_f32 v100, v204, v212
    v_fmac_f32 v101, v204, v213
    v_fmac_f32 v102, v204, v214
    v_fmac_f32 v103, v204, v215
    v_fmac_f32 v104, v205, v208
    v_fmac_f32 v105, v205, v209
    v_fmac_f32 v106, v205, v210
    v_fmac_f32 v107, v205, v211
    v_fmac_f32 v108, v205, v212
    v_fmac_f32 v109, v205, v213
    v_fmac_f32 v110, v205, v214
    v_fmac_f32 v111, v205, v215
    v_fmac_f32 v112, v206, v208
    v_fmac_f32 v113, v206, v209
    v_fmac_f32 v114, v206, v210
    v_fmac_f32 v115, v206, v211
    v_fmac_f32 v116, v206, v212
    v_fmac_f32 v117, v206, v213
    v_fmac_f32 v118, v206, v214
    v_fmac_f32 v119, v206, v215
    v_fmac_f32 v120, v207, v208
    v_fmac_f32 v121, v207, v209
    v_fmac_f32 v122, v207, v210
    v_fmac_f32 v123, v207, v211
    v_fmac_f32 v124, v207, v212
    v_fmac_f32 v125, v207, v213
    v_fmac_f32 v126, v207, v214
    v_fmac_f32 v127, v207, v215
    ds_read_b128 v[200:203], v7 offset:12288
    ds_read_b128 v[204:207], v7 offset:12304
    v_lshlrev_b32 v208, 16, v176
    v_and_b32 v209, 0xffff0000, v176
    v_lshlrev_b32 v210, 16, v177
    v_and_b32 v211, 0xffff0000, v177
    v_lshlrev_b32 v212, 16, v178
    v_and_b32 v213, 0xffff0000, v178
    v_lshlrev_b32 v214, 16, v179
    v_and_b32 v215, 0xffff0000, v179
    s_waitcnt lgkmcnt(0)
    v_fmac_f32 v64, v200, v208
    v_fmac_f32 v65, v200, v209
    v_fmac_f32 v66, v200, v210
    v_fmac_f32 v67, v200, v211
    v_fmac_f32 v68, v200, v212
    v_fmac_f32 v69, v200, v213
    v_fmac_f32 v70, v200, v214
    v_fmac_f32 v71, v200, v215
    v_fmac_f32 v72, v201, v208
    v_fmac_f32 v73, v201, v209
    v_fmac_f32 v74, v201, v210
    v_fmac_f32 v75, v201, v211
    v_fmac_f32 v76, v201, v212
    v_fmac_f32 v77, v201, v213
    v_fmac_f32 v78, v201, v214
    v_fmac_f32 v79, v201, v215
    v_fmac_f32 v80, v202, v208
    v_fmac_f32 v81, v202, v209
    v_fmac_f32 v82, v202, v210
    v_fmac_f32 v83, v202, v211
    v_fmac_f32 v84, v202, v212
    v_fmac_f32 v85, v202, v213
    v_fmac_f32 v86, v202, v214
    v_fmac_f32 v87, v202, v215
    v_fmac_f32 v88, v203, v208
    v_fmac_f32 v89, v203, v209
    v_fmac_f32 v90, v203, v210
    v_fmac_f32 v91, v203, v211
    v_fmac_f32 v92, v203, v212
    v_fmac_f32 v93, v203, v213
    v_fmac_f32 v94, v203, v214
    v_fmac_f32 v95, v203, v215
    v_fmac_f32 v96, v204, v208
    v_fmac_f32 v97, v204, v209
    v_fmac_f32 v98, v204, v210
    v_fmac_f32 v99, v204, v211
    v_fmac_f32 v100, v204, v212
    v_fmac_f32 v101, v204, v213
    v_fmac_f32 v102, v204, v214
    v_fmac_f32 v103, v204, v215
    v_fmac_f32 v104, v205, v208
    v_fmac_f32 v105, v205, v209
    v_fmac_f32 v106, v205, v210
    v_fmac_f32 v107, v205, v211
    v_fmac_f32 v108, v205, v212
    v_fmac_f32 v109, v205, v213
    v_fmac_f32 v110, v205, v214
    v_fmac_f32 v111, v205, v215
    v_fmac_f32 v112, v206, v208
    v_fmac_f32 v113, v206, v209
    v_fmac_f32 v114, v206, v210
    v_fmac_f32 v115, v206, v211
    v_fmac_f32 v116, v206, v212
    v_fmac_f32 v117, v206, v213
    v_fmac_f32 v118, v206, v214
    v_fmac_f32 v119, v206, v215
    v_fmac_f32 v120, v207, v208
    v_fmac_f32 v121, v207, v209
    v_fmac_f32 v122, v207, v210
    v_fmac_f32 v123, v207, v211
    v_fmac_f32 v124, v207, v212
    v_fmac_f32 v125, v207, v213
    v_fmac_f32 v126, v207, v214
    v_fmac_f32 v127, v207, v215
    ds_read_b128 v[200:203], v7 offset:13312
    ds_read_b128 v[204:207], v7 offset:13328
    v_lshlrev_b32 v208, 16, v180
    v_and_b32 v209, 0xffff0000, v180
    v_lshlrev_b32 v210, 16, v181
    v_and_b32 v211, 0xffff0000, v181
    v_lshlrev_b32 v212, 16, v182
    v_and_b32 v213, 0xffff0000, v182
    v_lshlrev_b32 v214, 16, v183
    v_and_b32 v215, 0xffff0000, v183
    s_waitcnt lgkmcnt(0)
    v_fmac_f32 v64, v200, v208
    v_fmac_f32 v65, v200, v209
    v_fmac_f32 v66, v200, v210
    v_fmac_f32 v67, v200, v211
    v_fmac_f32 v68, v200, v212
    v_fmac_f32 v69, v200, v213
    v_fmac_f32 v70, v200, v214
    v_fmac_f32 v71, v200, v215
    v_fmac_f32 v72, v201, v208
    v_fmac_f32 v73, v201, v209
    v_fmac_f32 v74, v201, v210
    v_fmac_f32 v75, v201, v211
    v_fmac_f32 v76, v201, v212
    v_fmac_f32 v77, v201, v213
    v_fmac_f32 v78, v201, v214
    v_fmac_f32 v79, v201, v215
    v_fmac_f32 v80, v202, v208
    v_fmac_f32 v81, v202, v209
    v_fmac_f32 v82, v202, v210
    v_fmac_f32 v83, v202, v211
    v_fmac_f32 v84, v202, v212
    v_fmac_f32 v85, v202, v213
    v_fmac_f32 v86, v202, v214
    v_fmac_f32 v87, v202, v215
    v_fmac_f32 v88, v203, v208
    v_fmac_f32 v89, v203, v209
    v_fmac_f32 v90, v203, v210
    v_fmac_f32 v91, v203, v211
    v_fmac_f32 v92, v203, v212
    v_fmac_f32 v93, v203, v213
    v_fmac_f32 v94, v203, v214
    v_fmac_f32 v95, v203, v215
    v_fmac_f32 v96, v204, v208
    v_fmac_f32 v97, v204, v209
    v_fmac_f32 v98, v204, v210
    v_fmac_f32 v99, v204, v211
    v_fmac_f32 v100, v204, v212
    v_fmac_f32 v101, v204, v213
    v_fmac_f32 v102, v204, v214
    v_fmac_f32 v103, v204, v215
    v_fmac_f32 v104, v205, v208
    v_fmac_f32 v105, v205, v209
    v_fmac_f32 v106, v205, v210
    v_fmac_f32 v107, v205, v211
    v_fmac_f32 v108, v205, v212
    v_fmac_f32 v109, v205, v213
    v_fmac_f32 v110, v205, v214
    v_fmac_f32 v111, v205, v215
    v_fmac_f32 v112, v206, v208
    v_fmac_f32 v113, v206, v209
    v_fmac_f32 v114, v206, v210
    v_fmac_f32 v115, v206, v211
    v_fmac_f32 v116, v206, v212
    v_fmac_f32 v117, v206, v213
    v_fmac_f32 v118, v206, v214
    v_fmac_f32 v119, v206, v215
    v_fmac_f32 v120, v207, v208
    v_fmac_f32 v121, v207, v209
    v_fmac_f32 v122, v207, v210
    v_fmac_f32 v123, v207, v211
    v_fmac_f32 v124, v207, v212
    v_fmac_f32 v125, v207, v213
    v_fmac_f32 v126, v207, v214
    v_fmac_f32 v127, v207, v215
    ds_read_b128 v[200:203], v7 offset:14336
    ds_read_b128 v[204:207], v7 offset:14352
    v_lshlrev_b32 v208, 16, v184
    v_and_b32 v209, 0xffff0000, v184
    v_lshlrev_b32 v210, 16, v185
    v_and_b32 v211, 0xffff0000, v185
    v_lshlrev_b32 v212, 16, v186
    v_and_b32 v213, 0xffff0000, v186
    v_lshlrev_b32 v214, 16, v187
    v_and_b32 v215, 0xffff0000, v187
    s_waitcnt lgkmcnt(0)
    v_fmac_f32 v64, v200, v208
    v_fmac_f32 v65, v200, v209
    v_fmac_f32 v66, v200, v210
    v_fmac_f32 v67, v200, v211
    v_fmac_f32 v68, v200, v212
    v_fmac_f32 v69, v200, v213
    v_fmac_f32 v70, v200, v214
    v_fmac_f32 v71, v200, v215
    v_fmac_f32 v72, v201, v208
    v_fmac_f32 v73, v201, v209
    v_fmac_f32 v74, v201, v210
    v_fmac_f32 v75, v201, v211
    v_fmac_f32 v76, v201, v212
    v_fmac_f32 v77, v201, v213
    v_fmac_f32 v78, v201, v214
    v_fmac_f32 v79, v201, v215
    v_fmac_f32 v80, v202, v208
    v_fmac_f32 v81, v202, v209
    v_fmac_f32 v82, v202, v210
    v_fmac_f32 v83, v202, v211
    v_fmac_f32 v84, v202, v212
    v_fmac_f32 v85, v202, v213
    v_fmac_f32 v86, v202, v214
    v_fmac_f32 v87, v202, v215
    v_fmac_f32 v88, v203, v208
    v_fmac_f32 v89, v203, v209
    v_fmac_f32 v90, v203, v210
    v_fmac_f32 v91, v203, v211
    v_fmac_f32 v92, v203, v212
    v_fmac_f32 v93, v203, v213
    v_fmac_f32 v94, v203, v214
    v_fmac_f32 v95, v203, v215
    v_fmac_f32 v96, v204, v208
    v_fmac_f32 v97, v204, v209
    v_fmac_f32 v98, v204, v210
    v_fmac_f32 v99, v204, v211
    v_fmac_f32 v100, v204, v212
    v_fmac_f32 v101, v204, v213
    v_fmac_f32 v102, v204, v214
    v_fmac_f32 v103, v204, v215
    v_fmac_f32 v104, v205, v208
    v_fmac_f32 v105, v205, v209
    v_fmac_f32 v106, v205, v210
    v_fmac_f32 v107, v205, v211
    v_fmac_f32 v108, v205, v212
    v_fmac_f32 v109, v205, v213
    v_fmac_f32 v110, v205, v214
    v_fmac_f32 v111, v205, v215
    v_fmac_f32 v112, v206, v208
    v_fmac_f32 v113, v206, v209
    v_fmac_f32 v114, v206, v210
    v_fmac_f32 v115, v206, v211
    v_fmac_f32 v116, v206, v212
    v_fmac_f32 v117, v206, v213
    v_fmac_f32 v118, v206, v214
    v_fmac_f32 v119, v206, v215
    v_fmac_f32 v120, v207, v208
    v_fmac_f32 v121, v207, v209
    v_fmac_f32 v122, v207, v210
    v_fmac_f32 v123, v207, v211
    v_fmac_f32 v124, v207, v212
    v_fmac_f32 v125, v207, v213
    v_fmac_f32 v126, v207, v214
    v_fmac_f32 v127, v207, v215
    ds_read_b128 v[200:203], v7 offset:15360
    ds_read_b128 v[204:207], v7 offset:15376
    v_lshlrev_b32 v208, 16, v188
    v_and_b32 v209, 0xffff0000, v188
    v_lshlrev_b32 v210, 16, v189
    v_and_b32 v211, 0xffff0000, v189
    v_lshlrev_b32 v212, 16, v190
    v_and_b32 v213, 0xffff0000, v190
    v_lshlrev_b32 v214, 16, v191
    v_and_b32 v215, 0xffff0000, v191
    s_waitcnt lgkmcnt(0)
    v_fmac_f32 v64, v200, v208
    v_fmac_f32 v65, v200, v209
    v_fmac_f32 v66, v200, v210
    v_fmac_f32 v67, v200, v211
    v_fmac_f32 v68, v200, v212
    v_fmac_f32 v69, v200, v213
    v_fmac_f32 v70, v200, v214
    v_fmac_f32 v71, v200, v215
    v_fmac_f32 v72, v201, v208
    v_fmac_f32 v73, v201, v209
    v_fmac_f32 v74, v201, v210
    v_fmac_f32 v75, v201, v211
    v_fmac_f32 v76, v201, v212
    v_fmac_f32 v77, v201, v213
    v_fmac_f32 v78, v201, v214
    v_fmac_f32 v79, v201, v215
    v_fmac_f32 v80, v202, v208
    v_fmac_f32 v81, v202, v209
    v_fmac_f32 v82, v202, v210
    v_fmac_f32 v83, v202, v211
    v_fmac_f32 v84, v202, v212
    v_fmac_f32 v85, v202, v213
    v_fmac_f32 v86, v202, v214
    v_fmac_f32 v87, v202, v215
    v_fmac_f32 v88, v203, v208
    v_fmac_f32 v89, v203, v209
    v_fmac_f32 v90, v203, v210
    v_fmac_f32 v91, v203, v211
    v_fmac_f32 v92, v203, v212
    v_fmac_f32 v93, v203, v213
    v_fmac_f32 v94, v203, v214
    v_fmac_f32 v95, v203, v215
    v_fmac_f32 v96, v204, v208
    v_fmac_f32 v97, v204, v209
    v_fmac_f32 v98, v204, v210
    v_fmac_f32 v99, v204, v211
    v_fmac_f32 v100, v204, v212
    v_fmac_f32 v101, v204, v213
    v_fmac_f32 v102, v204, v214
    v_fmac_f32 v103, v204, v215
    v_fmac_f32 v104, v205, v208
    v_fmac_f32 v105, v205, v209
    v_fmac_f32 v106, v205, v210
    v_fmac_f32 v107, v205, v211
    v_fmac_f32 v108, v205, v212
    v_fmac_f32 v109, v205, v213
    v_fmac_f32 v110, v205, v214
    v_fmac_f32 v111, v205, v215
    v_fmac_f32 v112, v206, v208
    v_fmac_f32 v113, v206, v209
    v_fmac_f32 v114, v206, v210
    v_fmac_f32 v115, v206, v211
    v_fmac_f32 v116, v206, v212
    v_fmac_f32 v117, v206, v213
    v_fmac_f32 v118, v206, v214
    v_fmac_f32 v119, v206, v215
    v_fmac_f32 v120, v207, v208
    v_fmac_f32 v121, v207, v209
    v_fmac_f32 v122, v207, v210
    v_fmac_f32 v123, v207, v211
    v_fmac_f32 v124, v207, v212
    v_fmac_f32 v125, v207, v213
    v_fmac_f32 v126, v207, v214
    v_fmac_f32 v127, v207, v215
    v_lshlrev_b32 v8, 11, v5
    v_lshl_add_u32 v8, v4, 5, v8
    v_add_u32 v8, 18432, v8
    ds_write_b128 v8, v[64:67] offset:0
    ds_write_b128 v8, v[68:71] offset:16
    ds_write_b128 v8, v[72:75] offset:256
    ds_write_b128 v8, v[76:79] offset:272
    ds_write_b128 v8, v[80:83] offset:512
    ds_write_b128 v8, v[84:87] offset:528
    ds_write_b128 v8, v[88:91] offset:768
    ds_write_b128 v8, v[92:95] offset:784
    ds_write_b128 v8, v[96:99] offset:1024
    ds_write_b128 v8, v[100:103] offset:1040
    ds_write_b128 v8, v[104:107] offset:1280
    ds_write_b128 v8, v[108:111] offset:1296
    ds_write_b128 v8, v[112:115] offset:1536
    ds_write_b128 v8, v[116:119] offset:1552
    ds_write_b128 v8, v[120:123] offset:1792
    ds_write_b128 v8, v[124:127] offset:1808
    s_waitcnt lgkmcnt(0)
    s_barrier
    v_lshrrev_b32 v9, 5, v0
    v_and_b32 v10, 31, v0
    v_lshlrev_b32 v11, 8, v9
    v_lshl_add_u32 v11, v10, 3, v11
    v_add_u32 v11, 18432, v11
    ds_read_b64 v[64:65], v11 offset:0
    ds_read_b64 v[66:67], v11 offset:2048
    ds_read_b64 v[68:69], v11 offset:4096
    ds_read_b64 v[70:71], v11 offset:6144
    ds_read_b64 v[72:73], v11 offset:8192
    ds_read_b64 v[74:75], v11 offset:10240
    ds_read_b64 v[76:77], v11 offset:12288
    ds_read_b64 v[78:79], v11 offset:14336
    ds_read_b64 v[80:81], v11 offset:16384
    ds_read_b64 v[82:83], v11 offset:18432
    ds_read_b64 v[84:85], v11 offset:20480
    ds_read_b64 v[86:87], v11 offset:22528
    ds_read_b64 v[88:89], v11 offset:24576
    ds_read_b64 v[90:91], v11 offset:26624
    ds_read_b64 v[92:93], v11 offset:28672
    ds_read_b64 v[94:95], v11 offset:30720
    ds_read_b64 v[96:97], v11 offset:32768
    ds_read_b64 v[98:99], v11 offset:34816
    ds_read_b64 v[100:101], v11 offset:36864
    ds_read_b64 v[102:103], v11 offset:38912
    ds_read_b64 v[104:105], v11 offset:40960
    ds_read_b64 v[106:107], v11 offset:43008
    ds_read_b64 v[108:109], v11 offset:45056
    ds_read_b64 v[110:111], v11 offset:47104
    ds_read_b64 v[112:113], v11 offset:49152
    ds_read_b64 v[114:115], v11 offset:51200
    ds_read_b64 v[116:117], v11 offset:53248
    ds_read_b64 v[118:119], v11 offset:55296
    ds_read_b64 v[120:121], v11 offset:57344
    ds_read_b64 v[122:123], v11 offset:59392
    ds_read_b64 v[124:125], v11 offset:61440
    ds_read_b64 v[126:127], v11 offset:63488
    s_waitcnt lgkmcnt(0)
    v_add_f32 v64, v64, v66
    v_add_f32 v65, v65, v67
    v_add_f32 v64, v64, v68
    v_add_f32 v65, v65, v69
    v_add_f32 v64, v64, v70
    v_add_f32 v65, v65, v71
    v_add_f32 v64, v64, v72
    v_add_f32 v65, v65, v73
    v_add_f32 v64, v64, v74
    v_add_f32 v65, v65, v75
    v_add_f32 v64, v64, v76
    v_add_f32 v65, v65, v77
    v_add_f32 v64, v64, v78
    v_add_f32 v65, v65, v79
    v_add_f32 v64, v64, v80
    v_add_f32 v65, v65, v81
    v_add_f32 v64, v64, v82
    v_add_f32 v65, v65, v83
    v_add_f32 v64, v64, v84
    v_add_f32 v65, v65, v85
    v_add_f32 v64, v64, v86
    v_add_f32 v65, v65, v87
    v_add_f32 v64, v64, v88
    v_add_f32 v65, v65, v89
    v_add_f32 v64, v64, v90
    v_add_f32 v65, v65, v91
    v_add_f32 v64, v64, v92
    v_add_f32 v65, v65, v93
    v_add_f32 v64, v64, v94
    v_add_f32 v65, v65, v95
    v_add_f32 v64, v64, v96
    v_add_f32 v65, v65, v97
    v_add_f32 v64, v64, v98
    v_add_f32 v65, v65, v99
    v_add_f32 v64, v64, v100
    v_add_f32 v65, v65, v101
    v_add_f32 v64, v64, v102
    v_add_f32 v65, v65, v103
    v_add_f32 v64, v64, v104
    v_add_f32 v65, v65, v105
    v_add_f32 v64, v64, v106
    v_add_f32 v65, v65, v107
    v_add_f32 v64, v64, v108
    v_add_f32 v65, v65, v109
    v_add_f32 v64, v64, v110
    v_add_f32 v65, v65, v111
    v_add_f32 v64, v64, v112
    v_add_f32 v65, v65, v113
    v_add_f32 v64, v64, v114
    v_add_f32 v65, v65, v115
    v_add_f32 v64, v64, v116
    v_add_f32 v65, v65, v117
    v_add_f32 v64, v64, v118
    v_add_f32 v65, v65, v119
    v_add_f32 v64, v64, v120
    v_add_f32 v65, v65, v121
    v_add_f32 v64, v64, v122
    v_add_f32 v65, v65, v123
    v_add_f32 v64, v64, v124
    v_add_f32 v65, v65, v125
    v_add_f32 v64, v64, v126
    v_add_f32 v65, v65, v127
    s_mul_i32 s40, s31, 18432
    s_lshl_b32 s41, s30, 8
    s_add_u32 s40, s40, s41
    s_add_u32 s40, s40, 1376256
    s_mov_b32 s41, 2304
    v_mul_lo_u32 v12, v9, s41
    v_lshl_add_u32 v12, v10, 3, v12
    buffer_store_dwordx2 v[64:65], v12, s[12:15], s40 offen
    s_waitcnt vmcnt(0)
L_end_kd_kernel:
    s_endpgm
.globl ke_kernel
.p2align 8
.type ke_kernel,@function
ke_kernel:
    s_cmp_ge_u32 s2, 144
    s_cbranch_scc1 L_end_ke_kernel
    s_load_dwordx2 s[28:29], s[0:1], 48
    s_load_dwordx2 s[34:35], s[0:1], 56
    s_load_dwordx2 s[36:37], s[0:1], 104
    s_load_dwordx2 s[38:39], s[0:1], 0
    s_waitcnt lgkmcnt(0)
    s_and_b32 s45, s2, 1
    s_lshr_b32 s30, s2, 1
    s_mov_b32 s31, 0
    s_cmp_eq_u32 s45, 0
    s_cselect_b32 s28, s28, s34
    s_cselect_b32 s29, s29, s35
    s_mov_b32 s8, s28
    s_and_b32 s9, s29, 0xffff
    s_mov_b32 s10, 0x510000
    s_mov_b32 s11, 0x20000
    s_mov_b32 s12, s36
    s_and_b32 s13, s37, 0xffff
    s_mov_b32 s14, 0x40000000
    s_mov_b32 s15, 0x20000
    s_mov_b32 s16, s38
    s_and_b32 s17, s39, 0xffff
    s_mov_b32 s18, 0x2400
    s_mov_b32 s19, 0x20000
    v_and_b32 v1, 63, v0
    v_lshrrev_b32 v2, 6, v0
    v_lshrrev_b32 v3, 3, v1
    v_and_b32 v4, 7, v1
    v_lshl_add_u32 v5, v2, 3, v3
    s_mov_b32 s33, 9216
    v_mul_lo_u32 v6, v5, s33
    v_lshl_add_u32 v6, v4, 4, v6
    v_lshlrev_b32 v7, 5, v5
    s_lshl_b32 s32, s30, 7
    s_mul_i32 s34, s31, 5308416
    s_add_u32 s32, s32, s34
    buffer_load_dwordx4 v[128:131], v6, s[8:11], s32 offen
    s_add_u32 s32, s32, 294912
    buffer_load_dwordx4 v[132:135], v6, s[8:11], s32 offen
    s_add_u32 s32, s32, 294912
    buffer_load_dwordx4 v[136:139], v6, s[8:11], s32 offen
    s_add_u32 s32, s32, 294912
    buffer_load_dwordx4 v[140:143], v6, s[8:11], s32 offen
    s_add_u32 s32, s32, 294912
    buffer_load_dwordx4 v[144:147], v6, s[8:11], s32 offen
    s_add_u32 s32, s32, 294912
    buffer_load_dwordx4 v[148:151], v6, s[8:11], s32 offen
    s_add_u32 s32, s32, 294912
    buffer_load_dwordx4 v[152:155], v6, s[8:11], s32 offen
    s_add_u32 s32, s32, 294912
    buffer_load_dwordx4 v[156:159], v6, s[8:11], s32 offen
    s_add_u32 s32, s32, 294912
    buffer_load_dwordx4 v[160:163], v6, s[8:11], s32 offen
    s_add_u32 s32, s32, 294912
    buffer_load_dwordx4 v[164:167], v6, s[8:11], s32 offen
    s_add_u32 s32, s32, 294912
    buffer_load_dwordx4 v[168:171], v6, s[8:11], s32 offen
    s_add_u32 s32, s32, 294912
    buffer_load_dwordx4 v[172:175], v6, s[8:11], s32 offen
    s_add_u32 s32, s32, 294912
    buffer_load_dwordx4 v[176:179], v6, s[8:11], s32 offen
    s_add_u32 s32, s32, 294912
    buffer_load_dwordx4 v[180:183], v6, s[8:11], s32 offen
    s_add_u32 s32, s32, 294912
    buffer_load_dwordx4 v[184:187], v6, s[8:11], s32 offen
    s_add_u32 s32, s32, 294912
    buffer_load_dwordx4 v[188:191], v6, s[8:11], s32 offen
    s_add_u32 s32, s32, 294912
    buffer_load_dwordx4 v[192:195], v6, s[8:11], s32 offen
    s_add_u32 s32, s32, 294912
    buffer_load_dwordx4 v[196:199], v6, s[8:11], s32 offen
    v_mul_u32_u24 v226, 2304, v2
    v_lshl_add_u32 v226, v1, 1, v226
    s_mov_b32 s40, 27648
    v_mul_lo_u32 v220, v2, s40
    v_lshl_add_u32 v220, v1, 2, v220
    v_mul_u32_u24 v221, 4608, v2
    v_lshl_add_u32 v221, v1, 2, v221
    v_add_u32 v221, 1373952, v221
    v_lshlrev_b32 v224, 5, v1
    v_lshl_add_u32 v224, v2, 3, v224
    s_mov_b32 s56, -2304
    s_mov_b32 s48, 0
    s_mov_b32 s49, 18432
    s_mov_b32 s50, 36864
    s_mov_b32 s51, 55296
    s_mov_b32 s52, 73728
    s_mov_b32 s53, 92160
    s_mov_b32 s54, 110592
    s_mov_b32 s55, 129024
    v_add_u32 v221, 2304, v221
    v_add_u32 v222, 4608, v220
    v_add_u32 v223, 9216, v220
    v_add_u32 v227, 6912, v220
    buffer_load_dword v64, v221, s[12:15], s48 offen offset:0
    buffer_load_dword v65, v221, s[12:15], s48 offen offset:256
    buffer_load_dword v66, v221, s[12:15], s48 offen offset:512
    buffer_load_dword v67, v221, s[12:15], s48 offen offset:768
    buffer_load_dword v68, v221, s[12:15], s48 offen offset:1024
    buffer_load_dword v69, v221, s[12:15], s48 offen offset:1280
    buffer_load_dword v70, v221, s[12:15], s48 offen offset:1536
    buffer_load_dword v71, v221, s[12:15], s48 offen offset:1792
    buffer_load_dword v72, v221, s[12:15], s48 offen offset:2048
    buffer_load_dword v73, v221, s[12:15], s49 offen offset:0
    buffer_load_dword v74, v221, s[12:15], s49 offen offset:256
    buffer_load_dword v75, v221, s[12:15], s49 offen offset:512
    buffer_load_dword v76, v221, s[12:15], s49 offen offset:768
    buffer_load_dword v77, v221, s[12:15], s49 offen offset:1024
    buffer_load_dword v78, v221, s[12:15], s49 offen offset:1280
    buffer_load_dword v79, v221, s[12:15], s49 offen offset:1536
    buffer_load_dword v80, v221, s[12:15], s49 offen offset:1792
    buffer_load_dword v81, v221, s[12:15], s49 offen offset:2048
    buffer_load_dword v82, v221, s[12:15], s50 offen offset:0
    buffer_load_dword v83, v221, s[12:15], s50 offen offset:256
    buffer_load_dword v84, v221, s[12:15], s50 offen offset:512
    buffer_load_dword v85, v221, s[12:15], s50 offen offset:768
    buffer_load_dword v86, v221, s[12:15], s50 offen offset:1024
    buffer_load_dword v87, v221, s[12:15], s50 offen offset:1280
    buffer_load_dword v88, v221, s[12:15], s50 offen offset:1536
    buffer_load_dword v89, v221, s[12:15], s50 offen offset:1792
    buffer_load_dword v90, v221, s[12:15], s50 offen offset:2048
    buffer_load_dword v91, v221, s[12:15], s51 offen offset:0
    buffer_load_dword v92, v221, s[12:15], s51 offen offset:256
    buffer_load_dword v93, v221, s[12:15], s51 offen offset:512
    buffer_load_dword v94, v221, s[12:15], s51 offen offset:768
    buffer_load_dword v95, v221, s[12:15], s51 offen offset:1024
    buffer_load_dword v96, v221, s[12:15], s51 offen offset:1280
    buffer_load_dword v97, v221, s[12:15], s51 offen offset:1536
    buffer_load_dword v98, v221, s[12:15], s51 offen offset:1792
    buffer_load_dword v99, v221, s[12:15], s51 offen offset:2048
    buffer_load_dword v8, v221, s[12:15], s52 offen offset:0
    buffer_load_dword v9, v221, s[12:15], s52 offen offset:256
    buffer_load_dword v10, v221, s[12:15], s52 offen offset:512
    buffer_load_dword v11, v221, s[12:15], s52 offen offset:768
    buffer_load_dword v12, v221, s[12:15], s52 offen offset:1024
    buffer_load_dword v13, v221, s[12:15], s52 offen offset:1280
    buffer_load_dword v14, v221, s[12:15], s52 offen offset:1536
    buffer_load_dword v15, v221, s[12:15], s52 offen offset:1792
    buffer_load_dword v16, v221, s[12:15], s52 offen offset:2048
    buffer_load_dword v17, v221, s[12:15], s53 offen offset:0
    buffer_load_dword v18, v221, s[12:15], s53 offen offset:256
    buffer_load_dword v19, v221, s[12:15], s53 offen offset:512
    buffer_load_dword v20, v221, s[12:15], s53 offen offset:768
    buffer_load_dword v21, v221, s[12:15], s53 offen offset:1024
    buffer_load_dword v22, v221, s[12:15], s53 offen offset:1280
    buffer_load_dword v23, v221, s[12:15], s53 offen offset:1536
    buffer_load_dword v24, v221, s[12:15], s53 offen offset:1792
    buffer_load_dword v25, v221, s[12:15], s53 offen offset:2048
    buffer_load_dword v26, v221, s[12:15], s54 offen offset:0
    buffer_load_dword v27, v221, s[12:15], s54 offen offset:256
    buffer_load_dword v28, v221, s[12:15], s54 offen offset:512
    buffer_load_dword v29, v221, s[12:15], s54 offen offset:768
    buffer_load_dword v30, v221, s[12:15], s54 offen offset:1024
    buffer_load_dword v31, v221, s[12:15], s54 offen offset:1280
    buffer_load_dword v32, v221, s[12:15], s54 offen offset:1536
    buffer_load_dword v33, v221, s[12:15], s54 offen offset:1792
    buffer_load_dword v34, v221, s[12:15], s54 offen offset:2048
    buffer_load_dword v35, v221, s[12:15], s55 offen offset:0
    buffer_load_dword v36, v221, s[12:15], s55 offen offset:256
    buffer_load_dword v37, v221, s[12:15], s55 offen offset:512
    buffer_load_dword v38, v221, s[12:15], s55 offen offset:768
    buffer_load_dword v39, v221, s[12:15], s55 offen offset:1024
    buffer_load_dword v40, v221, s[12:15], s55 offen offset:1280
    buffer_load_dword v41, v221, s[12:15], s55 offen offset:1536
    buffer_load_dword v42, v221, s[12:15], s55 offen offset:1792
    buffer_load_dword v43, v221, s[12:15], s55 offen offset:2048
    buffer_load_ushort v44, v226, s[16:19], 0 offen offset:0
    buffer_load_dword v53, v222, s[12:15], 0 offen offset:0
    buffer_load_dword v100, v223, s[12:15], 0 offen offset:0
    buffer_load_dword v109, v227, s[12:15], 0 offen offset:0
    buffer_load_ushort v45, v226, s[16:19], 0 offen offset:128
    buffer_load_dword v54, v222, s[12:15], 0 offen offset:256
    buffer_load_dword v101, v223, s[12:15], 0 offen offset:256
    buffer_load_dword v110, v227, s[12:15], 0 offen offset:256
    buffer_load_ushort v46, v226, s[16:19], 0 offen offset:256
    buffer_load_dword v55, v222, s[12:15], 0 offen offset:512
    buffer_load_dword v102, v223, s[12:15], 0 offen offset:512
    buffer_load_dword v111, v227, s[12:15], 0 offen offset:512
    buffer_load_ushort v47, v226, s[16:19], 0 offen offset:384
    buffer_load_dword v56, v222, s[12:15], 0 offen offset:768
    buffer_load_dword v103, v223, s[12:15], 0 offen offset:768
    buffer_load_dword v112, v227, s[12:15], 0 offen offset:768
    buffer_load_ushort v48, v226, s[16:19], 0 offen offset:512
    buffer_load_dword v57, v222, s[12:15], 0 offen offset:1024
    buffer_load_dword v104, v223, s[12:15], 0 offen offset:1024
    buffer_load_dword v113, v227, s[12:15], 0 offen offset:1024
    buffer_load_ushort v49, v226, s[16:19], 0 offen offset:640
    buffer_load_dword v58, v222, s[12:15], 0 offen offset:1280
    buffer_load_dword v105, v223, s[12:15], 0 offen offset:1280
    buffer_load_dword v114, v227, s[12:15], 0 offen offset:1280
    buffer_load_ushort v50, v226, s[16:19], 0 offen offset:768
    buffer_load_dword v59, v222, s[12:15], 0 offen offset:1536
    buffer_load_dword v106, v223, s[12:15], 0 offen offset:1536
    buffer_load_dword v115, v227, s[12:15], 0 offen offset:1536
    buffer_load_ushort v51, v226, s[16:19], 0 offen offset:896
    buffer_load_dword v60, v222, s[12:15], 0 offen offset:1792
    buffer_load_dword v107, v223, s[12:15], 0 offen offset:1792
    buffer_load_dword v116, v227, s[12:15], 0 offen offset:1792
    buffer_load_ushort v52, v226, s[16:19], 0 offen offset:1024
    buffer_load_dword v61, v222, s[12:15], 0 offen offset:2048
    buffer_load_dword v108, v223, s[12:15], 0 offen offset:2048
    buffer_load_dword v117, v227, s[12:15], 0 offen offset:2048
    s_waitcnt vmcnt(0)
    v_add_f32 v64, v64, v73
    v_add_f32 v64, v64, v82
    v_add_f32 v64, v64, v91
    v_add_f32 v64, v64, v8
    v_add_f32 v64, v64, v17
    v_add_f32 v64, v64, v26
    v_add_f32 v64, v64, v35
    v_lshlrev_b32 v44, 16, v44
    v_fma_f32 v64, v64, v53, v44
    v_add_f32 v65, v65, v74
    v_add_f32 v65, v65, v83
    v_add_f32 v65, v65, v92
    v_add_f32 v65, v65, v9
    v_add_f32 v65, v65, v18
    v_add_f32 v65, v65, v27
    v_add_f32 v65, v65, v36
    v_lshlrev_b32 v45, 16, v45
    v_fma_f32 v65, v65, v54, v45
    v_add_f32 v66, v66, v75
    v_add_f32 v66, v66, v84
    v_add_f32 v66, v66, v93
    v_add_f32 v66, v66, v10
    v_add_f32 v66, v66, v19
    v_add_f32 v66, v66, v28
    v_add_f32 v66, v66, v37
    v_lshlrev_b32 v46, 16, v46
    v_fma_f32 v66, v66, v55, v46
    v_add_f32 v67, v67, v76
    v_add_f32 v67, v67, v85
    v_add_f32 v67, v67, v94
    v_add_f32 v67, v67, v11
    v_add_f32 v67, v67, v20
    v_add_f32 v67, v67, v29
    v_add_f32 v67, v67, v38
    v_lshlrev_b32 v47, 16, v47
    v_fma_f32 v67, v67, v56, v47
    v_add_f32 v68, v68, v77
    v_add_f32 v68, v68, v86
    v_add_f32 v68, v68, v95
    v_add_f32 v68, v68, v12
    v_add_f32 v68, v68, v21
    v_add_f32 v68, v68, v30
    v_add_f32 v68, v68, v39
    v_lshlrev_b32 v48, 16, v48
    v_fma_f32 v68, v68, v57, v48
    v_add_f32 v69, v69, v78
    v_add_f32 v69, v69, v87
    v_add_f32 v69, v69, v96
    v_add_f32 v69, v69, v13
    v_add_f32 v69, v69, v22
    v_add_f32 v69, v69, v31
    v_add_f32 v69, v69, v40
    v_lshlrev_b32 v49, 16, v49
    v_fma_f32 v69, v69, v58, v49
    v_add_f32 v70, v70, v79
    v_add_f32 v70, v70, v88
    v_add_f32 v70, v70, v97
    v_add_f32 v70, v70, v14
    v_add_f32 v70, v70, v23
    v_add_f32 v70, v70, v32
    v_add_f32 v70, v70, v41
    v_lshlrev_b32 v50, 16, v50
    v_fma_f32 v70, v70, v59, v50
    v_add_f32 v71, v71, v80
    v_add_f32 v71, v71, v89
    v_add_f32 v71, v71, v98
    v_add_f32 v71, v71, v15
    v_add_f32 v71, v71, v24
    v_add_f32 v71, v71, v33
    v_add_f32 v71, v71, v42
    v_lshlrev_b32 v51, 16, v51
    v_fma_f32 v71, v71, v60, v51
    v_add_f32 v72, v72, v81
    v_add_f32 v72, v72, v90
    v_add_f32 v72, v72, v99
    v_add_f32 v72, v72, v16
    v_add_f32 v72, v72, v25
    v_add_f32 v72, v72, v34
    v_add_f32 v72, v72, v43
    v_lshlrev_b32 v52, 16, v52
    v_fma_f32 v72, v72, v61, v52
    s_cmp_lg_u32 s2, 0
    s_cbranch_scc1 L_skipx1_0
    v_add_u32 v225, 196608, v221
    buffer_store_dword v64, v225, s[12:15], 0 offen offset:0
    buffer_store_dword v65, v225, s[12:15], 0 offen offset:256
    buffer_store_dword v66, v225, s[12:15], 0 offen offset:512
    buffer_store_dword v67, v225, s[12:15], 0 offen offset:768
    buffer_store_dword v68, v225, s[12:15], 0 offen offset:1024
    buffer_store_dword v69, v225, s[12:15], 0 offen offset:1280
    buffer_store_dword v70, v225, s[12:15], 0 offen offset:1536
    buffer_store_dword v71, v225, s[12:15], 0 offen offset:1792
    buffer_store_dword v72, v225, s[12:15], 0 offen offset:2048
L_skipx1_0:
    v_add_f32 v216, v64, v65
    v_add_f32 v216, v216, v66
    v_add_f32 v216, v216, v67
    v_add_f32 v216, v216, v68
    v_add_f32 v216, v216, v69
    v_add_f32 v216, v216, v70
    v_add_f32 v216, v216, v71
    v_add_f32 v216, v216, v72
    s_nop 1
    v_add_f32_dpp v216, v216, v216 row_ror:8 row_mask:0xf bank_mask:0xf
    s_nop 1
    v_add_f32_dpp v216, v216, v216 row_ror:4 row_mask:0xf bank_mask:0xf
    s_nop 1
    v_add_f32_dpp v216, v216, v216 row_ror:2 row_mask:0xf bank_mask:0xf
    s_nop 1
    v_add_f32_dpp v216, v216, v216 row_ror:1 row_mask:0xf bank_mask:0xf
    s_nop 0
    v_readlane_b32 s40, v216, 0
    v_readlane_b32 s41, v216, 16
    v_readlane_b32 s42, v216, 32
    v_readlane_b32 s43, v216, 48
    v_mov_b32 v216, s40
    v_add_f32 v216, s41, v216
    v_add_f32 v216, s42, v216
    v_add_f32 v216, s43, v216
    v_mul_f32 v216, 0x3ae38e39, v216
    v_sub_f32 v64, v64, v216
    v_sub_f32 v65, v65, v216
    v_sub_f32 v66, v66, v216
    v_sub_f32 v67, v67, v216
    v_sub_f32 v68, v68, v216
    v_sub_f32 v69, v69, v216
    v_sub_f32 v70, v70, v216
    v_sub_f32 v71, v71, v216
    v_sub_f32 v72, v72, v216
    v_mul_f32 v217, v64, v64
    v_fmac_f32 v217, v65, v65
    v_fmac_f32 v217, v66, v66
    v_fmac_f32 v217, v67, v67
    v_fmac_f32 v217, v68, v68
    v_fmac_f32 v217, v69, v69
    v_fmac_f32 v217, v70, v70
    v_fmac_f32 v217, v71, v71
    v_fmac_f32 v217, v72, v72
    s_nop 1
    v_add_f32_dpp v217, v217, v217 row_ror:8 row_mask:0xf bank_mask:0xf
    s_nop 1
    v_add_f32_dpp v217, v217, v217 row_ror:4 row_mask:0xf bank_mask:0xf
    s_nop 1
    v_add_f32_dpp v217, v217, v217 row_ror:2 row_mask:0xf bank_mask:0xf
    s_nop 1
    v_add_f32_dpp v217, v217, v217 row_ror:1 row_mask:0xf bank_mask:0xf
    s_nop 0
    v_readlane_b32 s40, v217, 0
    v_readlane_b32 s41, v217, 16
    v_readlane_b32 s42, v217, 32
    v_readlane_b32 s43, v217, 48
    v_mov_b32 v217, s40
    v_add_f32 v217, s41, v217
    v_add_f32 v217, s42, v217
    v_add_f32 v217, s43, v217
    v_mov_b32 v218, 0x3727c5ac
    v_fmac_f32 v218, 0x3ae38e39, v217
    v_rsq_f32 v218, v218
    s_nop 0
    v_mul_f32 v64, v64, v218
    v_mul_f32 v65, v65, v218
    v_mul_f32 v66, v66, v218
    v_mul_f32 v67, v67, v218
    v_mul_f32 v68, v68, v218
    v_mul_f32 v69, v69, v218
    v_mul_f32 v70, v70, v218
    v_mul_f32 v71, v71, v218
    v_mul_f32 v72, v72, v218
    v_add_f32 v219, 1.0, v100
    v_fma_f32 v64, v64, v219, v109
    ds_write_b32 v224, v64 offset:0
    v_add_f32 v219, 1.0, v101
    v_fma_f32 v65, v65, v219, v110
    ds_write_b32 v224, v65 offset:2048
    v_add_f32 v219, 1.0, v102
    v_fma_f32 v66, v66, v219, v111
    ds_write_b32 v224, v66 offset:4096
    v_add_f32 v219, 1.0, v103
    v_fma_f32 v67, v67, v219, v112
    ds_write_b32 v224, v67 offset:6144
    v_add_f32 v219, 1.0, v104
    v_fma_f32 v68, v68, v219, v113
    ds_write_b32 v224, v68 offset:8192
    v_add_f32 v219, 1.0, v105
    v_fma_f32 v69, v69, v219, v114
    ds_write_b32 v224, v69 offset:10240
    v_add_f32 v219, 1.0, v106
    v_fma_f32 v70, v70, v219, v115
    ds_write_b32 v224, v70 offset:12288
    v_add_f32 v219, 1.0, v107
    v_fma_f32 v71, v71, v219, v116
    ds_write_b32 v224, v71 offset:14336
    v_add_f32 v219, 1.0, v108
    v_fma_f32 v72, v72, v219, v117
    ds_write_b32 v224, v72 offset:16384
    s_waitcnt vmcnt(0)
    v_add_u32 v221, 2304, v221
    v_add_u32 v222, 18432, v220
    v_add_u32 v223, 23040, v220
    v_add_u32 v227, 20736, v220
    buffer_load_dword v64, v221, s[12:15], s48 offen offset:0
    buffer_load_dword v65, v221, s[12:15], s48 offen offset:256
    buffer_load_dword v66, v221, s[12:15], s48 offen offset:512
    buffer_load_dword v67, v221, s[12:15], s48 offen offset:768
    buffer_load_dword v68, v221, s[12:15], s48 offen offset:1024
    buffer_load_dword v69, v221, s[12:15], s48 offen offset:1280
    buffer_load_dword v70, v221, s[12:15], s48 offen offset:1536
    buffer_load_dword v71, v221, s[12:15], s48 offen offset:1792
    buffer_load_dword v72, v221, s[12:15], s48 offen offset:2048
    buffer_load_dword v73, v221, s[12:15], s49 offen offset:0
    buffer_load_dword v74, v221, s[12:15], s49 offen offset:256
    buffer_load_dword v75, v221, s[12:15], s49 offen offset:512
    buffer_load_dword v76, v221, s[12:15], s49 offen offset:768
    buffer_load_dword v77, v221, s[12:15], s49 offen offset:1024
    buffer_load_dword v78, v221, s[12:15], s49 offen offset:1280
    buffer_load_dword v79, v221, s[12:15], s49 offen offset:1536
    buffer_load_dword v80, v221, s[12:15], s49 offen offset:1792
    buffer_load_dword v81, v221, s[12:15], s49 offen offset:2048
    buffer_load_dword v82, v221, s[12:15], s50 offen offset:0
    buffer_load_dword v83, v221, s[12:15], s50 offen offset:256
    buffer_load_dword v84, v221, s[12:15], s50 offen offset:512
    buffer_load_dword v85, v221, s[12:15], s50 offen offset:768
    buffer_load_dword v86, v221, s[12:15], s50 offen offset:1024
    buffer_load_dword v87, v221, s[12:15], s50 offen offset:1280
    buffer_load_dword v88, v221, s[12:15], s50 offen offset:1536
    buffer_load_dword v89, v221, s[12:15], s50 offen offset:1792
    buffer_load_dword v90, v221, s[12:15], s50 offen offset:2048
    buffer_load_dword v91, v221, s[12:15], s51 offen offset:0
    buffer_load_dword v92, v221, s[12:15], s51 offen offset:256
    buffer_load_dword v93, v221, s[12:15], s51 offen offset:512
    buffer_load_dword v94, v221, s[12:15], s51 offen offset:768
    buffer_load_dword v95, v221, s[12:15], s51 offen offset:1024
    buffer_load_dword v96, v221, s[12:15], s51 offen offset:1280
    buffer_load_dword v97, v221, s[12:15], s51 offen offset:1536
    buffer_load_dword v98, v221, s[12:15], s51 offen offset:1792
    buffer_load_dword v99, v221, s[12:15], s51 offen offset:2048
    buffer_load_dword v8, v221, s[12:15], s52 offen offset:0
    buffer_load_dword v9, v221, s[12:15], s52 offen offset:256
    buffer_load_dword v10, v221, s[12:15], s52 offen offset:512
    buffer_load_dword v11, v221, s[12:15], s52 offen offset:768
    buffer_load_dword v12, v221, s[12:15], s52 offen offset:1024
    buffer_load_dword v13, v221, s[12:15], s52 offen offset:1280
    buffer_load_dword v14, v221, s[12:15], s52 offen offset:1536
    buffer_load_dword v15, v221, s[12:15], s52 offen offset:1792
    buffer_load_dword v16, v221, s[12:15], s52 offen offset:2048
    buffer_load_dword v17, v221, s[12:15], s53 offen offset:0
    buffer_load_dword v18, v221, s[12:15], s53 offen offset:256
    buffer_load_dword v19, v221, s[12:15], s53 offen offset:512
    buffer_load_dword v20, v221, s[12:15], s53 offen offset:768
    buffer_load_dword v21, v221, s[12:15], s53 offen offset:1024
    buffer_load_dword v22, v221, s[12:15], s53 offen offset:1280
    buffer_load_dword v23, v221, s[12:15], s53 offen offset:1536
    buffer_load_dword v24, v221, s[12:15], s53 offen offset:1792
    buffer_load_dword v25, v221, s[12:15], s53 offen offset:2048
    buffer_load_dword v26, v221, s[12:15], s54 offen offset:0
    buffer_load_dword v27, v221, s[12:15], s54 offen offset:256
    buffer_load_dword v28, v221, s[12:15], s54 offen offset:512
    buffer_load_dword v29, v221, s[12:15], s54 offen offset:768
    buffer_load_dword v30, v221, s[12:15], s54 offen offset:1024
    buffer_load_dword v31, v221, s[12:15], s54 offen offset:1280
    buffer_load_dword v32, v221, s[12:15], s54 offen offset:1536
    buffer_load_dword v33, v221, s[12:15], s54 offen offset:1792
    buffer_load_dword v34, v221, s[12:15], s54 offen offset:2048
    buffer_load_dword v35, v221, s[12:15], s55 offen offset:0
    buffer_load_dword v36, v221, s[12:15], s55 offen offset:256
    buffer_load_dword v37, v221, s[12:15], s55 offen offset:512
    buffer_load_dword v38, v221, s[12:15], s55 offen offset:768
    buffer_load_dword v39, v221, s[12:15], s55 offen offset:1024
    buffer_load_dword v40, v221, s[12:15], s55 offen offset:1280
    buffer_load_dword v41, v221, s[12:15], s55 offen offset:1536
    buffer_load_dword v42, v221, s[12:15], s55 offen offset:1792
    buffer_load_dword v43, v221, s[12:15], s55 offen offset:2048
    buffer_load_ushort v44, v226, s[16:19], 0 offen offset:1152
    buffer_load_dword v53, v222, s[12:15], 0 offen offset:0
    buffer_load_dword v100, v223, s[12:15], 0 offen offset:0
    buffer_load_dword v109, v227, s[12:15], 0 offen offset:0
    buffer_load_ushort v45, v226, s[16:19], 0 offen offset:1280
    buffer_load_dword v54, v222, s[12:15], 0 offen offset:256
    buffer_load_dword v101, v223, s[12:15], 0 offen offset:256
    buffer_load_dword v110, v227, s[12:15], 0 offen offset:256
    buffer_load_ushort v46, v226, s[16:19], 0 offen offset:1408
    buffer_load_dword v55, v222, s[12:15], 0 offen offset:512
    buffer_load_dword v102, v223, s[12:15], 0 offen offset:512
    buffer_load_dword v111, v227, s[12:15], 0 offen offset:512
    buffer_load_ushort v47, v226, s[16:19], 0 offen offset:1536
    buffer_load_dword v56, v222, s[12:15], 0 offen offset:768
    buffer_load_dword v103, v223, s[12:15], 0 offen offset:768
    buffer_load_dword v112, v227, s[12:15], 0 offen offset:768
    buffer_load_ushort v48, v226, s[16:19], 0 offen offset:1664
    buffer_load_dword v57, v222, s[12:15], 0 offen offset:1024
    buffer_load_dword v104, v223, s[12:15], 0 offen offset:1024
    buffer_load_dword v113, v227, s[12:15], 0 offen offset:1024
    buffer_load_ushort v49, v226, s[16:19], 0 offen offset:1792
    buffer_load_dword v58, v222, s[12:15], 0 offen offset:1280
    buffer_load_dword v105, v223, s[12:15], 0 offen offset:1280
    buffer_load_dword v114, v227, s[12:15], 0 offen offset:1280
    buffer_load_ushort v50, v226, s[16:19], 0 offen offset:1920
    buffer_load_dword v59, v222, s[12:15], 0 offen offset:1536
    buffer_load_dword v106, v223, s[12:15], 0 offen offset:1536
    buffer_load_dword v115, v227, s[12:15], 0 offen offset:1536
    buffer_load_ushort v51, v226, s[16:19], 0 offen offset:2048
    buffer_load_dword v60, v222, s[12:15], 0 offen offset:1792
    buffer_load_dword v107, v223, s[12:15], 0 offen offset:1792
    buffer_load_dword v116, v227, s[12:15], 0 offen offset:1792
    buffer_load_ushort v52, v226, s[16:19], 0 offen offset:2176
    buffer_load_dword v61, v222, s[12:15], 0 offen offset:2048
    buffer_load_dword v108, v223, s[12:15], 0 offen offset:2048
    buffer_load_dword v117, v227, s[12:15], 0 offen offset:2048
    s_waitcnt vmcnt(0)
    v_add_f32 v64, v64, v73
    v_add_f32 v64, v64, v82
    v_add_f32 v64, v64, v91
    v_add_f32 v64, v64, v8
    v_add_f32 v64, v64, v17
    v_add_f32 v64, v64, v26
    v_add_f32 v64, v64, v35
    v_lshlrev_b32 v44, 16, v44
    v_fma_f32 v64, v64, v53, v44
    v_add_f32 v65, v65, v74
    v_add_f32 v65, v65, v83
    v_add_f32 v65, v65, v92
    v_add_f32 v65, v65, v9
    v_add_f32 v65, v65, v18
    v_add_f32 v65, v65, v27
    v_add_f32 v65, v65, v36
    v_lshlrev_b32 v45, 16, v45
    v_fma_f32 v65, v65, v54, v45
    v_add_f32 v66, v66, v75
    v_add_f32 v66, v66, v84
    v_add_f32 v66, v66, v93
    v_add_f32 v66, v66, v10
    v_add_f32 v66, v66, v19
    v_add_f32 v66, v66, v28
    v_add_f32 v66, v66, v37
    v_lshlrev_b32 v46, 16, v46
    v_fma_f32 v66, v66, v55, v46
    v_add_f32 v67, v67, v76
    v_add_f32 v67, v67, v85
    v_add_f32 v67, v67, v94
    v_add_f32 v67, v67, v11
    v_add_f32 v67, v67, v20
    v_add_f32 v67, v67, v29
    v_add_f32 v67, v67, v38
    v_lshlrev_b32 v47, 16, v47
    v_fma_f32 v67, v67, v56, v47
    v_add_f32 v68, v68, v77
    v_add_f32 v68, v68, v86
    v_add_f32 v68, v68, v95
    v_add_f32 v68, v68, v12
    v_add_f32 v68, v68, v21
    v_add_f32 v68, v68, v30
    v_add_f32 v68, v68, v39
    v_lshlrev_b32 v48, 16, v48
    v_fma_f32 v68, v68, v57, v48
    v_add_f32 v69, v69, v78
    v_add_f32 v69, v69, v87
    v_add_f32 v69, v69, v96
    v_add_f32 v69, v69, v13
    v_add_f32 v69, v69, v22
    v_add_f32 v69, v69, v31
    v_add_f32 v69, v69, v40
    v_lshlrev_b32 v49, 16, v49
    v_fma_f32 v69, v69, v58, v49
    v_add_f32 v70, v70, v79
    v_add_f32 v70, v70, v88
    v_add_f32 v70, v70, v97
    v_add_f32 v70, v70, v14
    v_add_f32 v70, v70, v23
    v_add_f32 v70, v70, v32
    v_add_f32 v70, v70, v41
    v_lshlrev_b32 v50, 16, v50
    v_fma_f32 v70, v70, v59, v50
    v_add_f32 v71, v71, v80
    v_add_f32 v71, v71, v89
    v_add_f32 v71, v71, v98
    v_add_f32 v71, v71, v15
    v_add_f32 v71, v71, v24
    v_add_f32 v71, v71, v33
    v_add_f32 v71, v71, v42
    v_lshlrev_b32 v51, 16, v51
    v_fma_f32 v71, v71, v60, v51
    v_add_f32 v72, v72, v81
    v_add_f32 v72, v72, v90
    v_add_f32 v72, v72, v99
    v_add_f32 v72, v72, v16
    v_add_f32 v72, v72, v25
    v_add_f32 v72, v72, v34
    v_add_f32 v72, v72, v43
    v_lshlrev_b32 v52, 16, v52
    v_fma_f32 v72, v72, v61, v52
    s_cmp_lg_u32 s2, 0
    s_cbranch_scc1 L_skipx1_1
    v_add_u32 v225, 196608, v221
    buffer_store_dword v64, v225, s[12:15], 0 offen offset:0
    buffer_store_dword v65, v225, s[12:15], 0 offen offset:256
    buffer_store_dword v66, v225, s[12:15], 0 offen offset:512
    buffer_store_dword v67, v225, s[12:15], 0 offen offset:768
    buffer_store_dword v68, v225, s[12:15], 0 offen offset:1024
    buffer_store_dword v69, v225, s[12:15], 0 offen offset:1280
    buffer_store_dword v70, v225, s[12:15], 0 offen offset:1536
    buffer_store_dword v71, v225, s[12:15], 0 offen offset:1792
    buffer_store_dword v72, v225, s[12:15], 0 offen offset:2048
L_skipx1_1:
    v_add_f32 v216, v64, v65
    v_add_f32 v216, v216, v66
    v_add_f32 v216, v216, v67
    v_add_f32 v216, v216, v68
    v_add_f32 v216, v216, v69
    v_add_f32 v216, v216, v70
    v_add_f32 v216, v216, v71
    v_add_f32 v216, v216, v72
    s_nop 1
    v_add_f32_dpp v216, v216, v216 row_ror:8 row_mask:0xf bank_mask:0xf
    s_nop 1
    v_add_f32_dpp v216, v216, v216 row_ror:4 row_mask:0xf bank_mask:0xf
    s_nop 1
    v_add_f32_dpp v216, v216, v216 row_ror:2 row_mask:0xf bank_mask:0xf
    s_nop 1
    v_add_f32_dpp v216, v216, v216 row_ror:1 row_mask:0xf bank_mask:0xf
    s_nop 0
    v_readlane_b32 s40, v216, 0
    v_readlane_b32 s41, v216, 16
    v_readlane_b32 s42, v216, 32
    v_readlane_b32 s43, v216, 48
    v_mov_b32 v216, s40
    v_add_f32 v216, s41, v216
    v_add_f32 v216, s42, v216
    v_add_f32 v216, s43, v216
    v_mul_f32 v216, 0x3ae38e39, v216
    v_sub_f32 v64, v64, v216
    v_sub_f32 v65, v65, v216
    v_sub_f32 v66, v66, v216
    v_sub_f32 v67, v67, v216
    v_sub_f32 v68, v68, v216
    v_sub_f32 v69, v69, v216
    v_sub_f32 v70, v70, v216
    v_sub_f32 v71, v71, v216
    v_sub_f32 v72, v72, v216
    v_mul_f32 v217, v64, v64
    v_fmac_f32 v217, v65, v65
    v_fmac_f32 v217, v66, v66
    v_fmac_f32 v217, v67, v67
    v_fmac_f32 v217, v68, v68
    v_fmac_f32 v217, v69, v69
    v_fmac_f32 v217, v70, v70
    v_fmac_f32 v217, v71, v71
    v_fmac_f32 v217, v72, v72
    s_nop 1
    v_add_f32_dpp v217, v217, v217 row_ror:8 row_mask:0xf bank_mask:0xf
    s_nop 1
    v_add_f32_dpp v217, v217, v217 row_ror:4 row_mask:0xf bank_mask:0xf
    s_nop 1
    v_add_f32_dpp v217, v217, v217 row_ror:2 row_mask:0xf bank_mask:0xf
    s_nop 1
    v_add_f32_dpp v217, v217, v217 row_ror:1 row_mask:0xf bank_mask:0xf
    s_nop 0
    v_readlane_b32 s40, v217, 0
    v_readlane_b32 s41, v217, 16
    v_readlane_b32 s42, v217, 32
    v_readlane_b32 s43, v217, 48
    v_mov_b32 v217, s40
    v_add_f32 v217, s41, v217
    v_add_f32 v217, s42, v217
    v_add_f32 v217, s43, v217
    v_mov_b32 v218, 0x3727c5ac
    v_fmac_f32 v218, 0x3ae38e39, v217
    v_rsq_f32 v218, v218
    s_nop 0
    v_mul_f32 v64, v64, v218
    v_mul_f32 v65, v65, v218
    v_mul_f32 v66, v66, v218
    v_mul_f32 v67, v67, v218
    v_mul_f32 v68, v68, v218
    v_mul_f32 v69, v69, v218
    v_mul_f32 v70, v70, v218
    v_mul_f32 v71, v71, v218
    v_mul_f32 v72, v72, v218
    v_add_f32 v219, 1.0, v100
    v_fma_f32 v64, v64, v219, v109
    ds_write_b32 v224, v64 offset:4
    v_add_f32 v219, 1.0, v101
    v_fma_f32 v65, v65, v219, v110
    ds_write_b32 v224, v65 offset:2052
    v_add_f32 v219, 1.0, v102
    v_fma_f32 v66, v66, v219, v111
    ds_write_b32 v224, v66 offset:4100
    v_add_f32 v219, 1.0, v103
    v_fma_f32 v67, v67, v219, v112
    ds_write_b32 v224, v67 offset:6148
    v_add_f32 v219, 1.0, v104
    v_fma_f32 v68, v68, v219, v113
    ds_write_b32 v224, v68 offset:8196
    v_add_f32 v219, 1.0, v105
    v_fma_f32 v69, v69, v219, v114
    ds_write_b32 v224, v69 offset:10244
    v_add_f32 v219, 1.0, v106
    v_fma_f32 v70, v70, v219, v115
    ds_write_b32 v224, v70 offset:12292
    v_add_f32 v219, 1.0, v107
    v_fma_f32 v71, v71, v219, v116
    ds_write_b32 v224, v71 offset:14340
    v_add_f32 v219, 1.0, v108
    v_fma_f32 v72, v72, v219, v117
    ds_write_b32 v224, v72 offset:16388
    s_waitcnt vmcnt(0)
    s_waitcnt vmcnt(0) lgkmcnt(0)
    s_barrier
    v_mov_b32 v64, 0
    v_mov_b32 v65, 0
    v_mov_b32 v66, 0
    v_mov_b32 v67, 0
    v_mov_b32 v68, 0
    v_mov_b32 v69, 0
    v_mov_b32 v70, 0
    v_mov_b32 v71, 0
    v_mov_b32 v72, 0
    v_mov_b32 v73, 0
    v_mov_b32 v74, 0
    v_mov_b32 v75, 0
    v_mov_b32 v76, 0
    v_mov_b32 v77, 0
    v_mov_b32 v78, 0
    v_mov_b32 v79, 0
    v_mov_b32 v80, 0
    v_mov_b32 v81, 0
    v_mov_b32 v82, 0
    v_mov_b32 v83, 0
    v_mov_b32 v84, 0
    v_mov_b32 v85, 0
    v_mov_b32 v86, 0
    v_mov_b32 v87, 0
    v_mov_b32 v88, 0
    v_mov_b32 v89, 0
    v_mov_b32 v90, 0
    v_mov_b32 v91, 0
    v_mov_b32 v92, 0
    v_mov_b32 v93, 0
    v_mov_b32 v94, 0
    v_mov_b32 v95, 0
    v_mov_b32 v96, 0
    v_mov_b32 v97, 0
    v_mov_b32 v98, 0
    v_mov_b32 v99, 0
    v_mov_b32 v100, 0
    v_mov_b32 v101, 0
    v_mov_b32 v102, 0
    v_mov_b32 v103, 0
    v_mov_b32 v104, 0
    v_mov_b32 v105, 0
    v_mov_b32 v106, 0
    v_mov_b32 v107, 0
    v_mov_b32 v108, 0
    v_mov_b32 v109, 0
    v_mov_b32 v110, 0
    v_mov_b32 v111, 0
    v_mov_b32 v112, 0
    v_mov_b32 v113, 0
    v_mov_b32 v114, 0
    v_mov_b32 v115, 0
    v_mov_b32 v116, 0
    v_mov_b32 v117, 0
    v_mov_b32 v118, 0
    v_mov_b32 v119, 0
    v_mov_b32 v120, 0
    v_mov_b32 v121, 0
    v_mov_b32 v122, 0
    v_mov_b32 v123, 0
    v_mov_b32 v124, 0
    v_mov_b32 v125, 0
    v_mov_b32 v126, 0
    v_mov_b32 v127, 0
    ds_read_b128 v[200:203], v7 offset:0
    ds_read_b128 v[204:207], v7 offset:16
    v_lshlrev_b32 v208, 16, v128
    v_and_b32 v209, 0xffff0000, v128
    v_lshlrev_b32 v210, 16, v129
    v_and_b32 v211, 0xffff0000, v129
    v_lshlrev_b32 v212, 16, v130
    v_and_b32 v213, 0xffff0000, v130
    v_lshlrev_b32 v214, 16, v131
    v_and_b32 v215, 0xffff0000, v131
    s_waitcnt lgkmcnt(0)
    v_fmac_f32 v64, v200, v208
    v_fmac_f32 v65, v200, v209
    v_fmac_f32 v66, v200, v210
    v_fmac_f32 v67, v200, v211
    v_fmac_f32 v68, v200, v212
    v_fmac_f32 v69, v200, v213
    v_fmac_f32 v70, v200, v214
    v_fmac_f32 v71, v200, v215
    v_fmac_f32 v72, v201, v208
    v_fmac_f32 v73, v201, v209
    v_fmac_f32 v74, v201, v210
    v_fmac_f32 v75, v201, v211
    v_fmac_f32 v76, v201, v212
    v_fmac_f32 v77, v201, v213
    v_fmac_f32 v78, v201, v214
    v_fmac_f32 v79, v201, v215
    v_fmac_f32 v80, v202, v208
    v_fmac_f32 v81, v202, v209
    v_fmac_f32 v82, v202, v210
    v_fmac_f32 v83, v202, v211
    v_fmac_f32 v84, v202, v212
    v_fmac_f32 v85, v202, v213
    v_fmac_f32 v86, v202, v214
    v_fmac_f32 v87, v202, v215
    v_fmac_f32 v88, v203, v208
    v_fmac_f32 v89, v203, v209
    v_fmac_f32 v90, v203, v210
    v_fmac_f32 v91, v203, v211
    v_fmac_f32 v92, v203, v212
    v_fmac_f32 v93, v203, v213
    v_fmac_f32 v94, v203, v214
    v_fmac_f32 v95, v203, v215
    v_fmac_f32 v96, v204, v208
    v_fmac_f32 v97, v204, v209
    v_fmac_f32 v98, v204, v210
    v_fmac_f32 v99, v204, v211
    v_fmac_f32 v100, v204, v212
    v_fmac_f32 v101, v204, v213
    v_fmac_f32 v102, v204, v214
    v_fmac_f32 v103, v204, v215
    v_fmac_f32 v104, v205, v208
    v_fmac_f32 v105, v205, v209
    v_fmac_f32 v106, v205, v210
    v_fmac_f32 v107, v205, v211
    v_fmac_f32 v108, v205, v212
    v_fmac_f32 v109, v205, v213
    v_fmac_f32 v110, v205, v214
    v_fmac_f32 v111, v205, v215
    v_fmac_f32 v112, v206, v208
    v_fmac_f32 v113, v206, v209
    v_fmac_f32 v114, v206, v210
    v_fmac_f32 v115, v206, v211
    v_fmac_f32 v116, v206, v212
    v_fmac_f32 v117, v206, v213
    v_fmac_f32 v118, v206, v214
    v_fmac_f32 v119, v206, v215
    v_fmac_f32 v120, v207, v208
    v_fmac_f32 v121, v207, v209
    v_fmac_f32 v122, v207, v210
    v_fmac_f32 v123, v207, v211
    v_fmac_f32 v124, v207, v212
    v_fmac_f32 v125, v207, v213
    v_fmac_f32 v126, v207, v214
    v_fmac_f32 v127, v207, v215
    ds_read_b128 v[200:203], v7 offset:1024
    ds_read_b128 v[204:207], v7 offset:1040
    v_lshlrev_b32 v208, 16, v132
    v_and_b32 v209, 0xffff0000, v132
    v_lshlrev_b32 v210, 16, v133
    v_and_b32 v211, 0xffff0000, v133
    v_lshlrev_b32 v212, 16, v134
    v_and_b32 v213, 0xffff0000, v134
    v_lshlrev_b32 v214, 16, v135
    v_and_b32 v215, 0xffff0000, v135
    s_waitcnt lgkmcnt(0)
    v_fmac_f32 v64, v200, v208
    v_fmac_f32 v65, v200, v209
    v_fmac_f32 v66, v200, v210
    v_fmac_f32 v67, v200, v211
    v_fmac_f32 v68, v200, v212
    v_fmac_f32 v69, v200, v213
    v_fmac_f32 v70, v200, v214
    v_fmac_f32 v71, v200, v215
    v_fmac_f32 v72, v201, v208
    v_fmac_f32 v73, v201, v209
    v_fmac_f32 v74, v201, v210
    v_fmac_f32 v75, v201, v211
    v_fmac_f32 v76, v201, v212
    v_fmac_f32 v77, v201, v213
    v_fmac_f32 v78, v201, v214
    v_fmac_f32 v79, v201, v215
    v_fmac_f32 v80, v202, v208
    v_fmac_f32 v81, v202, v209
    v_fmac_f32 v82, v202, v210
    v_fmac_f32 v83, v202, v211
    v_fmac_f32 v84, v202, v212
    v_fmac_f32 v85, v202, v213
    v_fmac_f32 v86, v202, v214
    v_fmac_f32 v87, v202, v215
    v_fmac_f32 v88, v203, v208
    v_fmac_f32 v89, v203, v209
    v_fmac_f32 v90, v203, v210
    v_fmac_f32 v91, v203, v211
    v_fmac_f32 v92, v203, v212
    v_fmac_f32 v93, v203, v213
    v_fmac_f32 v94, v203, v214
    v_fmac_f32 v95, v203, v215
    v_fmac_f32 v96, v204, v208
    v_fmac_f32 v97, v204, v209
    v_fmac_f32 v98, v204, v210
    v_fmac_f32 v99, v204, v211
    v_fmac_f32 v100, v204, v212
    v_fmac_f32 v101, v204, v213
    v_fmac_f32 v102, v204, v214
    v_fmac_f32 v103, v204, v215
    v_fmac_f32 v104, v205, v208
    v_fmac_f32 v105, v205, v209
    v_fmac_f32 v106, v205, v210
    v_fmac_f32 v107, v205, v211
    v_fmac_f32 v108, v205, v212
    v_fmac_f32 v109, v205, v213
    v_fmac_f32 v110, v205, v214
    v_fmac_f32 v111, v205, v215
    v_fmac_f32 v112, v206, v208
    v_fmac_f32 v113, v206, v209
    v_fmac_f32 v114, v206, v210
    v_fmac_f32 v115, v206, v211
    v_fmac_f32 v116, v206, v212
    v_fmac_f32 v117, v206, v213
    v_fmac_f32 v118, v206, v214
    v_fmac_f32 v119, v206, v215
    v_fmac_f32 v120, v207, v208
    v_fmac_f32 v121, v207, v209
    v_fmac_f32 v122, v207, v210
    v_fmac_f32 v123, v207, v211
    v_fmac_f32 v124, v207, v212
    v_fmac_f32 v125, v207, v213
    v_fmac_f32 v126, v207, v214
    v_fmac_f32 v127, v207, v215
    ds_read_b128 v[200:203], v7 offset:2048
    ds_read_b128 v[204:207], v7 offset:2064
    v_lshlrev_b32 v208, 16, v136
    v_and_b32 v209, 0xffff0000, v136
    v_lshlrev_b32 v210, 16, v137
    v_and_b32 v211, 0xffff0000, v137
    v_lshlrev_b32 v212, 16, v138
    v_and_b32 v213, 0xffff0000, v138
    v_lshlrev_b32 v214, 16, v139
    v_and_b32 v215, 0xffff0000, v139
    s_waitcnt lgkmcnt(0)
    v_fmac_f32 v64, v200, v208
    v_fmac_f32 v65, v200, v209
    v_fmac_f32 v66, v200, v210
    v_fmac_f32 v67, v200, v211
    v_fmac_f32 v68, v200, v212
    v_fmac_f32 v69, v200, v213
    v_fmac_f32 v70, v200, v214
    v_fmac_f32 v71, v200, v215
    v_fmac_f32 v72, v201, v208
    v_fmac_f32 v73, v201, v209
    v_fmac_f32 v74, v201, v210
    v_fmac_f32 v75, v201, v211
    v_fmac_f32 v76, v201, v212
    v_fmac_f32 v77, v201, v213
    v_fmac_f32 v78, v201, v214
    v_fmac_f32 v79, v201, v215
    v_fmac_f32 v80, v202, v208
    v_fmac_f32 v81, v202, v209
    v_fmac_f32 v82, v202, v210
    v_fmac_f32 v83, v202, v211
    v_fmac_f32 v84, v202, v212
    v_fmac_f32 v85, v202, v213
    v_fmac_f32 v86, v202, v214
    v_fmac_f32 v87, v202, v215
    v_fmac_f32 v88, v203, v208
    v_fmac_f32 v89, v203, v209
    v_fmac_f32 v90, v203, v210
    v_fmac_f32 v91, v203, v211
    v_fmac_f32 v92, v203, v212
    v_fmac_f32 v93, v203, v213
    v_fmac_f32 v94, v203, v214
    v_fmac_f32 v95, v203, v215
    v_fmac_f32 v96, v204, v208
    v_fmac_f32 v97, v204, v209
    v_fmac_f32 v98, v204, v210
    v_fmac_f32 v99, v204, v211
    v_fmac_f32 v100, v204, v212
    v_fmac_f32 v101, v204, v213
    v_fmac_f32 v102, v204, v214
    v_fmac_f32 v103, v204, v215
    v_fmac_f32 v104, v205, v208
    v_fmac_f32 v105, v205, v209
    v_fmac_f32 v106, v205, v210
    v_fmac_f32 v107, v205, v211
    v_fmac_f32 v108, v205, v212
    v_fmac_f32 v109, v205, v213
    v_fmac_f32 v110, v205, v214
    v_fmac_f32 v111, v205, v215
    v_fmac_f32 v112, v206, v208
    v_fmac_f32 v113, v206, v209
    v_fmac_f32 v114, v206, v210
    v_fmac_f32 v115, v206, v211
    v_fmac_f32 v116, v206, v212
    v_fmac_f32 v117, v206, v213
    v_fmac_f32 v118, v206, v214
    v_fmac_f32 v119, v206, v215
    v_fmac_f32 v120, v207, v208
    v_fmac_f32 v121, v207, v209
    v_fmac_f32 v122, v207, v210
    v_fmac_f32 v123, v207, v211
    v_fmac_f32 v124, v207, v212
    v_fmac_f32 v125, v207, v213
    v_fmac_f32 v126, v207, v214
    v_fmac_f32 v127, v207, v215
    ds_read_b128 v[200:203], v7 offset:3072
    ds_read_b128 v[204:207], v7 offset:3088
    v_lshlrev_b32 v208, 16, v140
    v_and_b32 v209, 0xffff0000, v140
    v_lshlrev_b32 v210, 16, v141
    v_and_b32 v211, 0xffff0000, v141
    v_lshlrev_b32 v212, 16, v142
    v_and_b32 v213, 0xffff0000, v142
    v_lshlrev_b32 v214, 16, v143
    v_and_b32 v215, 0xffff0000, v143
    s_waitcnt lgkmcnt(0)
    v_fmac_f32 v64, v200, v208
    v_fmac_f32 v65, v200, v209
    v_fmac_f32 v66, v200, v210
    v_fmac_f32 v67, v200, v211
    v_fmac_f32 v68, v200, v212
    v_fmac_f32 v69, v200, v213
    v_fmac_f32 v70, v200, v214
    v_fmac_f32 v71, v200, v215
    v_fmac_f32 v72, v201, v208
    v_fmac_f32 v73, v201, v209
    v_fmac_f32 v74, v201, v210
    v_fmac_f32 v75, v201, v211
    v_fmac_f32 v76, v201, v212
    v_fmac_f32 v77, v201, v213
    v_fmac_f32 v78, v201, v214
    v_fmac_f32 v79, v201, v215
    v_fmac_f32 v80, v202, v208
    v_fmac_f32 v81, v202, v209
    v_fmac_f32 v82, v202, v210
    v_fmac_f32 v83, v202, v211
    v_fmac_f32 v84, v202, v212
    v_fmac_f32 v85, v202, v213
    v_fmac_f32 v86, v202, v214
    v_fmac_f32 v87, v202, v215
    v_fmac_f32 v88, v203, v208
    v_fmac_f32 v89, v203, v209
    v_fmac_f32 v90, v203, v210
    v_fmac_f32 v91, v203, v211
    v_fmac_f32 v92, v203, v212
    v_fmac_f32 v93, v203, v213
    v_fmac_f32 v94, v203, v214
    v_fmac_f32 v95, v203, v215
    v_fmac_f32 v96, v204, v208
    v_fmac_f32 v97, v204, v209
    v_fmac_f32 v98, v204, v210
    v_fmac_f32 v99, v204, v211
    v_fmac_f32 v100, v204, v212
    v_fmac_f32 v101, v204, v213
    v_fmac_f32 v102, v204, v214
    v_fmac_f32 v103, v204, v215
    v_fmac_f32 v104, v205, v208
    v_fmac_f32 v105, v205, v209
    v_fmac_f32 v106, v205, v210
    v_fmac_f32 v107, v205, v211
    v_fmac_f32 v108, v205, v212
    v_fmac_f32 v109, v205, v213
    v_fmac_f32 v110, v205, v214
    v_fmac_f32 v111, v205, v215
    v_fmac_f32 v112, v206, v208
    v_fmac_f32 v113, v206, v209
    v_fmac_f32 v114, v206, v210
    v_fmac_f32 v115, v206, v211
    v_fmac_f32 v116, v206, v212
    v_fmac_f32 v117, v206, v213
    v_fmac_f32 v118, v206, v214
    v_fmac_f32 v119, v206, v215
    v_fmac_f32 v120, v207, v208
    v_fmac_f32 v121, v207, v209
    v_fmac_f32 v122, v207, v210
    v_fmac_f32 v123, v207, v211
    v_fmac_f32 v124, v207, v212
    v_fmac_f32 v125, v207, v213
    v_fmac_f32 v126, v207, v214
    v_fmac_f32 v127, v207, v215
    ds_read_b128 v[200:203], v7 offset:4096
    ds_read_b128 v[204:207], v7 offset:4112
    v_lshlrev_b32 v208, 16, v144
    v_and_b32 v209, 0xffff0000, v144
    v_lshlrev_b32 v210, 16, v145
    v_and_b32 v211, 0xffff0000, v145
    v_lshlrev_b32 v212, 16, v146
    v_and_b32 v213, 0xffff0000, v146
    v_lshlrev_b32 v214, 16, v147
    v_and_b32 v215, 0xffff0000, v147
    s_waitcnt lgkmcnt(0)
    v_fmac_f32 v64, v200, v208
    v_fmac_f32 v65, v200, v209
    v_fmac_f32 v66, v200, v210
    v_fmac_f32 v67, v200, v211
    v_fmac_f32 v68, v200, v212
    v_fmac_f32 v69, v200, v213
    v_fmac_f32 v70, v200, v214
    v_fmac_f32 v71, v200, v215
    v_fmac_f32 v72, v201, v208
    v_fmac_f32 v73, v201, v209
    v_fmac_f32 v74, v201, v210
    v_fmac_f32 v75, v201, v211
    v_fmac_f32 v76, v201, v212
    v_fmac_f32 v77, v201, v213
    v_fmac_f32 v78, v201, v214
    v_fmac_f32 v79, v201, v215
    v_fmac_f32 v80, v202, v208
    v_fmac_f32 v81, v202, v209
    v_fmac_f32 v82, v202, v210
    v_fmac_f32 v83, v202, v211
    v_fmac_f32 v84, v202, v212
    v_fmac_f32 v85, v202, v213
    v_fmac_f32 v86, v202, v214
    v_fmac_f32 v87, v202, v215
    v_fmac_f32 v88, v203, v208
    v_fmac_f32 v89, v203, v209
    v_fmac_f32 v90, v203, v210
    v_fmac_f32 v91, v203, v211
    v_fmac_f32 v92, v203, v212
    v_fmac_f32 v93, v203, v213
    v_fmac_f32 v94, v203, v214
    v_fmac_f32 v95, v203, v215
    v_fmac_f32 v96, v204, v208
    v_fmac_f32 v97, v204, v209
    v_fmac_f32 v98, v204, v210
    v_fmac_f32 v99, v204, v211
    v_fmac_f32 v100, v204, v212
    v_fmac_f32 v101, v204, v213
    v_fmac_f32 v102, v204, v214
    v_fmac_f32 v103, v204, v215
    v_fmac_f32 v104, v205, v208
    v_fmac_f32 v105, v205, v209
    v_fmac_f32 v106, v205, v210
    v_fmac_f32 v107, v205, v211
    v_fmac_f32 v108, v205, v212
    v_fmac_f32 v109, v205, v213
    v_fmac_f32 v110, v205, v214
    v_fmac_f32 v111, v205, v215
    v_fmac_f32 v112, v206, v208
    v_fmac_f32 v113, v206, v209
    v_fmac_f32 v114, v206, v210
    v_fmac_f32 v115, v206, v211
    v_fmac_f32 v116, v206, v212
    v_fmac_f32 v117, v206, v213
    v_fmac_f32 v118, v206, v214
    v_fmac_f32 v119, v206, v215
    v_fmac_f32 v120, v207, v208
    v_fmac_f32 v121, v207, v209
    v_fmac_f32 v122, v207, v210
    v_fmac_f32 v123, v207, v211
    v_fmac_f32 v124, v207, v212
    v_fmac_f32 v125, v207, v213
    v_fmac_f32 v126, v207, v214
    v_fmac_f32 v127, v207, v215
    ds_read_b128 v[200:203], v7 offset:5120
    ds_read_b128 v[204:207], v7 offset:5136
    v_lshlrev_b32 v208, 16, v148
    v_and_b32 v209, 0xffff0000, v148
    v_lshlrev_b32 v210, 16, v149
    v_and_b32 v211, 0xffff0000, v149
    v_lshlrev_b32 v212, 16, v150
    v_and_b32 v213, 0xffff0000, v150
    v_lshlrev_b32 v214, 16, v151
    v_and_b32 v215, 0xffff0000, v151
    s_waitcnt lgkmcnt(0)
    v_fmac_f32 v64, v200, v208
    v_fmac_f32 v65, v200, v209
    v_fmac_f32 v66, v200, v210
    v_fmac_f32 v67, v200, v211
    v_fmac_f32 v68, v200, v212
    v_fmac_f32 v69, v200, v213
    v_fmac_f32 v70, v200, v214
    v_fmac_f32 v71, v200, v215
    v_fmac_f32 v72, v201, v208
    v_fmac_f32 v73, v201, v209
    v_fmac_f32 v74, v201, v210
    v_fmac_f32 v75, v201, v211
    v_fmac_f32 v76, v201, v212
    v_fmac_f32 v77, v201, v213
    v_fmac_f32 v78, v201, v214
    v_fmac_f32 v79, v201, v215
    v_fmac_f32 v80, v202, v208
    v_fmac_f32 v81, v202, v209
    v_fmac_f32 v82, v202, v210
    v_fmac_f32 v83, v202, v211
    v_fmac_f32 v84, v202, v212
    v_fmac_f32 v85, v202, v213
    v_fmac_f32 v86, v202, v214
    v_fmac_f32 v87, v202, v215
    v_fmac_f32 v88, v203, v208
    v_fmac_f32 v89, v203, v209
    v_fmac_f32 v90, v203, v210
    v_fmac_f32 v91, v203, v211
    v_fmac_f32 v92, v203, v212
    v_fmac_f32 v93, v203, v213
    v_fmac_f32 v94, v203, v214
    v_fmac_f32 v95, v203, v215
    v_fmac_f32 v96, v204, v208
    v_fmac_f32 v97, v204, v209
    v_fmac_f32 v98, v204, v210
    v_fmac_f32 v99, v204, v211
    v_fmac_f32 v100, v204, v212
    v_fmac_f32 v101, v204, v213
    v_fmac_f32 v102, v204, v214
    v_fmac_f32 v103, v204, v215
    v_fmac_f32 v104, v205, v208
    v_fmac_f32 v105, v205, v209
    v_fmac_f32 v106, v205, v210
    v_fmac_f32 v107, v205, v211
    v_fmac_f32 v108, v205, v212
    v_fmac_f32 v109, v205, v213
    v_fmac_f32 v110, v205, v214
    v_fmac_f32 v111, v205, v215
    v_fmac_f32 v112, v206, v208
    v_fmac_f32 v113, v206, v209
    v_fmac_f32 v114, v206, v210
    v_fmac_f32 v115, v206, v211
    v_fmac_f32 v116, v206, v212
    v_fmac_f32 v117, v206, v213
    v_fmac_f32 v118, v206, v214
    v_fmac_f32 v119, v206, v215
    v_fmac_f32 v120, v207, v208
    v_fmac_f32 v121, v207, v209
    v_fmac_f32 v122, v207, v210
    v_fmac_f32 v123, v207, v211
    v_fmac_f32 v124, v207, v212
    v_fmac_f32 v125, v207, v213
    v_fmac_f32 v126, v207, v214
    v_fmac_f32 v127, v207, v215
    ds_read_b128 v[200:203], v7 offset:6144
    ds_read_b128 v[204:207], v7 offset:6160
    v_lshlrev_b32 v208, 16, v152
    v_and_b32 v209, 0xffff0000, v152
    v_lshlrev_b32 v210, 16, v153
    v_and_b32 v211, 0xffff0000, v153
    v_lshlrev_b32 v212, 16, v154
    v_and_b32 v213, 0xffff0000, v154
    v_lshlrev_b32 v214, 16, v155
    v_and_b32 v215, 0xffff0000, v155
    s_waitcnt lgkmcnt(0)
    v_fmac_f32 v64, v200, v208
    v_fmac_f32 v65, v200, v209
    v_fmac_f32 v66, v200, v210
    v_fmac_f32 v67, v200, v211
    v_fmac_f32 v68, v200, v212
    v_fmac_f32 v69, v200, v213
    v_fmac_f32 v70, v200, v214
    v_fmac_f32 v71, v200, v215
    v_fmac_f32 v72, v201, v208
    v_fmac_f32 v73, v201, v209
    v_fmac_f32 v74, v201, v210
    v_fmac_f32 v75, v201, v211
    v_fmac_f32 v76, v201, v212
    v_fmac_f32 v77, v201, v213
    v_fmac_f32 v78, v201, v214
    v_fmac_f32 v79, v201, v215
    v_fmac_f32 v80, v202, v208
    v_fmac_f32 v81, v202, v209
    v_fmac_f32 v82, v202, v210
    v_fmac_f32 v83, v202, v211
    v_fmac_f32 v84, v202, v212
    v_fmac_f32 v85, v202, v213
    v_fmac_f32 v86, v202, v214
    v_fmac_f32 v87, v202, v215
    v_fmac_f32 v88, v203, v208
    v_fmac_f32 v89, v203, v209
    v_fmac_f32 v90, v203, v210
    v_fmac_f32 v91, v203, v211
    v_fmac_f32 v92, v203, v212
    v_fmac_f32 v93, v203, v213
    v_fmac_f32 v94, v203, v214
    v_fmac_f32 v95, v203, v215
    v_fmac_f32 v96, v204, v208
    v_fmac_f32 v97, v204, v209
    v_fmac_f32 v98, v204, v210
    v_fmac_f32 v99, v204, v211
    v_fmac_f32 v100, v204, v212
    v_fmac_f32 v101, v204, v213
    v_fmac_f32 v102, v204, v214
    v_fmac_f32 v103, v204, v215
    v_fmac_f32 v104, v205, v208
    v_fmac_f32 v105, v205, v209
    v_fmac_f32 v106, v205, v210
    v_fmac_f32 v107, v205, v211
    v_fmac_f32 v108, v205, v212
    v_fmac_f32 v109, v205, v213
    v_fmac_f32 v110, v205, v214
    v_fmac_f32 v111, v205, v215
    v_fmac_f32 v112, v206, v208
    v_fmac_f32 v113, v206, v209
    v_fmac_f32 v114, v206, v210
    v_fmac_f32 v115, v206, v211
    v_fmac_f32 v116, v206, v212
    v_fmac_f32 v117, v206, v213
    v_fmac_f32 v118, v206, v214
    v_fmac_f32 v119, v206, v215
    v_fmac_f32 v120, v207, v208
    v_fmac_f32 v121, v207, v209
    v_fmac_f32 v122, v207, v210
    v_fmac_f32 v123, v207, v211
    v_fmac_f32 v124, v207, v212
    v_fmac_f32 v125, v207, v213
    v_fmac_f32 v126, v207, v214
    v_fmac_f32 v127, v207, v215
    ds_read_b128 v[200:203], v7 offset:7168
    ds_read_b128 v[204:207], v7 offset:7184
    v_lshlrev_b32 v208, 16, v156
    v_and_b32 v209, 0xffff0000, v156
    v_lshlrev_b32 v210, 16, v157
    v_and_b32 v211, 0xffff0000, v157
    v_lshlrev_b32 v212, 16, v158
    v_and_b32 v213, 0xffff0000, v158
    v_lshlrev_b32 v214, 16, v159
    v_and_b32 v215, 0xffff0000, v159
    s_waitcnt lgkmcnt(0)
    v_fmac_f32 v64, v200, v208
    v_fmac_f32 v65, v200, v209
    v_fmac_f32 v66, v200, v210
    v_fmac_f32 v67, v200, v211
    v_fmac_f32 v68, v200, v212
    v_fmac_f32 v69, v200, v213
    v_fmac_f32 v70, v200, v214
    v_fmac_f32 v71, v200, v215
    v_fmac_f32 v72, v201, v208
    v_fmac_f32 v73, v201, v209
    v_fmac_f32 v74, v201, v210
    v_fmac_f32 v75, v201, v211
    v_fmac_f32 v76, v201, v212
    v_fmac_f32 v77, v201, v213
    v_fmac_f32 v78, v201, v214
    v_fmac_f32 v79, v201, v215
    v_fmac_f32 v80, v202, v208
    v_fmac_f32 v81, v202, v209
    v_fmac_f32 v82, v202, v210
    v_fmac_f32 v83, v202, v211
    v_fmac_f32 v84, v202, v212
    v_fmac_f32 v85, v202, v213
    v_fmac_f32 v86, v202, v214
    v_fmac_f32 v87, v202, v215
    v_fmac_f32 v88, v203, v208
    v_fmac_f32 v89, v203, v209
    v_fmac_f32 v90, v203, v210
    v_fmac_f32 v91, v203, v211
    v_fmac_f32 v92, v203, v212
    v_fmac_f32 v93, v203, v213
    v_fmac_f32 v94, v203, v214
    v_fmac_f32 v95, v203, v215
    v_fmac_f32 v96, v204, v208
    v_fmac_f32 v97, v204, v209
    v_fmac_f32 v98, v204, v210
    v_fmac_f32 v99, v204, v211
    v_fmac_f32 v100, v204, v212
    v_fmac_f32 v101, v204, v213
    v_fmac_f32 v102, v204, v214
    v_fmac_f32 v103, v204, v215
    v_fmac_f32 v104, v205, v208
    v_fmac_f32 v105, v205, v209
    v_fmac_f32 v106, v205, v210
    v_fmac_f32 v107, v205, v211
    v_fmac_f32 v108, v205, v212
    v_fmac_f32 v109, v205, v213
    v_fmac_f32 v110, v205, v214
    v_fmac_f32 v111, v205, v215
    v_fmac_f32 v112, v206, v208
    v_fmac_f32 v113, v206, v209
    v_fmac_f32 v114, v206, v210
    v_fmac_f32 v115, v206, v211
    v_fmac_f32 v116, v206, v212
    v_fmac_f32 v117, v206, v213
    v_fmac_f32 v118, v206, v214
    v_fmac_f32 v119, v206, v215
    v_fmac_f32 v120, v207, v208
    v_fmac_f32 v121, v207, v209
    v_fmac_f32 v122, v207, v210
    v_fmac_f32 v123, v207, v211
    v_fmac_f32 v124, v207, v212
    v_fmac_f32 v125, v207, v213
    v_fmac_f32 v126, v207, v214
    v_fmac_f32 v127, v207, v215
    ds_read_b128 v[200:203], v7 offset:8192
    ds_read_b128 v[204:207], v7 offset:8208
    v_lshlrev_b32 v208, 16, v160
    v_and_b32 v209, 0xffff0000, v160
    v_lshlrev_b32 v210, 16, v161
    v_and_b32 v211, 0xffff0000, v161
    v_lshlrev_b32 v212, 16, v162
    v_and_b32 v213, 0xffff0000, v162
    v_lshlrev_b32 v214, 16, v163
    v_and_b32 v215, 0xffff0000, v163
    s_waitcnt lgkmcnt(0)
    v_fmac_f32 v64, v200, v208
    v_fmac_f32 v65, v200, v209
    v_fmac_f32 v66, v200, v210
    v_fmac_f32 v67, v200, v211
    v_fmac_f32 v68, v200, v212
    v_fmac_f32 v69, v200, v213
    v_fmac_f32 v70, v200, v214
    v_fmac_f32 v71, v200, v215
    v_fmac_f32 v72, v201, v208
    v_fmac_f32 v73, v201, v209
    v_fmac_f32 v74, v201, v210
    v_fmac_f32 v75, v201, v211
    v_fmac_f32 v76, v201, v212
    v_fmac_f32 v77, v201, v213
    v_fmac_f32 v78, v201, v214
    v_fmac_f32 v79, v201, v215
    v_fmac_f32 v80, v202, v208
    v_fmac_f32 v81, v202, v209
    v_fmac_f32 v82, v202, v210
    v_fmac_f32 v83, v202, v211
    v_fmac_f32 v84, v202, v212
    v_fmac_f32 v85, v202, v213
    v_fmac_f32 v86, v202, v214
    v_fmac_f32 v87, v202, v215
    v_fmac_f32 v88, v203, v208
    v_fmac_f32 v89, v203, v209
    v_fmac_f32 v90, v203, v210
    v_fmac_f32 v91, v203, v211
    v_fmac_f32 v92, v203, v212
    v_fmac_f32 v93, v203, v213
    v_fmac_f32 v94, v203, v214
    v_fmac_f32 v95, v203, v215
    v_fmac_f32 v96, v204, v208
    v_fmac_f32 v97, v204, v209
    v_fmac_f32 v98, v204, v210
    v_fmac_f32 v99, v204, v211
    v_fmac_f32 v100, v204, v212
    v_fmac_f32 v101, v204, v213
    v_fmac_f32 v102, v204, v214
    v_fmac_f32 v103, v204, v215
    v_fmac_f32 v104, v205, v208
    v_fmac_f32 v105, v205, v209
    v_fmac_f32 v106, v205, v210
    v_fmac_f32 v107, v205, v211
    v_fmac_f32 v108, v205, v212
    v_fmac_f32 v109, v205, v213
    v_fmac_f32 v110, v205, v214
    v_fmac_f32 v111, v205, v215
    v_fmac_f32 v112, v206, v208
    v_fmac_f32 v113, v206, v209
    v_fmac_f32 v114, v206, v210
    v_fmac_f32 v115, v206, v211
    v_fmac_f32 v116, v206, v212
    v_fmac_f32 v117, v206, v213
    v_fmac_f32 v118, v206, v214
    v_fmac_f32 v119, v206, v215
    v_fmac_f32 v120, v207, v208
    v_fmac_f32 v121, v207, v209
    v_fmac_f32 v122, v207, v210
    v_fmac_f32 v123, v207, v211
    v_fmac_f32 v124, v207, v212
    v_fmac_f32 v125, v207, v213
    v_fmac_f32 v126, v207, v214
    v_fmac_f32 v127, v207, v215
    ds_read_b128 v[200:203], v7 offset:9216
    ds_read_b128 v[204:207], v7 offset:9232
    v_lshlrev_b32 v208, 16, v164
    v_and_b32 v209, 0xffff0000, v164
    v_lshlrev_b32 v210, 16, v165
    v_and_b32 v211, 0xffff0000, v165
    v_lshlrev_b32 v212, 16, v166
    v_and_b32 v213, 0xffff0000, v166
    v_lshlrev_b32 v214, 16, v167
    v_and_b32 v215, 0xffff0000, v167
    s_waitcnt lgkmcnt(0)
    v_fmac_f32 v64, v200, v208
    v_fmac_f32 v65, v200, v209
    v_fmac_f32 v66, v200, v210
    v_fmac_f32 v67, v200, v211
    v_fmac_f32 v68, v200, v212
    v_fmac_f32 v69, v200, v213
    v_fmac_f32 v70, v200, v214
    v_fmac_f32 v71, v200, v215
    v_fmac_f32 v72, v201, v208
    v_fmac_f32 v73, v201, v209
    v_fmac_f32 v74, v201, v210
    v_fmac_f32 v75, v201, v211
    v_fmac_f32 v76, v201, v212
    v_fmac_f32 v77, v201, v213
    v_fmac_f32 v78, v201, v214
    v_fmac_f32 v79, v201, v215
    v_fmac_f32 v80, v202, v208
    v_fmac_f32 v81, v202, v209
    v_fmac_f32 v82, v202, v210
    v_fmac_f32 v83, v202, v211
    v_fmac_f32 v84, v202, v212
    v_fmac_f32 v85, v202, v213
    v_fmac_f32 v86, v202, v214
    v_fmac_f32 v87, v202, v215
    v_fmac_f32 v88, v203, v208
    v_fmac_f32 v89, v203, v209
    v_fmac_f32 v90, v203, v210
    v_fmac_f32 v91, v203, v211
    v_fmac_f32 v92, v203, v212
    v_fmac_f32 v93, v203, v213
    v_fmac_f32 v94, v203, v214
    v_fmac_f32 v95, v203, v215
    v_fmac_f32 v96, v204, v208
    v_fmac_f32 v97, v204, v209
    v_fmac_f32 v98, v204, v210
    v_fmac_f32 v99, v204, v211
    v_fmac_f32 v100, v204, v212
    v_fmac_f32 v101, v204, v213
    v_fmac_f32 v102, v204, v214
    v_fmac_f32 v103, v204, v215
    v_fmac_f32 v104, v205, v208
    v_fmac_f32 v105, v205, v209
    v_fmac_f32 v106, v205, v210
    v_fmac_f32 v107, v205, v211
    v_fmac_f32 v108, v205, v212
    v_fmac_f32 v109, v205, v213
    v_fmac_f32 v110, v205, v214
    v_fmac_f32 v111, v205, v215
    v_fmac_f32 v112, v206, v208
    v_fmac_f32 v113, v206, v209
    v_fmac_f32 v114, v206, v210
    v_fmac_f32 v115, v206, v211
    v_fmac_f32 v116, v206, v212
    v_fmac_f32 v117, v206, v213
    v_fmac_f32 v118, v206, v214
    v_fmac_f32 v119, v206, v215
    v_fmac_f32 v120, v207, v208
    v_fmac_f32 v121, v207, v209
    v_fmac_f32 v122, v207, v210
    v_fmac_f32 v123, v207, v211
    v_fmac_f32 v124, v207, v212
    v_fmac_f32 v125, v207, v213
    v_fmac_f32 v126, v207, v214
    v_fmac_f32 v127, v207, v215
    ds_read_b128 v[200:203], v7 offset:10240
    ds_read_b128 v[204:207], v7 offset:10256
    v_lshlrev_b32 v208, 16, v168
    v_and_b32 v209, 0xffff0000, v168
    v_lshlrev_b32 v210, 16, v169
    v_and_b32 v211, 0xffff0000, v169
    v_lshlrev_b32 v212, 16, v170
    v_and_b32 v213, 0xffff0000, v170
    v_lshlrev_b32 v214, 16, v171
    v_and_b32 v215, 0xffff0000, v171
    s_waitcnt lgkmcnt(0)
    v_fmac_f32 v64, v200, v208
    v_fmac_f32 v65, v200, v209
    v_fmac_f32 v66, v200, v210
    v_fmac_f32 v67, v200, v211
    v_fmac_f32 v68, v200, v212
    v_fmac_f32 v69, v200, v213
    v_fmac_f32 v70, v200, v214
    v_fmac_f32 v71, v200, v215
    v_fmac_f32 v72, v201, v208
    v_fmac_f32 v73, v201, v209
    v_fmac_f32 v74, v201, v210
    v_fmac_f32 v75, v201, v211
    v_fmac_f32 v76, v201, v212
    v_fmac_f32 v77, v201, v213
    v_fmac_f32 v78, v201, v214
    v_fmac_f32 v79, v201, v215
    v_fmac_f32 v80, v202, v208
    v_fmac_f32 v81, v202, v209
    v_fmac_f32 v82, v202, v210
    v_fmac_f32 v83, v202, v211
    v_fmac_f32 v84, v202, v212
    v_fmac_f32 v85, v202, v213
    v_fmac_f32 v86, v202, v214
    v_fmac_f32 v87, v202, v215
    v_fmac_f32 v88, v203, v208
    v_fmac_f32 v89, v203, v209
    v_fmac_f32 v90, v203, v210
    v_fmac_f32 v91, v203, v211
    v_fmac_f32 v92, v203, v212
    v_fmac_f32 v93, v203, v213
    v_fmac_f32 v94, v203, v214
    v_fmac_f32 v95, v203, v215
    v_fmac_f32 v96, v204, v208
    v_fmac_f32 v97, v204, v209
    v_fmac_f32 v98, v204, v210
    v_fmac_f32 v99, v204, v211
    v_fmac_f32 v100, v204, v212
    v_fmac_f32 v101, v204, v213
    v_fmac_f32 v102, v204, v214
    v_fmac_f32 v103, v204, v215
    v_fmac_f32 v104, v205, v208
    v_fmac_f32 v105, v205, v209
    v_fmac_f32 v106, v205, v210
    v_fmac_f32 v107, v205, v211
    v_fmac_f32 v108, v205, v212
    v_fmac_f32 v109, v205, v213
    v_fmac_f32 v110, v205, v214
    v_fmac_f32 v111, v205, v215
    v_fmac_f32 v112, v206, v208
    v_fmac_f32 v113, v206, v209
    v_fmac_f32 v114, v206, v210
    v_fmac_f32 v115, v206, v211
    v_fmac_f32 v116, v206, v212
    v_fmac_f32 v117, v206, v213
    v_fmac_f32 v118, v206, v214
    v_fmac_f32 v119, v206, v215
    v_fmac_f32 v120, v207, v208
    v_fmac_f32 v121, v207, v209
    v_fmac_f32 v122, v207, v210
    v_fmac_f32 v123, v207, v211
    v_fmac_f32 v124, v207, v212
    v_fmac_f32 v125, v207, v213
    v_fmac_f32 v126, v207, v214
    v_fmac_f32 v127, v207, v215
    ds_read_b128 v[200:203], v7 offset:11264
    ds_read_b128 v[204:207], v7 offset:11280
    v_lshlrev_b32 v208, 16, v172
    v_and_b32 v209, 0xffff0000, v172
    v_lshlrev_b32 v210, 16, v173
    v_and_b32 v211, 0xffff0000, v173
    v_lshlrev_b32 v212, 16, v174
    v_and_b32 v213, 0xffff0000, v174
    v_lshlrev_b32 v214, 16, v175
    v_and_b32 v215, 0xffff0000, v175
    s_waitcnt lgkmcnt(0)
    v_fmac_f32 v64, v200, v208
    v_fmac_f32 v65, v200, v209
    v_fmac_f32 v66, v200, v210
    v_fmac_f32 v67, v200, v211
    v_fmac_f32 v68, v200, v212
    v_fmac_f32 v69, v200, v213
    v_fmac_f32 v70, v200, v214
    v_fmac_f32 v71, v200, v215
    v_fmac_f32 v72, v201, v208
    v_fmac_f32 v73, v201, v209
    v_fmac_f32 v74, v201, v210
    v_fmac_f32 v75, v201, v211
    v_fmac_f32 v76, v201, v212
    v_fmac_f32 v77, v201, v213
    v_fmac_f32 v78, v201, v214
    v_fmac_f32 v79, v201, v215
    v_fmac_f32 v80, v202, v208
    v_fmac_f32 v81, v202, v209
    v_fmac_f32 v82, v202, v210
    v_fmac_f32 v83, v202, v211
    v_fmac_f32 v84, v202, v212
    v_fmac_f32 v85, v202, v213
    v_fmac_f32 v86, v202, v214
    v_fmac_f32 v87, v202, v215
    v_fmac_f32 v88, v203, v208
    v_fmac_f32 v89, v203, v209
    v_fmac_f32 v90, v203, v210
    v_fmac_f32 v91, v203, v211
    v_fmac_f32 v92, v203, v212
    v_fmac_f32 v93, v203, v213
    v_fmac_f32 v94, v203, v214
    v_fmac_f32 v95, v203, v215
    v_fmac_f32 v96, v204, v208
    v_fmac_f32 v97, v204, v209
    v_fmac_f32 v98, v204, v210
    v_fmac_f32 v99, v204, v211
    v_fmac_f32 v100, v204, v212
    v_fmac_f32 v101, v204, v213
    v_fmac_f32 v102, v204, v214
    v_fmac_f32 v103, v204, v215
    v_fmac_f32 v104, v205, v208
    v_fmac_f32 v105, v205, v209
    v_fmac_f32 v106, v205, v210
    v_fmac_f32 v107, v205, v211
    v_fmac_f32 v108, v205, v212
    v_fmac_f32 v109, v205, v213
    v_fmac_f32 v110, v205, v214
    v_fmac_f32 v111, v205, v215
    v_fmac_f32 v112, v206, v208
    v_fmac_f32 v113, v206, v209
    v_fmac_f32 v114, v206, v210
    v_fmac_f32 v115, v206, v211
    v_fmac_f32 v116, v206, v212
    v_fmac_f32 v117, v206, v213
    v_fmac_f32 v118, v206, v214
    v_fmac_f32 v119, v206, v215
    v_fmac_f32 v120, v207, v208
    v_fmac_f32 v121, v207, v209
    v_fmac_f32 v122, v207, v210
    v_fmac_f32 v123, v207, v211
    v_fmac_f32 v124, v207, v212
    v_fmac_f32 v125, v207, v213
    v_fmac_f32 v126, v207, v214
    v_fmac_f32 v127, v207, v215
    ds_read_b128 v[200:203], v7 offset:12288
    ds_read_b128 v[204:207], v7 offset:12304
    v_lshlrev_b32 v208, 16, v176
    v_and_b32 v209, 0xffff0000, v176
    v_lshlrev_b32 v210, 16, v177
    v_and_b32 v211, 0xffff0000, v177
    v_lshlrev_b32 v212, 16, v178
    v_and_b32 v213, 0xffff0000, v178
    v_lshlrev_b32 v214, 16, v179
    v_and_b32 v215, 0xffff0000, v179
    s_waitcnt lgkmcnt(0)
    v_fmac_f32 v64, v200, v208
    v_fmac_f32 v65, v200, v209
    v_fmac_f32 v66, v200, v210
    v_fmac_f32 v67, v200, v211
    v_fmac_f32 v68, v200, v212
    v_fmac_f32 v69, v200, v213
    v_fmac_f32 v70, v200, v214
    v_fmac_f32 v71, v200, v215
    v_fmac_f32 v72, v201, v208
    v_fmac_f32 v73, v201, v209
    v_fmac_f32 v74, v201, v210
    v_fmac_f32 v75, v201, v211
    v_fmac_f32 v76, v201, v212
    v_fmac_f32 v77, v201, v213
    v_fmac_f32 v78, v201, v214
    v_fmac_f32 v79, v201, v215
    v_fmac_f32 v80, v202, v208
    v_fmac_f32 v81, v202, v209
    v_fmac_f32 v82, v202, v210
    v_fmac_f32 v83, v202, v211
    v_fmac_f32 v84, v202, v212
    v_fmac_f32 v85, v202, v213
    v_fmac_f32 v86, v202, v214
    v_fmac_f32 v87, v202, v215
    v_fmac_f32 v88, v203, v208
    v_fmac_f32 v89, v203, v209
    v_fmac_f32 v90, v203, v210
    v_fmac_f32 v91, v203, v211
    v_fmac_f32 v92, v203, v212
    v_fmac_f32 v93, v203, v213
    v_fmac_f32 v94, v203, v214
    v_fmac_f32 v95, v203, v215
    v_fmac_f32 v96, v204, v208
    v_fmac_f32 v97, v204, v209
    v_fmac_f32 v98, v204, v210
    v_fmac_f32 v99, v204, v211
    v_fmac_f32 v100, v204, v212
    v_fmac_f32 v101, v204, v213
    v_fmac_f32 v102, v204, v214
    v_fmac_f32 v103, v204, v215
    v_fmac_f32 v104, v205, v208
    v_fmac_f32 v105, v205, v209
    v_fmac_f32 v106, v205, v210
    v_fmac_f32 v107, v205, v211
    v_fmac_f32 v108, v205, v212
    v_fmac_f32 v109, v205, v213
    v_fmac_f32 v110, v205, v214
    v_fmac_f32 v111, v205, v215
    v_fmac_f32 v112, v206, v208
    v_fmac_f32 v113, v206, v209
    v_fmac_f32 v114, v206, v210
    v_fmac_f32 v115, v206, v211
    v_fmac_f32 v116, v206, v212
    v_fmac_f32 v117, v206, v213
    v_fmac_f32 v118, v206, v214
    v_fmac_f32 v119, v206, v215
    v_fmac_f32 v120, v207, v208
    v_fmac_f32 v121, v207, v209
    v_fmac_f32 v122, v207, v210
    v_fmac_f32 v123, v207, v211
    v_fmac_f32 v124, v207, v212
    v_fmac_f32 v125, v207, v213
    v_fmac_f32 v126, v207, v214
    v_fmac_f32 v127, v207, v215
    ds_read_b128 v[200:203], v7 offset:13312
    ds_read_b128 v[204:207], v7 offset:13328
    v_lshlrev_b32 v208, 16, v180
    v_and_b32 v209, 0xffff0000, v180
    v_lshlrev_b32 v210, 16, v181
    v_and_b32 v211, 0xffff0000, v181
    v_lshlrev_b32 v212, 16, v182
    v_and_b32 v213, 0xffff0000, v182
    v_lshlrev_b32 v214, 16, v183
    v_and_b32 v215, 0xffff0000, v183
    s_waitcnt lgkmcnt(0)
    v_fmac_f32 v64, v200, v208
    v_fmac_f32 v65, v200, v209
    v_fmac_f32 v66, v200, v210
    v_fmac_f32 v67, v200, v211
    v_fmac_f32 v68, v200, v212
    v_fmac_f32 v69, v200, v213
    v_fmac_f32 v70, v200, v214
    v_fmac_f32 v71, v200, v215
    v_fmac_f32 v72, v201, v208
    v_fmac_f32 v73, v201, v209
    v_fmac_f32 v74, v201, v210
    v_fmac_f32 v75, v201, v211
    v_fmac_f32 v76, v201, v212
    v_fmac_f32 v77, v201, v213
    v_fmac_f32 v78, v201, v214
    v_fmac_f32 v79, v201, v215
    v_fmac_f32 v80, v202, v208
    v_fmac_f32 v81, v202, v209
    v_fmac_f32 v82, v202, v210
    v_fmac_f32 v83, v202, v211
    v_fmac_f32 v84, v202, v212
    v_fmac_f32 v85, v202, v213
    v_fmac_f32 v86, v202, v214
    v_fmac_f32 v87, v202, v215
    v_fmac_f32 v88, v203, v208
    v_fmac_f32 v89, v203, v209
    v_fmac_f32 v90, v203, v210
    v_fmac_f32 v91, v203, v211
    v_fmac_f32 v92, v203, v212
    v_fmac_f32 v93, v203, v213
    v_fmac_f32 v94, v203, v214
    v_fmac_f32 v95, v203, v215
    v_fmac_f32 v96, v204, v208
    v_fmac_f32 v97, v204, v209
    v_fmac_f32 v98, v204, v210
    v_fmac_f32 v99, v204, v211
    v_fmac_f32 v100, v204, v212
    v_fmac_f32 v101, v204, v213
    v_fmac_f32 v102, v204, v214
    v_fmac_f32 v103, v204, v215
    v_fmac_f32 v104, v205, v208
    v_fmac_f32 v105, v205, v209
    v_fmac_f32 v106, v205, v210
    v_fmac_f32 v107, v205, v211
    v_fmac_f32 v108, v205, v212
    v_fmac_f32 v109, v205, v213
    v_fmac_f32 v110, v205, v214
    v_fmac_f32 v111, v205, v215
    v_fmac_f32 v112, v206, v208
    v_fmac_f32 v113, v206, v209
    v_fmac_f32 v114, v206, v210
    v_fmac_f32 v115, v206, v211
    v_fmac_f32 v116, v206, v212
    v_fmac_f32 v117, v206, v213
    v_fmac_f32 v118, v206, v214
    v_fmac_f32 v119, v206, v215
    v_fmac_f32 v120, v207, v208
    v_fmac_f32 v121, v207, v209
    v_fmac_f32 v122, v207, v210
    v_fmac_f32 v123, v207, v211
    v_fmac_f32 v124, v207, v212
    v_fmac_f32 v125, v207, v213
    v_fmac_f32 v126, v207, v214
    v_fmac_f32 v127, v207, v215
    ds_read_b128 v[200:203], v7 offset:14336
    ds_read_b128 v[204:207], v7 offset:14352
    v_lshlrev_b32 v208, 16, v184
    v_and_b32 v209, 0xffff0000, v184
    v_lshlrev_b32 v210, 16, v185
    v_and_b32 v211, 0xffff0000, v185
    v_lshlrev_b32 v212, 16, v186
    v_and_b32 v213, 0xffff0000, v186
    v_lshlrev_b32 v214, 16, v187
    v_and_b32 v215, 0xffff0000, v187
    s_waitcnt lgkmcnt(0)
    v_fmac_f32 v64, v200, v208
    v_fmac_f32 v65, v200, v209
    v_fmac_f32 v66, v200, v210
    v_fmac_f32 v67, v200, v211
    v_fmac_f32 v68, v200, v212
    v_fmac_f32 v69, v200, v213
    v_fmac_f32 v70, v200, v214
    v_fmac_f32 v71, v200, v215
    v_fmac_f32 v72, v201, v208
    v_fmac_f32 v73, v201, v209
    v_fmac_f32 v74, v201, v210
    v_fmac_f32 v75, v201, v211
    v_fmac_f32 v76, v201, v212
    v_fmac_f32 v77, v201, v213
    v_fmac_f32 v78, v201, v214
    v_fmac_f32 v79, v201, v215
    v_fmac_f32 v80, v202, v208
    v_fmac_f32 v81, v202, v209
    v_fmac_f32 v82, v202, v210
    v_fmac_f32 v83, v202, v211
    v_fmac_f32 v84, v202, v212
    v_fmac_f32 v85, v202, v213
    v_fmac_f32 v86, v202, v214
    v_fmac_f32 v87, v202, v215
    v_fmac_f32 v88, v203, v208
    v_fmac_f32 v89, v203, v209
    v_fmac_f32 v90, v203, v210
    v_fmac_f32 v91, v203, v211
    v_fmac_f32 v92, v203, v212
    v_fmac_f32 v93, v203, v213
    v_fmac_f32 v94, v203, v214
    v_fmac_f32 v95, v203, v215
    v_fmac_f32 v96, v204, v208
    v_fmac_f32 v97, v204, v209
    v_fmac_f32 v98, v204, v210
    v_fmac_f32 v99, v204, v211
    v_fmac_f32 v100, v204, v212
    v_fmac_f32 v101, v204, v213
    v_fmac_f32 v102, v204, v214
    v_fmac_f32 v103, v204, v215
    v_fmac_f32 v104, v205, v208
    v_fmac_f32 v105, v205, v209
    v_fmac_f32 v106, v205, v210
    v_fmac_f32 v107, v205, v211
    v_fmac_f32 v108, v205, v212
    v_fmac_f32 v109, v205, v213
    v_fmac_f32 v110, v205, v214
    v_fmac_f32 v111, v205, v215
    v_fmac_f32 v112, v206, v208
    v_fmac_f32 v113, v206, v209
    v_fmac_f32 v114, v206, v210
    v_fmac_f32 v115, v206, v211
    v_fmac_f32 v116, v206, v212
    v_fmac_f32 v117, v206, v213
    v_fmac_f32 v118, v206, v214
    v_fmac_f32 v119, v206, v215
    v_fmac_f32 v120, v207, v208
    v_fmac_f32 v121, v207, v209
    v_fmac_f32 v122, v207, v210
    v_fmac_f32 v123, v207, v211
    v_fmac_f32 v124, v207, v212
    v_fmac_f32 v125, v207, v213
    v_fmac_f32 v126, v207, v214
    v_fmac_f32 v127, v207, v215
    ds_read_b128 v[200:203], v7 offset:15360
    ds_read_b128 v[204:207], v7 offset:15376
    v_lshlrev_b32 v208, 16, v188
    v_and_b32 v209, 0xffff0000, v188
    v_lshlrev_b32 v210, 16, v189
    v_and_b32 v211, 0xffff0000, v189
    v_lshlrev_b32 v212, 16, v190
    v_and_b32 v213, 0xffff0000, v190
    v_lshlrev_b32 v214, 16, v191
    v_and_b32 v215, 0xffff0000, v191
    s_waitcnt lgkmcnt(0)
    v_fmac_f32 v64, v200, v208
    v_fmac_f32 v65, v200, v209
    v_fmac_f32 v66, v200, v210
    v_fmac_f32 v67, v200, v211
    v_fmac_f32 v68, v200, v212
    v_fmac_f32 v69, v200, v213
    v_fmac_f32 v70, v200, v214
    v_fmac_f32 v71, v200, v215
    v_fmac_f32 v72, v201, v208
    v_fmac_f32 v73, v201, v209
    v_fmac_f32 v74, v201, v210
    v_fmac_f32 v75, v201, v211
    v_fmac_f32 v76, v201, v212
    v_fmac_f32 v77, v201, v213
    v_fmac_f32 v78, v201, v214
    v_fmac_f32 v79, v201, v215
    v_fmac_f32 v80, v202, v208
    v_fmac_f32 v81, v202, v209
    v_fmac_f32 v82, v202, v210
    v_fmac_f32 v83, v202, v211
    v_fmac_f32 v84, v202, v212
    v_fmac_f32 v85, v202, v213
    v_fmac_f32 v86, v202, v214
    v_fmac_f32 v87, v202, v215
    v_fmac_f32 v88, v203, v208
    v_fmac_f32 v89, v203, v209
    v_fmac_f32 v90, v203, v210
    v_fmac_f32 v91, v203, v211
    v_fmac_f32 v92, v203, v212
    v_fmac_f32 v93, v203, v213
    v_fmac_f32 v94, v203, v214
    v_fmac_f32 v95, v203, v215
    v_fmac_f32 v96, v204, v208
    v_fmac_f32 v97, v204, v209
    v_fmac_f32 v98, v204, v210
    v_fmac_f32 v99, v204, v211
    v_fmac_f32 v100, v204, v212
    v_fmac_f32 v101, v204, v213
    v_fmac_f32 v102, v204, v214
    v_fmac_f32 v103, v204, v215
    v_fmac_f32 v104, v205, v208
    v_fmac_f32 v105, v205, v209
    v_fmac_f32 v106, v205, v210
    v_fmac_f32 v107, v205, v211
    v_fmac_f32 v108, v205, v212
    v_fmac_f32 v109, v205, v213
    v_fmac_f32 v110, v205, v214
    v_fmac_f32 v111, v205, v215
    v_fmac_f32 v112, v206, v208
    v_fmac_f32 v113, v206, v209
    v_fmac_f32 v114, v206, v210
    v_fmac_f32 v115, v206, v211
    v_fmac_f32 v116, v206, v212
    v_fmac_f32 v117, v206, v213
    v_fmac_f32 v118, v206, v214
    v_fmac_f32 v119, v206, v215
    v_fmac_f32 v120, v207, v208
    v_fmac_f32 v121, v207, v209
    v_fmac_f32 v122, v207, v210
    v_fmac_f32 v123, v207, v211
    v_fmac_f32 v124, v207, v212
    v_fmac_f32 v125, v207, v213
    v_fmac_f32 v126, v207, v214
    v_fmac_f32 v127, v207, v215
    ds_read_b128 v[200:203], v7 offset:16384
    ds_read_b128 v[204:207], v7 offset:16400
    v_lshlrev_b32 v208, 16, v192
    v_and_b32 v209, 0xffff0000, v192
    v_lshlrev_b32 v210, 16, v193
    v_and_b32 v211, 0xffff0000, v193
    v_lshlrev_b32 v212, 16, v194
    v_and_b32 v213, 0xffff0000, v194
    v_lshlrev_b32 v214, 16, v195
    v_and_b32 v215, 0xffff0000, v195
    s_waitcnt lgkmcnt(0)
    v_fmac_f32 v64, v200, v208
    v_fmac_f32 v65, v200, v209
    v_fmac_f32 v66, v200, v210
    v_fmac_f32 v67, v200, v211
    v_fmac_f32 v68, v200, v212
    v_fmac_f32 v69, v200, v213
    v_fmac_f32 v70, v200, v214
    v_fmac_f32 v71, v200, v215
    v_fmac_f32 v72, v201, v208
    v_fmac_f32 v73, v201, v209
    v_fmac_f32 v74, v201, v210
    v_fmac_f32 v75, v201, v211
    v_fmac_f32 v76, v201, v212
    v_fmac_f32 v77, v201, v213
    v_fmac_f32 v78, v201, v214
    v_fmac_f32 v79, v201, v215
    v_fmac_f32 v80, v202, v208
    v_fmac_f32 v81, v202, v209
    v_fmac_f32 v82, v202, v210
    v_fmac_f32 v83, v202, v211
    v_fmac_f32 v84, v202, v212
    v_fmac_f32 v85, v202, v213
    v_fmac_f32 v86, v202, v214
    v_fmac_f32 v87, v202, v215
    v_fmac_f32 v88, v203, v208
    v_fmac_f32 v89, v203, v209
    v_fmac_f32 v90, v203, v210
    v_fmac_f32 v91, v203, v211
    v_fmac_f32 v92, v203, v212
    v_fmac_f32 v93, v203, v213
    v_fmac_f32 v94, v203, v214
    v_fmac_f32 v95, v203, v215
    v_fmac_f32 v96, v204, v208
    v_fmac_f32 v97, v204, v209
    v_fmac_f32 v98, v204, v210
    v_fmac_f32 v99, v204, v211
    v_fmac_f32 v100, v204, v212
    v_fmac_f32 v101, v204, v213
    v_fmac_f32 v102, v204, v214
    v_fmac_f32 v103, v204, v215
    v_fmac_f32 v104, v205, v208
    v_fmac_f32 v105, v205, v209
    v_fmac_f32 v106, v205, v210
    v_fmac_f32 v107, v205, v211
    v_fmac_f32 v108, v205, v212
    v_fmac_f32 v109, v205, v213
    v_fmac_f32 v110, v205, v214
    v_fmac_f32 v111, v205, v215
    v_fmac_f32 v112, v206, v208
    v_fmac_f32 v113, v206, v209
    v_fmac_f32 v114, v206, v210
    v_fmac_f32 v115, v206, v211
    v_fmac_f32 v116, v206, v212
    v_fmac_f32 v117, v206, v213
    v_fmac_f32 v118, v206, v214
    v_fmac_f32 v119, v206, v215
    v_fmac_f32 v120, v207, v208
    v_fmac_f32 v121, v207, v209
    v_fmac_f32 v122, v207, v210
    v_fmac_f32 v123, v207, v211
    v_fmac_f32 v124, v207, v212
    v_fmac_f32 v125, v207, v213
    v_fmac_f32 v126, v207, v214
    v_fmac_f32 v127, v207, v215
    ds_read_b128 v[200:203], v7 offset:17408
    ds_read_b128 v[204:207], v7 offset:17424
    v_lshlrev_b32 v208, 16, v196
    v_and_b32 v209, 0xffff0000, v196
    v_lshlrev_b32 v210, 16, v197
    v_and_b32 v211, 0xffff0000, v197
    v_lshlrev_b32 v212, 16, v198
    v_and_b32 v213, 0xffff0000, v198
    v_lshlrev_b32 v214, 16, v199
    v_and_b32 v215, 0xffff0000, v199
    s_waitcnt lgkmcnt(0)
    v_fmac_f32 v64, v200, v208
    v_fmac_f32 v65, v200, v209
    v_fmac_f32 v66, v200, v210
    v_fmac_f32 v67, v200, v211
    v_fmac_f32 v68, v200, v212
    v_fmac_f32 v69, v200, v213
    v_fmac_f32 v70, v200, v214
    v_fmac_f32 v71, v200, v215
    v_fmac_f32 v72, v201, v208
    v_fmac_f32 v73, v201, v209
    v_fmac_f32 v74, v201, v210
    v_fmac_f32 v75, v201, v211
    v_fmac_f32 v76, v201, v212
    v_fmac_f32 v77, v201, v213
    v_fmac_f32 v78, v201, v214
    v_fmac_f32 v79, v201, v215
    v_fmac_f32 v80, v202, v208
    v_fmac_f32 v81, v202, v209
    v_fmac_f32 v82, v202, v210
    v_fmac_f32 v83, v202, v211
    v_fmac_f32 v84, v202, v212
    v_fmac_f32 v85, v202, v213
    v_fmac_f32 v86, v202, v214
    v_fmac_f32 v87, v202, v215
    v_fmac_f32 v88, v203, v208
    v_fmac_f32 v89, v203, v209
    v_fmac_f32 v90, v203, v210
    v_fmac_f32 v91, v203, v211
    v_fmac_f32 v92, v203, v212
    v_fmac_f32 v93, v203, v213
    v_fmac_f32 v94, v203, v214
    v_fmac_f32 v95, v203, v215
    v_fmac_f32 v96, v204, v208
    v_fmac_f32 v97, v204, v209
    v_fmac_f32 v98, v204, v210
    v_fmac_f32 v99, v204, v211
    v_fmac_f32 v100, v204, v212
    v_fmac_f32 v101, v204, v213
    v_fmac_f32 v102, v204, v214
    v_fmac_f32 v103, v204, v215
    v_fmac_f32 v104, v205, v208
    v_fmac_f32 v105, v205, v209
    v_fmac_f32 v106, v205, v210
    v_fmac_f32 v107, v205, v211
    v_fmac_f32 v108, v205, v212
    v_fmac_f32 v109, v205, v213
    v_fmac_f32 v110, v205, v214
    v_fmac_f32 v111, v205, v215
    v_fmac_f32 v112, v206, v208
    v_fmac_f32 v113, v206, v209
    v_fmac_f32 v114, v206, v210
    v_fmac_f32 v115, v206, v211
    v_fmac_f32 v116, v206, v212
    v_fmac_f32 v117, v206, v213
    v_fmac_f32 v118, v206, v214
    v_fmac_f32 v119, v206, v215
    v_fmac_f32 v120, v207, v208
    v_fmac_f32 v121, v207, v209
    v_fmac_f32 v122, v207, v210
    v_fmac_f32 v123, v207, v211
    v_fmac_f32 v124, v207, v212
    v_fmac_f32 v125, v207, v213
    v_fmac_f32 v126, v207, v214
    v_fmac_f32 v127, v207, v215
    v_lshlrev_b32 v8, 11, v5
    v_lshl_add_u32 v8, v4, 5, v8
    v_add_u32 v8, 18432, v8
    ds_write_b128 v8, v[64:67] offset:0
    ds_write_b128 v8, v[68:71] offset:16
    ds_write_b128 v8, v[72:75] offset:256
    ds_write_b128 v8, v[76:79] offset:272
    ds_write_b128 v8, v[80:83] offset:512
    ds_write_b128 v8, v[84:87] offset:528
    ds_write_b128 v8, v[88:91] offset:768
    ds_write_b128 v8, v[92:95] offset:784
    ds_write_b128 v8, v[96:99] offset:1024
    ds_write_b128 v8, v[100:103] offset:1040
    ds_write_b128 v8, v[104:107] offset:1280
    ds_write_b128 v8, v[108:111] offset:1296
    ds_write_b128 v8, v[112:115] offset:1536
    ds_write_b128 v8, v[116:119] offset:1552
    ds_write_b128 v8, v[120:123] offset:1792
    ds_write_b128 v8, v[124:127] offset:1808
    s_waitcnt lgkmcnt(0)
    s_barrier
    v_lshrrev_b32 v9, 5, v0
    v_and_b32 v10, 31, v0
    v_lshlrev_b32 v11, 8, v9
    v_lshl_add_u32 v11, v10, 3, v11
    v_add_u32 v11, 18432, v11
    ds_read_b64 v[64:65], v11 offset:0
    ds_read_b64 v[66:67], v11 offset:2048
    ds_read_b64 v[68:69], v11 offset:4096
    ds_read_b64 v[70:71], v11 offset:6144
    ds_read_b64 v[72:73], v11 offset:8192
    ds_read_b64 v[74:75], v11 offset:10240
    ds_read_b64 v[76:77], v11 offset:12288
    ds_read_b64 v[78:79], v11 offset:14336
    ds_read_b64 v[80:81], v11 offset:16384
    ds_read_b64 v[82:83], v11 offset:18432
    ds_read_b64 v[84:85], v11 offset:20480
    ds_read_b64 v[86:87], v11 offset:22528
    ds_read_b64 v[88:89], v11 offset:24576
    ds_read_b64 v[90:91], v11 offset:26624
    ds_read_b64 v[92:93], v11 offset:28672
    ds_read_b64 v[94:95], v11 offset:30720
    ds_read_b64 v[96:97], v11 offset:32768
    ds_read_b64 v[98:99], v11 offset:34816
    ds_read_b64 v[100:101], v11 offset:36864
    ds_read_b64 v[102:103], v11 offset:38912
    ds_read_b64 v[104:105], v11 offset:40960
    ds_read_b64 v[106:107], v11 offset:43008
    ds_read_b64 v[108:109], v11 offset:45056
    ds_read_b64 v[110:111], v11 offset:47104
    ds_read_b64 v[112:113], v11 offset:49152
    ds_read_b64 v[114:115], v11 offset:51200
    ds_read_b64 v[116:117], v11 offset:53248
    ds_read_b64 v[118:119], v11 offset:55296
    ds_read_b64 v[120:121], v11 offset:57344
    ds_read_b64 v[122:123], v11 offset:59392
    ds_read_b64 v[124:125], v11 offset:61440
    ds_read_b64 v[126:127], v11 offset:63488
    s_waitcnt lgkmcnt(0)
    v_add_f32 v64, v64, v66
    v_add_f32 v65, v65, v67
    v_add_f32 v64, v64, v68
    v_add_f32 v65, v65, v69
    v_add_f32 v64, v64, v70
    v_add_f32 v65, v65, v71
    v_add_f32 v64, v64, v72
    v_add_f32 v65, v65, v73
    v_add_f32 v64, v64, v74
    v_add_f32 v65, v65, v75
    v_add_f32 v64, v64, v76
    v_add_f32 v65, v65, v77
    v_add_f32 v64, v64, v78
    v_add_f32 v65, v65, v79
    v_add_f32 v64, v64, v80
    v_add_f32 v65, v65, v81
    v_add_f32 v64, v64, v82
    v_add_f32 v65, v65, v83
    v_add_f32 v64, v64, v84
    v_add_f32 v65, v65, v85
    v_add_f32 v64, v64, v86
    v_add_f32 v65, v65, v87
    v_add_f32 v64, v64, v88
    v_add_f32 v65, v65, v89
    v_add_f32 v64, v64, v90
    v_add_f32 v65, v65, v91
    v_add_f32 v64, v64, v92
    v_add_f32 v65, v65, v93
    v_add_f32 v64, v64, v94
    v_add_f32 v65, v65, v95
    v_add_f32 v64, v64, v96
    v_add_f32 v65, v65, v97
    v_add_f32 v64, v64, v98
    v_add_f32 v65, v65, v99
    v_add_f32 v64, v64, v100
    v_add_f32 v65, v65, v101
    v_add_f32 v64, v64, v102
    v_add_f32 v65, v65, v103
    v_add_f32 v64, v64, v104
    v_add_f32 v65, v65, v105
    v_add_f32 v64, v64, v106
    v_add_f32 v65, v65, v107
    v_add_f32 v64, v64, v108
    v_add_f32 v65, v65, v109
    v_add_f32 v64, v64, v110
    v_add_f32 v65, v65, v111
    v_add_f32 v64, v64, v112
    v_add_f32 v65, v65, v113
    v_add_f32 v64, v64, v114
    v_add_f32 v65, v65, v115
    v_add_f32 v64, v64, v116
    v_add_f32 v65, v65, v117
    v_add_f32 v64, v64, v118
    v_add_f32 v65, v65, v119
    v_add_f32 v64, v64, v120
    v_add_f32 v65, v65, v121
    v_add_f32 v64, v64, v122
    v_add_f32 v65, v65, v123
    v_add_f32 v64, v64, v124
    v_add_f32 v65, v65, v125
    v_add_f32 v64, v64, v126
    v_add_f32 v65, v65, v127
    s_mul_i32 s40, s45, 147456
    s_lshl_b32 s41, s30, 8
    s_add_u32 s40, s40, s41
    s_add_u32 s40, s40, 1638400
    s_mov_b32 s41, 18432
    v_mul_lo_u32 v12, v9, s41
    v_lshl_add_u32 v12, v10, 3, v12
    buffer_store_dwordx2 v[64:65], v12, s[12:15], s40 offen
    s_waitcnt vmcnt(0)
L_end_ke_kernel:
    s_endpgm
.globl kf_kernel
.p2align 8
.type kf_kernel,@function
kf_kernel:
    s_cmp_ge_u32 s2, 72
    s_cbranch_scc1 L_end_kf_kernel
    s_load_dwordx2 s[28:29], s[0:1], 64
    s_load_dwordx2 s[36:37], s[0:1], 104
    s_waitcnt lgkmcnt(0)
    s_mov_b32 s40, 477218589
    s_mul_hi_u32 s31, s2, s40
    s_mul_i32 s40, s31, 9
    s_sub_u32 s30, s2, s40
    s_mov_b32 s45, 0
    s_mov_b32 s8, s28
    s_and_b32 s9, s29, 0xffff
    s_mov_b32 s10, 0x510000
    s_mov_b32 s11, 0x20000
    s_mov_b32 s12, s36
    s_and_b32 s13, s37, 0xffff
    s_mov_b32 s14, 0x40000000
    s_mov_b32 s15, 0x20000
    v_and_b32 v1, 63, v0
    v_lshrrev_b32 v2, 6, v0
    v_lshrrev_b32 v3, 3, v1
    v_and_b32 v4, 7, v1
    v_lshl_add_u32 v5, v2, 3, v3
    s_mov_b32 s33, 1152
    v_mul_lo_u32 v6, v5, s33
    v_lshl_add_u32 v6, v4, 4, v6
    v_lshlrev_b32 v7, 5, v5
    s_lshl_b32 s32, s30, 7
    s_mul_i32 s34, s31, 663552
    s_add_u32 s32, s32, s34
    buffer_load_dwordx4 v[128:131], v6, s[8:11], s32 offen
    s_add_u32 s32, s32, 36864
    buffer_load_dwordx4 v[132:135], v6, s[8:11], s32 offen
    s_add_u32 s32, s32, 36864
    buffer_load_dwordx4 v[136:139], v6, s[8:11], s32 offen
    s_add_u32 s32, s32, 36864
    buffer_load_dwordx4 v[140:143], v6, s[8:11], s32 offen
    s_add_u32 s32, s32, 36864
    buffer_load_dwordx4 v[144:147], v6, s[8:11], s32 offen
    s_add_u32 s32, s32, 36864
    buffer_load_dwordx4 v[148:151], v6, s[8:11], s32 offen
    s_add_u32 s32, s32, 36864
    buffer_load_dwordx4 v[152:155], v6, s[8:11], s32 offen
    s_add_u32 s32, s32, 36864
    buffer_load_dwordx4 v[156:159], v6, s[8:11], s32 offen
    s_add_u32 s32, s32, 36864
    buffer_load_dwordx4 v[160:163], v6, s[8:11], s32 offen
    s_add_u32 s32, s32, 36864
    buffer_load_dwordx4 v[164:167], v6, s[8:11], s32 offen
    s_add_u32 s32, s32, 36864
    buffer_load_dwordx4 v[168:171], v6, s[8:11], s32 offen
    s_add_u32 s32, s32, 36864
    buffer_load_dwordx4 v[172:175], v6, s[8:11], s32 offen
    s_add_u32 s32, s32, 36864
    buffer_load_dwordx4 v[176:179], v6, s[8:11], s32 offen
    s_add_u32 s32, s32, 36864
    buffer_load_dwordx4 v[180:183], v6, s[8:11], s32 offen
    s_add_u32 s32, s32, 36864
    buffer_load_dwordx4 v[184:187], v6, s[8:11], s32 offen
    s_add_u32 s32, s32, 36864
    buffer_load_dwordx4 v[188:191], v6, s[8:11], s32 offen
    s_add_u32 s32, s32, 36864
    buffer_load_dwordx4 v[192:195], v6, s[8:11], s32 offen
    s_add_u32 s32, s32, 36864
    buffer_load_dwordx4 v[196:199], v6, s[8:11], s32 offen
    s_mul_i32 s40, s31, 2304
    s_add_u32 s40, s40, 1638400
    v_lshlrev_b32 v216, 2, v0
    v_add_u32 v216, s40, v216
    v_add_u32 v217, 147456, v216
    s_mov_b32 s48, 0
    s_mov_b32 s49, 18432
    s_mov_b32 s50, 36864
    s_mov_b32 s51, 55296
    s_mov_b32 s52, 73728
    s_mov_b32 s53, 92160
    s_mov_b32 s54, 110592
    s_mov_b32 s55, 129024
    buffer_load_dword v8, v216, s[12:15], s48 offen offset:0
    buffer_load_dword v32, v217, s[12:15], s48 offen offset:0
    buffer_load_dword v9, v216, s[12:15], s48 offen offset:1024
    buffer_load_dword v33, v217, s[12:15], s48 offen offset:1024
    buffer_load_dword v10, v216, s[12:15], s48 offen offset:2048
    buffer_load_dword v34, v217, s[12:15], s48 offen offset:2048
    buffer_load_dword v11, v216, s[12:15], s49 offen offset:0
    buffer_load_dword v35, v217, s[12:15], s49 offen offset:0
    buffer_load_dword v12, v216, s[12:15], s49 offen offset:1024
    buffer_load_dword v36, v217, s[12:15], s49 offen offset:1024
    buffer_load_dword v13, v216, s[12:15], s49 offen offset:2048
    buffer_load_dword v37, v217, s[12:15], s49 offen offset:2048
    buffer_load_dword v14, v216, s[12:15], s50 offen offset:0
    buffer_load_dword v38, v217, s[12:15], s50 offen offset:0
    buffer_load_dword v15, v216, s[12:15], s50 offen offset:1024
    buffer_load_dword v39, v217, s[12:15], s50 offen offset:1024
    buffer_load_dword v16, v216, s[12:15], s50 offen offset:2048
    buffer_load_dword v40, v217, s[12:15], s50 offen offset:2048
    buffer_load_dword v17, v216, s[12:15], s51 offen offset:0
    buffer_load_dword v41, v217, s[12:15], s51 offen offset:0
    buffer_load_dword v18, v216, s[12:15], s51 offen offset:1024
    buffer_load_dword v42, v217, s[12:15], s51 offen offset:1024
    buffer_load_dword v19, v216, s[12:15], s51 offen offset:2048
    buffer_load_dword v43, v217, s[12:15], s51 offen offset:2048
    buffer_load_dword v20, v216, s[12:15], s52 offen offset:0
    buffer_load_dword v44, v217, s[12:15], s52 offen offset:0
    buffer_load_dword v21, v216, s[12:15], s52 offen offset:1024
    buffer_load_dword v45, v217, s[12:15], s52 offen offset:1024
    buffer_load_dword v22, v216, s[12:15], s52 offen offset:2048
    buffer_load_dword v46, v217, s[12:15], s52 offen offset:2048
    buffer_load_dword v23, v216, s[12:15], s53 offen offset:0
    buffer_load_dword v47, v217, s[12:15], s53 offen offset:0
    buffer_load_dword v24, v216, s[12:15], s53 offen offset:1024
    buffer_load_dword v48, v217, s[12:15], s53 offen offset:1024
    buffer_load_dword v25, v216, s[12:15], s53 offen offset:2048
    buffer_load_dword v49, v217, s[12:15], s53 offen offset:2048
    buffer_load_dword v26, v216, s[12:15], s54 offen offset:0
    buffer_load_dword v50, v217, s[12:15], s54 offen offset:0
    buffer_load_dword v27, v216, s[12:15], s54 offen offset:1024
    buffer_load_dword v51, v217, s[12:15], s54 offen offset:1024
    buffer_load_dword v28, v216, s[12:15], s54 offen offset:2048
    buffer_load_dword v52, v217, s[12:15], s54 offen offset:2048
    buffer_load_dword v29, v216, s[12:15], s55 offen offset:0
    buffer_load_dword v53, v217, s[12:15], s55 offen offset:0
    buffer_load_dword v30, v216, s[12:15], s55 offen offset:1024
    buffer_load_dword v54, v217, s[12:15], s55 offen offset:1024
    buffer_load_dword v31, v216, s[12:15], s55 offen offset:2048
    buffer_load_dword v55, v217, s[12:15], s55 offen offset:2048
    s_mov_b32 s40, 0x3d372713
    s_mov_b32 s41, 0xc0135761
    v_lshlrev_b32 v218, 5, v0
    s_waitcnt vmcnt(0)
    v_mul_f32 v219, v8, v8
    v_mul_f32 v219, s40, v219
    v_fma_f32 v219, v219, v8, v8
    v_mul_f32 v219, s41, v219
    v_exp_f32 v219, v219
    s_nop 0
    v_add_f32 v219, 1.0, v219
    v_rcp_f32 v219, v219
    s_nop 0
    v_mul_f32 v8, v8, v219
    v_mul_f32 v8, v8, v32
    v_mul_f32 v219, v9, v9
    v_mul_f32 v219, s40, v219
    v_fma_f32 v219, v219, v9, v9
    v_mul_f32 v219, s41, v219
    v_exp_f32 v219, v219
    s_nop 0
    v_add_f32 v219, 1.0, v219
    v_rcp_f32 v219, v219
    s_nop 0
    v_mul_f32 v9, v9, v219
    v_mul_f32 v9, v9, v33
    v_mul_f32 v219, v10, v10
    v_mul_f32 v219, s40, v219
    v_fma_f32 v219, v219, v10, v10
    v_mul_f32 v219, s41, v219
    v_exp_f32 v219, v219
    s_nop 0
    v_add_f32 v219, 1.0, v219
    v_rcp_f32 v219, v219
    s_nop 0
    v_mul_f32 v10, v10, v219
    v_mul_f32 v10, v10, v34
    v_mul_f32 v219, v11, v11
    v_mul_f32 v219, s40, v219
    v_fma_f32 v219, v219, v11, v11
    v_mul_f32 v219, s41, v219
    v_exp_f32 v219, v219
    s_nop 0
    v_add_f32 v219, 1.0, v219
    v_rcp_f32 v219, v219
    s_nop 0
    v_mul_f32 v11, v11, v219
    v_mul_f32 v11, v11, v35
    v_mul_f32 v219, v12, v12
    v_mul_f32 v219, s40, v219
    v_fma_f32 v219, v219, v12, v12
    v_mul_f32 v219, s41, v219
    v_exp_f32 v219, v219
    s_nop 0
    v_add_f32 v219, 1.0, v219
    v_rcp_f32 v219, v219
    s_nop 0
    v_mul_f32 v12, v12, v219
    v_mul_f32 v12, v12, v36
    v_mul_f32 v219, v13, v13
    v_mul_f32 v219, s40, v219
    v_fma_f32 v219, v219, v13, v13
    v_mul_f32 v219, s41, v219
    v_exp_f32 v219, v219
    s_nop 0
    v_add_f32 v219, 1.0, v219
    v_rcp_f32 v219, v219
    s_nop 0
    v_mul_f32 v13, v13, v219
    v_mul_f32 v13, v13, v37
    v_mul_f32 v219, v14, v14
    v_mul_f32 v219, s40, v219
    v_fma_f32 v219, v219, v14, v14
    v_mul_f32 v219, s41, v219
    v_exp_f32 v219, v219
    s_nop 0
    v_add_f32 v219, 1.0, v219
    v_rcp_f32 v219, v219
    s_nop 0
    v_mul_f32 v14, v14, v219
    v_mul_f32 v14, v14, v38
    v_mul_f32 v219, v15, v15
    v_mul_f32 v219, s40, v219
    v_fma_f32 v219, v219, v15, v15
    v_mul_f32 v219, s41, v219
    v_exp_f32 v219, v219
    s_nop 0
    v_add_f32 v219, 1.0, v219
    v_rcp_f32 v219, v219
    s_nop 0
    v_mul_f32 v15, v15, v219
    v_mul_f32 v15, v15, v39
    v_mul_f32 v219, v16, v16
    v_mul_f32 v219, s40, v219
    v_fma_f32 v219, v219, v16, v16
    v_mul_f32 v219, s41, v219
    v_exp_f32 v219, v219
    s_nop 0
    v_add_f32 v219, 1.0, v219
    v_rcp_f32 v219, v219
    s_nop 0
    v_mul_f32 v16, v16, v219
    v_mul_f32 v16, v16, v40
    v_mul_f32 v219, v17, v17
    v_mul_f32 v219, s40, v219
    v_fma_f32 v219, v219, v17, v17
    v_mul_f32 v219, s41, v219
    v_exp_f32 v219, v219
    s_nop 0
    v_add_f32 v219, 1.0, v219
    v_rcp_f32 v219, v219
    s_nop 0
    v_mul_f32 v17, v17, v219
    v_mul_f32 v17, v17, v41
    v_mul_f32 v219, v18, v18
    v_mul_f32 v219, s40, v219
    v_fma_f32 v219, v219, v18, v18
    v_mul_f32 v219, s41, v219
    v_exp_f32 v219, v219
    s_nop 0
    v_add_f32 v219, 1.0, v219
    v_rcp_f32 v219, v219
    s_nop 0
    v_mul_f32 v18, v18, v219
    v_mul_f32 v18, v18, v42
    v_mul_f32 v219, v19, v19
    v_mul_f32 v219, s40, v219
    v_fma_f32 v219, v219, v19, v19
    v_mul_f32 v219, s41, v219
    v_exp_f32 v219, v219
    s_nop 0
    v_add_f32 v219, 1.0, v219
    v_rcp_f32 v219, v219
    s_nop 0
    v_mul_f32 v19, v19, v219
    v_mul_f32 v19, v19, v43
    v_mul_f32 v219, v20, v20
    v_mul_f32 v219, s40, v219
    v_fma_f32 v219, v219, v20, v20
    v_mul_f32 v219, s41, v219
    v_exp_f32 v219, v219
    s_nop 0
    v_add_f32 v219, 1.0, v219
    v_rcp_f32 v219, v219
    s_nop 0
    v_mul_f32 v20, v20, v219
    v_mul_f32 v20, v20, v44
    v_mul_f32 v219, v21, v21
    v_mul_f32 v219, s40, v219
    v_fma_f32 v219, v219, v21, v21
    v_mul_f32 v219, s41, v219
    v_exp_f32 v219, v219
    s_nop 0
    v_add_f32 v219, 1.0, v219
    v_rcp_f32 v219, v219
    s_nop 0
    v_mul_f32 v21, v21, v219
    v_mul_f32 v21, v21, v45
    v_mul_f32 v219, v22, v22
    v_mul_f32 v219, s40, v219
    v_fma_f32 v219, v219, v22, v22
    v_mul_f32 v219, s41, v219
    v_exp_f32 v219, v219
    s_nop 0
    v_add_f32 v219, 1.0, v219
    v_rcp_f32 v219, v219
    s_nop 0
    v_mul_f32 v22, v22, v219
    v_mul_f32 v22, v22, v46
    v_mul_f32 v219, v23, v23
    v_mul_f32 v219, s40, v219
    v_fma_f32 v219, v219, v23, v23
    v_mul_f32 v219, s41, v219
    v_exp_f32 v219, v219
    s_nop 0
    v_add_f32 v219, 1.0, v219
    v_rcp_f32 v219, v219
    s_nop 0
    v_mul_f32 v23, v23, v219
    v_mul_f32 v23, v23, v47
    v_mul_f32 v219, v24, v24
    v_mul_f32 v219, s40, v219
    v_fma_f32 v219, v219, v24, v24
    v_mul_f32 v219, s41, v219
    v_exp_f32 v219, v219
    s_nop 0
    v_add_f32 v219, 1.0, v219
    v_rcp_f32 v219, v219
    s_nop 0
    v_mul_f32 v24, v24, v219
    v_mul_f32 v24, v24, v48
    v_mul_f32 v219, v25, v25
    v_mul_f32 v219, s40, v219
    v_fma_f32 v219, v219, v25, v25
    v_mul_f32 v219, s41, v219
    v_exp_f32 v219, v219
    s_nop 0
    v_add_f32 v219, 1.0, v219
    v_rcp_f32 v219, v219
    s_nop 0
    v_mul_f32 v25, v25, v219
    v_mul_f32 v25, v25, v49
    v_mul_f32 v219, v26, v26
    v_mul_f32 v219, s40, v219
    v_fma_f32 v219, v219, v26, v26
    v_mul_f32 v219, s41, v219
    v_exp_f32 v219, v219
    s_nop 0
    v_add_f32 v219, 1.0, v219
    v_rcp_f32 v219, v219
    s_nop 0
    v_mul_f32 v26, v26, v219
    v_mul_f32 v26, v26, v50
    v_mul_f32 v219, v27, v27
    v_mul_f32 v219, s40, v219
    v_fma_f32 v219, v219, v27, v27
    v_mul_f32 v219, s41, v219
    v_exp_f32 v219, v219
    s_nop 0
    v_add_f32 v219, 1.0, v219
    v_rcp_f32 v219, v219
    s_nop 0
    v_mul_f32 v27, v27, v219
    v_mul_f32 v27, v27, v51
    v_mul_f32 v219, v28, v28
    v_mul_f32 v219, s40, v219
    v_fma_f32 v219, v219, v28, v28
    v_mul_f32 v219, s41, v219
    v_exp_f32 v219, v219
    s_nop 0
    v_add_f32 v219, 1.0, v219
    v_rcp_f32 v219, v219
    s_nop 0
    v_mul_f32 v28, v28, v219
    v_mul_f32 v28, v28, v52
    v_mul_f32 v219, v29, v29
    v_mul_f32 v219, s40, v219
    v_fma_f32 v219, v219, v29, v29
    v_mul_f32 v219, s41, v219
    v_exp_f32 v219, v219
    s_nop 0
    v_add_f32 v219, 1.0, v219
    v_rcp_f32 v219, v219
    s_nop 0
    v_mul_f32 v29, v29, v219
    v_mul_f32 v29, v29, v53
    v_mul_f32 v219, v30, v30
    v_mul_f32 v219, s40, v219
    v_fma_f32 v219, v219, v30, v30
    v_mul_f32 v219, s41, v219
    v_exp_f32 v219, v219
    s_nop 0
    v_add_f32 v219, 1.0, v219
    v_rcp_f32 v219, v219
    s_nop 0
    v_mul_f32 v30, v30, v219
    v_mul_f32 v30, v30, v54
    v_mul_f32 v219, v31, v31
    v_mul_f32 v219, s40, v219
    v_fma_f32 v219, v219, v31, v31
    v_mul_f32 v219, s41, v219
    v_exp_f32 v219, v219
    s_nop 0
    v_add_f32 v219, 1.0, v219
    v_rcp_f32 v219, v219
    s_nop 0
    v_mul_f32 v31, v31, v219
    v_mul_f32 v31, v31, v55
    ds_write_b32 v218, v8 offset:0
    ds_write_b32 v218, v9 offset:8192
    ds_write_b32 v218, v11 offset:4
    ds_write_b32 v218, v12 offset:8196
    ds_write_b32 v218, v14 offset:8
    ds_write_b32 v218, v15 offset:8200
    ds_write_b32 v218, v17 offset:12
    ds_write_b32 v218, v18 offset:8204
    ds_write_b32 v218, v20 offset:16
    ds_write_b32 v218, v21 offset:8208
    ds_write_b32 v218, v23 offset:20
    ds_write_b32 v218, v24 offset:8212
    ds_write_b32 v218, v26 offset:24
    ds_write_b32 v218, v27 offset:8216
    ds_write_b32 v218, v29 offset:28
    ds_write_b32 v218, v30 offset:8220
    v_cmp_gt_u32 vcc, 64, v0
    s_nop 1
    s_and_saveexec_b64 s[42:43], vcc
    ds_write_b32 v218, v10 offset:16384
    ds_write_b32 v218, v13 offset:16388
    ds_write_b32 v218, v16 offset:16392
    ds_write_b32 v218, v19 offset:16396
    ds_write_b32 v218, v22 offset:16400
    ds_write_b32 v218, v25 offset:16404
    ds_write_b32 v218, v28 offset:16408
    ds_write_b32 v218, v31 offset:16412
    s_mov_b64 exec, s[42:43]
    s_waitcnt vmcnt(0) lgkmcnt(0)
    s_barrier
    v_mov_b32 v64, 0
    v_mov_b32 v65, 0
    v_mov_b32 v66, 0
    v_mov_b32 v67, 0
    v_mov_b32 v68, 0
    v_mov_b32 v69, 0
    v_mov_b32 v70, 0
    v_mov_b32 v71, 0
    v_mov_b32 v72, 0
    v_mov_b32 v73, 0
    v_mov_b32 v74, 0
    v_mov_b32 v75, 0
    v_mov_b32 v76, 0
    v_mov_b32 v77, 0
    v_mov_b32 v78, 0
    v_mov_b32 v79, 0
    v_mov_b32 v80, 0
    v_mov_b32 v81, 0
    v_mov_b32 v82, 0
    v_mov_b32 v83, 0
    v_mov_b32 v84, 0
    v_mov_b32 v85, 0
    v_mov_b32 v86, 0
    v_mov_b32 v87, 0
    v_mov_b32 v88, 0
    v_mov_b32 v89, 0
    v_mov_b32 v90, 0
    v_mov_b32 v91, 0
    v_mov_b32 v92, 0
    v_mov_b32 v93, 0
    v_mov_b32 v94, 0
    v_mov_b32 v95, 0
    v_mov_b32 v96, 0
    v_mov_b32 v97, 0
    v_mov_b32 v98, 0
    v_mov_b32 v99, 0
    v_mov_b32 v100, 0
    v_mov_b32 v101, 0
    v_mov_b32 v102, 0
    v_mov_b32 v103, 0
    v_mov_b32 v104, 0
    v_mov_b32 v105, 0
    v_mov_b32 v106, 0
    v_mov_b32 v107, 0
    v_mov_b32 v108, 0
    v_mov_b32 v109, 0
    v_mov_b32 v110, 0
    v_mov_b32 v111, 0
    v_mov_b32 v112, 0
    v_mov_b32 v113, 0
    v_mov_b32 v114, 0
    v_mov_b32 v115, 0
    v_mov_b32 v116, 0
    v_mov_b32 v117, 0
    v_mov_b32 v118, 0
    v_mov_b32 v119, 0
    v_mov_b32 v120, 0
    v_mov_b32 v121, 0
    v_mov_b32 v122, 0
    v_mov_b32 v123, 0
    v_mov_b32 v124, 0
    v_mov_b32 v125, 0
    v_mov_b32 v126, 0
    v_mov_b32 v127, 0
    ds_read_b128 v[200:203], v7 offset:0
    ds_read_b128 v[204:207], v7 offset:16
    v_lshlrev_b32 v208, 16, v128
    v_and_b32 v209, 0xffff0000, v128
    v_lshlrev_b32 v210, 16, v129
    v_and_b32 v211, 0xffff0000, v129
    v_lshlrev_b32 v212, 16, v130
    v_and_b32 v213, 0xffff0000, v130
    v_lshlrev_b32 v214, 16, v131
    v_and_b32 v215, 0xffff0000, v131
    s_waitcnt lgkmcnt(0)
    v_fmac_f32 v64, v200, v208
    v_fmac_f32 v65, v200, v209
    v_fmac_f32 v66, v200, v210
    v_fmac_f32 v67, v200, v211
    v_fmac_f32 v68, v200, v212
    v_fmac_f32 v69, v200, v213
    v_fmac_f32 v70, v200, v214
    v_fmac_f32 v71, v200, v215
    v_fmac_f32 v72, v201, v208
    v_fmac_f32 v73, v201, v209
    v_fmac_f32 v74, v201, v210
    v_fmac_f32 v75, v201, v211
    v_fmac_f32 v76, v201, v212
    v_fmac_f32 v77, v201, v213
    v_fmac_f32 v78, v201, v214
    v_fmac_f32 v79, v201, v215
    v_fmac_f32 v80, v202, v208
    v_fmac_f32 v81, v202, v209
    v_fmac_f32 v82, v202, v210
    v_fmac_f32 v83, v202, v211
    v_fmac_f32 v84, v202, v212
    v_fmac_f32 v85, v202, v213
    v_fmac_f32 v86, v202, v214
    v_fmac_f32 v87, v202, v215
    v_fmac_f32 v88, v203, v208
    v_fmac_f32 v89, v203, v209
    v_fmac_f32 v90, v203, v210
    v_fmac_f32 v91, v203, v211
    v_fmac_f32 v92, v203, v212
    v_fmac_f32 v93, v203, v213
    v_fmac_f32 v94, v203, v214
    v_fmac_f32 v95, v203, v215
    v_fmac_f32 v96, v204, v208
    v_fmac_f32 v97, v204, v209
    v_fmac_f32 v98, v204, v210
    v_fmac_f32 v99, v204, v211
    v_fmac_f32 v100, v204, v212
    v_fmac_f32 v101, v204, v213
    v_fmac_f32 v102, v204, v214
    v_fmac_f32 v103, v204, v215
    v_fmac_f32 v104, v205, v208
    v_fmac_f32 v105, v205, v209
    v_fmac_f32 v106, v205, v210
    v_fmac_f32 v107, v205, v211
    v_fmac_f32 v108, v205, v212
    v_fmac_f32 v109, v205, v213
    v_fmac_f32 v110, v205, v214
    v_fmac_f32 v111, v205, v215
    v_fmac_f32 v112, v206, v208
    v_fmac_f32 v113, v206, v209
    v_fmac_f32 v114, v206, v210
    v_fmac_f32 v115, v206, v211
    v_fmac_f32 v116, v206, v212
    v_fmac_f32 v117, v206, v213
    v_fmac_f32 v118, v206, v214
    v_fmac_f32 v119, v206, v215
    v_fmac_f32 v120, v207, v208
    v_fmac_f32 v121, v207, v209
    v_fmac_f32 v122, v207, v210
    v_fmac_f32 v123, v207, v211
    v_fmac_f32 v124, v207, v212
    v_fmac_f32 v125, v207, v213
    v_fmac_f32 v126, v207, v214
    v_fmac_f32 v127, v207, v215
    ds_read_b128 v[200:203], v7 offset:1024
    ds_read_b128 v[204:207], v7 offset:1040
    v_lshlrev_b32 v208, 16, v132
    v_and_b32 v209, 0xffff0000, v132
    v_lshlrev_b32 v210, 16, v133
    v_and_b32 v211, 0xffff0000, v133
    v_lshlrev_b32 v212, 16, v134
    v_and_b32 v213, 0xffff0000, v134
    v_lshlrev_b32 v214, 16, v135
    v_and_b32 v215, 0xffff0000, v135
    s_waitcnt lgkmcnt(0)
    v_fmac_f32 v64, v200, v208
    v_fmac_f32 v65, v200, v209
    v_fmac_f32 v66, v200, v210
    v_fmac_f32 v67, v200, v211
    v_fmac_f32 v68, v200, v212
    v_fmac_f32 v69, v200, v213
    v_fmac_f32 v70, v200, v214
    v_fmac_f32 v71, v200, v215
    v_fmac_f32 v72, v201, v208
    v_fmac_f32 v73, v201, v209
    v_fmac_f32 v74, v201, v210
    v_fmac_f32 v75, v201, v211
    v_fmac_f32 v76, v201, v212
    v_fmac_f32 v77, v201, v213
    v_fmac_f32 v78, v201, v214
    v_fmac_f32 v79, v201, v215
    v_fmac_f32 v80, v202, v208
    v_fmac_f32 v81, v202, v209
    v_fmac_f32 v82, v202, v210
    v_fmac_f32 v83, v202, v211
    v_fmac_f32 v84, v202, v212
    v_fmac_f32 v85, v202, v213
    v_fmac_f32 v86, v202, v214
    v_fmac_f32 v87, v202, v215
    v_fmac_f32 v88, v203, v208
    v_fmac_f32 v89, v203, v209
    v_fmac_f32 v90, v203, v210
    v_fmac_f32 v91, v203, v211
    v_fmac_f32 v92, v203, v212
    v_fmac_f32 v93, v203, v213
    v_fmac_f32 v94, v203, v214
    v_fmac_f32 v95, v203, v215
    v_fmac_f32 v96, v204, v208
    v_fmac_f32 v97, v204, v209
    v_fmac_f32 v98, v204, v210
    v_fmac_f32 v99, v204, v211
    v_fmac_f32 v100, v204, v212
    v_fmac_f32 v101, v204, v213
    v_fmac_f32 v102, v204, v214
    v_fmac_f32 v103, v204, v215
    v_fmac_f32 v104, v205, v208
    v_fmac_f32 v105, v205, v209
    v_fmac_f32 v106, v205, v210
    v_fmac_f32 v107, v205, v211
    v_fmac_f32 v108, v205, v212
    v_fmac_f32 v109, v205, v213
    v_fmac_f32 v110, v205, v214
    v_fmac_f32 v111, v205, v215
    v_fmac_f32 v112, v206, v208
    v_fmac_f32 v113, v206, v209
    v_fmac_f32 v114, v206, v210
    v_fmac_f32 v115, v206, v211
    v_fmac_f32 v116, v206, v212
    v_fmac_f32 v117, v206, v213
    v_fmac_f32 v118, v206, v214
    v_fmac_f32 v119, v206, v215
    v_fmac_f32 v120, v207, v208
    v_fmac_f32 v121, v207, v209
    v_fmac_f32 v122, v207, v210
    v_fmac_f32 v123, v207, v211
    v_fmac_f32 v124, v207, v212
    v_fmac_f32 v125, v207, v213
    v_fmac_f32 v126, v207, v214
    v_fmac_f32 v127, v207, v215
    ds_read_b128 v[200:203], v7 offset:2048
    ds_read_b128 v[204:207], v7 offset:2064
    v_lshlrev_b32 v208, 16, v136
    v_and_b32 v209, 0xffff0000, v136
    v_lshlrev_b32 v210, 16, v137
    v_and_b32 v211, 0xffff0000, v137
    v_lshlrev_b32 v212, 16, v138
    v_and_b32 v213, 0xffff0000, v138
    v_lshlrev_b32 v214, 16, v139
    v_and_b32 v215, 0xffff0000, v139
    s_waitcnt lgkmcnt(0)
    v_fmac_f32 v64, v200, v208
    v_fmac_f32 v65, v200, v209
    v_fmac_f32 v66, v200, v210
    v_fmac_f32 v67, v200, v211
    v_fmac_f32 v68, v200, v212
    v_fmac_f32 v69, v200, v213
    v_fmac_f32 v70, v200, v214
    v_fmac_f32 v71, v200, v215
    v_fmac_f32 v72, v201, v208
    v_fmac_f32 v73, v201, v209
    v_fmac_f32 v74, v201, v210
    v_fmac_f32 v75, v201, v211
    v_fmac_f32 v76, v201, v212
    v_fmac_f32 v77, v201, v213
    v_fmac_f32 v78, v201, v214
    v_fmac_f32 v79, v201, v215
    v_fmac_f32 v80, v202, v208
    v_fmac_f32 v81, v202, v209
    v_fmac_f32 v82, v202, v210
    v_fmac_f32 v83, v202, v211
    v_fmac_f32 v84, v202, v212
    v_fmac_f32 v85, v202, v213
    v_fmac_f32 v86, v202, v214
    v_fmac_f32 v87, v202, v215
    v_fmac_f32 v88, v203, v208
    v_fmac_f32 v89, v203, v209
    v_fmac_f32 v90, v203, v210
    v_fmac_f32 v91, v203, v211
    v_fmac_f32 v92, v203, v212
    v_fmac_f32 v93, v203, v213
    v_fmac_f32 v94, v203, v214
    v_fmac_f32 v95, v203, v215
    v_fmac_f32 v96, v204, v208
    v_fmac_f32 v97, v204, v209
    v_fmac_f32 v98, v204, v210
    v_fmac_f32 v99, v204, v211
    v_fmac_f32 v100, v204, v212
    v_fmac_f32 v101, v204, v213
    v_fmac_f32 v102, v204, v214
    v_fmac_f32 v103, v204, v215
    v_fmac_f32 v104, v205, v208
    v_fmac_f32 v105, v205, v209
    v_fmac_f32 v106, v205, v210
    v_fmac_f32 v107, v205, v211
    v_fmac_f32 v108, v205, v212
    v_fmac_f32 v109, v205, v213
    v_fmac_f32 v110, v205, v214
    v_fmac_f32 v111, v205, v215
    v_fmac_f32 v112, v206, v208
    v_fmac_f32 v113, v206, v209
    v_fmac_f32 v114, v206, v210
    v_fmac_f32 v115, v206, v211
    v_fmac_f32 v116, v206, v212
    v_fmac_f32 v117, v206, v213
    v_fmac_f32 v118, v206, v214
    v_fmac_f32 v119, v206, v215
    v_fmac_f32 v120, v207, v208
    v_fmac_f32 v121, v207, v209
    v_fmac_f32 v122, v207, v210
    v_fmac_f32 v123, v207, v211
    v_fmac_f32 v124, v207, v212
    v_fmac_f32 v125, v207, v213
    v_fmac_f32 v126, v207, v214
    v_fmac_f32 v127, v207, v215
    ds_read_b128 v[200:203], v7 offset:3072
    ds_read_b128 v[204:207], v7 offset:3088
    v_lshlrev_b32 v208, 16, v140
    v_and_b32 v209, 0xffff0000, v140
    v_lshlrev_b32 v210, 16, v141
    v_and_b32 v211, 0xffff0000, v141
    v_lshlrev_b32 v212, 16, v142
    v_and_b32 v213, 0xffff0000, v142
    v_lshlrev_b32 v214, 16, v143
    v_and_b32 v215, 0xffff0000, v143
    s_waitcnt lgkmcnt(0)
    v_fmac_f32 v64, v200, v208
    v_fmac_f32 v65, v200, v209
    v_fmac_f32 v66, v200, v210
    v_fmac_f32 v67, v200, v211
    v_fmac_f32 v68, v200, v212
    v_fmac_f32 v69, v200, v213
    v_fmac_f32 v70, v200, v214
    v_fmac_f32 v71, v200, v215
    v_fmac_f32 v72, v201, v208
    v_fmac_f32 v73, v201, v209
    v_fmac_f32 v74, v201, v210
    v_fmac_f32 v75, v201, v211
    v_fmac_f32 v76, v201, v212
    v_fmac_f32 v77, v201, v213
    v_fmac_f32 v78, v201, v214
    v_fmac_f32 v79, v201, v215
    v_fmac_f32 v80, v202, v208
    v_fmac_f32 v81, v202, v209
    v_fmac_f32 v82, v202, v210
    v_fmac_f32 v83, v202, v211
    v_fmac_f32 v84, v202, v212
    v_fmac_f32 v85, v202, v213
    v_fmac_f32 v86, v202, v214
    v_fmac_f32 v87, v202, v215
    v_fmac_f32 v88, v203, v208
    v_fmac_f32 v89, v203, v209
    v_fmac_f32 v90, v203, v210
    v_fmac_f32 v91, v203, v211
    v_fmac_f32 v92, v203, v212
    v_fmac_f32 v93, v203, v213
    v_fmac_f32 v94, v203, v214
    v_fmac_f32 v95, v203, v215
    v_fmac_f32 v96, v204, v208
    v_fmac_f32 v97, v204, v209
    v_fmac_f32 v98, v204, v210
    v_fmac_f32 v99, v204, v211
    v_fmac_f32 v100, v204, v212
    v_fmac_f32 v101, v204, v213
    v_fmac_f32 v102, v204, v214
    v_fmac_f32 v103, v204, v215
    v_fmac_f32 v104, v205, v208
    v_fmac_f32 v105, v205, v209
    v_fmac_f32 v106, v205, v210
    v_fmac_f32 v107, v205, v211
    v_fmac_f32 v108, v205, v212
    v_fmac_f32 v109, v205, v213
    v_fmac_f32 v110, v205, v214
    v_fmac_f32 v111, v205, v215
    v_fmac_f32 v112, v206, v208
    v_fmac_f32 v113, v206, v209
    v_fmac_f32 v114, v206, v210
    v_fmac_f32 v115, v206, v211
    v_fmac_f32 v116, v206, v212
    v_fmac_f32 v117, v206, v213
    v_fmac_f32 v118, v206, v214
    v_fmac_f32 v119, v206, v215
    v_fmac_f32 v120, v207, v208
    v_fmac_f32 v121, v207, v209
    v_fmac_f32 v122, v207, v210
    v_fmac_f32 v123, v207, v211
    v_fmac_f32 v124, v207, v212
    v_fmac_f32 v125, v207, v213
    v_fmac_f32 v126, v207, v214
    v_fmac_f32 v127, v207, v215
    ds_read_b128 v[200:203], v7 offset:4096
    ds_read_b128 v[204:207], v7 offset:4112
    v_lshlrev_b32 v208, 16, v144
    v_and_b32 v209, 0xffff0000, v144
    v_lshlrev_b32 v210, 16, v145
    v_and_b32 v211, 0xffff0000, v145
    v_lshlrev_b32 v212, 16, v146
    v_and_b32 v213, 0xffff0000, v146
    v_lshlrev_b32 v214, 16, v147
    v_and_b32 v215, 0xffff0000, v147
    s_waitcnt lgkmcnt(0)
    v_fmac_f32 v64, v200, v208
    v_fmac_f32 v65, v200, v209
    v_fmac_f32 v66, v200, v210
    v_fmac_f32 v67, v200, v211
    v_fmac_f32 v68, v200, v212
    v_fmac_f32 v69, v200, v213
    v_fmac_f32 v70, v200, v214
    v_fmac_f32 v71, v200, v215
    v_fmac_f32 v72, v201, v208
    v_fmac_f32 v73, v201, v209
    v_fmac_f32 v74, v201, v210
    v_fmac_f32 v75, v201, v211
    v_fmac_f32 v76, v201, v212
    v_fmac_f32 v77, v201, v213
    v_fmac_f32 v78, v201, v214
    v_fmac_f32 v79, v201, v215
    v_fmac_f32 v80, v202, v208
    v_fmac_f32 v81, v202, v209
    v_fmac_f32 v82, v202, v210
    v_fmac_f32 v83, v202, v211
    v_fmac_f32 v84, v202, v212
    v_fmac_f32 v85, v202, v213
    v_fmac_f32 v86, v202, v214
    v_fmac_f32 v87, v202, v215
    v_fmac_f32 v88, v203, v208
    v_fmac_f32 v89, v203, v209
    v_fmac_f32 v90, v203, v210
    v_fmac_f32 v91, v203, v211
    v_fmac_f32 v92, v203, v212
    v_fmac_f32 v93, v203, v213
    v_fmac_f32 v94, v203, v214
    v_fmac_f32 v95, v203, v215
    v_fmac_f32 v96, v204, v208
    v_fmac_f32 v97, v204, v209
    v_fmac_f32 v98, v204, v210
    v_fmac_f32 v99, v204, v211
    v_fmac_f32 v100, v204, v212
    v_fmac_f32 v101, v204, v213
    v_fmac_f32 v102, v204, v214
    v_fmac_f32 v103, v204, v215
    v_fmac_f32 v104, v205, v208
    v_fmac_f32 v105, v205, v209
    v_fmac_f32 v106, v205, v210
    v_fmac_f32 v107, v205, v211
    v_fmac_f32 v108, v205, v212
    v_fmac_f32 v109, v205, v213
    v_fmac_f32 v110, v205, v214
    v_fmac_f32 v111, v205, v215
    v_fmac_f32 v112, v206, v208
    v_fmac_f32 v113, v206, v209
    v_fmac_f32 v114, v206, v210
    v_fmac_f32 v115, v206, v211
    v_fmac_f32 v116, v206, v212
    v_fmac_f32 v117, v206, v213
    v_fmac_f32 v118, v206, v214
    v_fmac_f32 v119, v206, v215
    v_fmac_f32 v120, v207, v208
    v_fmac_f32 v121, v207, v209
    v_fmac_f32 v122, v207, v210
    v_fmac_f32 v123, v207, v211
    v_fmac_f32 v124, v207, v212
    v_fmac_f32 v125, v207, v213
    v_fmac_f32 v126, v207, v214
    v_fmac_f32 v127, v207, v215
    ds_read_b128 v[200:203], v7 offset:5120
    ds_read_b128 v[204:207], v7 offset:5136
    v_lshlrev_b32 v208, 16, v148
    v_and_b32 v209, 0xffff0000, v148
    v_lshlrev_b32 v210, 16, v149
    v_and_b32 v211, 0xffff0000, v149
    v_lshlrev_b32 v212, 16, v150
    v_and_b32 v213, 0xffff0000, v150
    v_lshlrev_b32 v214, 16, v151
    v_and_b32 v215, 0xffff0000, v151
    s_waitcnt lgkmcnt(0)
    v_fmac_f32 v64, v200, v208
    v_fmac_f32 v65, v200, v209
    v_fmac_f32 v66, v200, v210
    v_fmac_f32 v67, v200, v211
    v_fmac_f32 v68, v200, v212
    v_fmac_f32 v69, v200, v213
    v_fmac_f32 v70, v200, v214
    v_fmac_f32 v71, v200, v215
    v_fmac_f32 v72, v201, v208
    v_fmac_f32 v73, v201, v209
    v_fmac_f32 v74, v201, v210
    v_fmac_f32 v75, v201, v211
    v_fmac_f32 v76, v201, v212
    v_fmac_f32 v77, v201, v213
    v_fmac_f32 v78, v201, v214
    v_fmac_f32 v79, v201, v215
    v_fmac_f32 v80, v202, v208
    v_fmac_f32 v81, v202, v209
    v_fmac_f32 v82, v202, v210
    v_fmac_f32 v83, v202, v211
    v_fmac_f32 v84, v202, v212
    v_fmac_f32 v85, v202, v213
    v_fmac_f32 v86, v202, v214
    v_fmac_f32 v87, v202, v215
    v_fmac_f32 v88, v203, v208
    v_fmac_f32 v89, v203, v209
    v_fmac_f32 v90, v203, v210
    v_fmac_f32 v91, v203, v211
    v_fmac_f32 v92, v203, v212
    v_fmac_f32 v93, v203, v213
    v_fmac_f32 v94, v203, v214
    v_fmac_f32 v95, v203, v215
    v_fmac_f32 v96, v204, v208
    v_fmac_f32 v97, v204, v209
    v_fmac_f32 v98, v204, v210
    v_fmac_f32 v99, v204, v211
    v_fmac_f32 v100, v204, v212
    v_fmac_f32 v101, v204, v213
    v_fmac_f32 v102, v204, v214
    v_fmac_f32 v103, v204, v215
    v_fmac_f32 v104, v205, v208
    v_fmac_f32 v105, v205, v209
    v_fmac_f32 v106, v205, v210
    v_fmac_f32 v107, v205, v211
    v_fmac_f32 v108, v205, v212
    v_fmac_f32 v109, v205, v213
    v_fmac_f32 v110, v205, v214
    v_fmac_f32 v111, v205, v215
    v_fmac_f32 v112, v206, v208
    v_fmac_f32 v113, v206, v209
    v_fmac_f32 v114, v206, v210
    v_fmac_f32 v115, v206, v211
    v_fmac_f32 v116, v206, v212
    v_fmac_f32 v117, v206, v213
    v_fmac_f32 v118, v206, v214
    v_fmac_f32 v119, v206, v215
    v_fmac_f32 v120, v207, v208
    v_fmac_f32 v121, v207, v209
    v_fmac_f32 v122, v207, v210
    v_fmac_f32 v123, v207, v211
    v_fmac_f32 v124, v207, v212
    v_fmac_f32 v125, v207, v213
    v_fmac_f32 v126, v207, v214
    v_fmac_f32 v127, v207, v215
    ds_read_b128 v[200:203], v7 offset:6144
    ds_read_b128 v[204:207], v7 offset:6160
    v_lshlrev_b32 v208, 16, v152
    v_and_b32 v209, 0xffff0000, v152
    v_lshlrev_b32 v210, 16, v153
    v_and_b32 v211, 0xffff0000, v153
    v_lshlrev_b32 v212, 16, v154
    v_and_b32 v213, 0xffff0000, v154
    v_lshlrev_b32 v214, 16, v155
    v_and_b32 v215, 0xffff0000, v155
    s_waitcnt lgkmcnt(0)
    v_fmac_f32 v64, v200, v208
    v_fmac_f32 v65, v200, v209
    v_fmac_f32 v66, v200, v210
    v_fmac_f32 v67, v200, v211
    v_fmac_f32 v68, v200, v212
    v_fmac_f32 v69, v200, v213
    v_fmac_f32 v70, v200, v214
    v_fmac_f32 v71, v200, v215
    v_fmac_f32 v72, v201, v208
    v_fmac_f32 v73, v201, v209
    v_fmac_f32 v74, v201, v210
    v_fmac_f32 v75, v201, v211
    v_fmac_f32 v76, v201, v212
    v_fmac_f32 v77, v201, v213
    v_fmac_f32 v78, v201, v214
    v_fmac_f32 v79, v201, v215
    v_fmac_f32 v80, v202, v208
    v_fmac_f32 v81, v202, v209
    v_fmac_f32 v82, v202, v210
    v_fmac_f32 v83, v202, v211
    v_fmac_f32 v84, v202, v212
    v_fmac_f32 v85, v202, v213
    v_fmac_f32 v86, v202, v214
    v_fmac_f32 v87, v202, v215
    v_fmac_f32 v88, v203, v208
    v_fmac_f32 v89, v203, v209
    v_fmac_f32 v90, v203, v210
    v_fmac_f32 v91, v203, v211
    v_fmac_f32 v92, v203, v212
    v_fmac_f32 v93, v203, v213
    v_fmac_f32 v94, v203, v214
    v_fmac_f32 v95, v203, v215
    v_fmac_f32 v96, v204, v208
    v_fmac_f32 v97, v204, v209
    v_fmac_f32 v98, v204, v210
    v_fmac_f32 v99, v204, v211
    v_fmac_f32 v100, v204, v212
    v_fmac_f32 v101, v204, v213
    v_fmac_f32 v102, v204, v214
    v_fmac_f32 v103, v204, v215
    v_fmac_f32 v104, v205, v208
    v_fmac_f32 v105, v205, v209
    v_fmac_f32 v106, v205, v210
    v_fmac_f32 v107, v205, v211
    v_fmac_f32 v108, v205, v212
    v_fmac_f32 v109, v205, v213
    v_fmac_f32 v110, v205, v214
    v_fmac_f32 v111, v205, v215
    v_fmac_f32 v112, v206, v208
    v_fmac_f32 v113, v206, v209
    v_fmac_f32 v114, v206, v210
    v_fmac_f32 v115, v206, v211
    v_fmac_f32 v116, v206, v212
    v_fmac_f32 v117, v206, v213
    v_fmac_f32 v118, v206, v214
    v_fmac_f32 v119, v206, v215
    v_fmac_f32 v120, v207, v208
    v_fmac_f32 v121, v207, v209
    v_fmac_f32 v122, v207, v210
    v_fmac_f32 v123, v207, v211
    v_fmac_f32 v124, v207, v212
    v_fmac_f32 v125, v207, v213
    v_fmac_f32 v126, v207, v214
    v_fmac_f32 v127, v207, v215
    ds_read_b128 v[200:203], v7 offset:7168
    ds_read_b128 v[204:207], v7 offset:7184
    v_lshlrev_b32 v208, 16, v156
    v_and_b32 v209, 0xffff0000, v156
    v_lshlrev_b32 v210, 16, v157
    v_and_b32 v211, 0xffff0000, v157
    v_lshlrev_b32 v212, 16, v158
    v_and_b32 v213, 0xffff0000, v158
    v_lshlrev_b32 v214, 16, v159
    v_and_b32 v215, 0xffff0000, v159
    s_waitcnt lgkmcnt(0)
    v_fmac_f32 v64, v200, v208
    v_fmac_f32 v65, v200, v209
    v_fmac_f32 v66, v200, v210
    v_fmac_f32 v67, v200, v211
    v_fmac_f32 v68, v200, v212
    v_fmac_f32 v69, v200, v213
    v_fmac_f32 v70, v200, v214
    v_fmac_f32 v71, v200, v215
    v_fmac_f32 v72, v201, v208
    v_fmac_f32 v73, v201, v209
    v_fmac_f32 v74, v201, v210
    v_fmac_f32 v75, v201, v211
    v_fmac_f32 v76, v201, v212
    v_fmac_f32 v77, v201, v213
    v_fmac_f32 v78, v201, v214
    v_fmac_f32 v79, v201, v215
    v_fmac_f32 v80, v202, v208
    v_fmac_f32 v81, v202, v209
    v_fmac_f32 v82, v202, v210
    v_fmac_f32 v83, v202, v211
    v_fmac_f32 v84, v202, v212
    v_fmac_f32 v85, v202, v213
    v_fmac_f32 v86, v202, v214
    v_fmac_f32 v87, v202, v215
    v_fmac_f32 v88, v203, v208
    v_fmac_f32 v89, v203, v209
    v_fmac_f32 v90, v203, v210
    v_fmac_f32 v91, v203, v211
    v_fmac_f32 v92, v203, v212
    v_fmac_f32 v93, v203, v213
    v_fmac_f32 v94, v203, v214
    v_fmac_f32 v95, v203, v215
    v_fmac_f32 v96, v204, v208
    v_fmac_f32 v97, v204, v209
    v_fmac_f32 v98, v204, v210
    v_fmac_f32 v99, v204, v211
    v_fmac_f32 v100, v204, v212
    v_fmac_f32 v101, v204, v213
    v_fmac_f32 v102, v204, v214
    v_fmac_f32 v103, v204, v215
    v_fmac_f32 v104, v205, v208
    v_fmac_f32 v105, v205, v209
    v_fmac_f32 v106, v205, v210
    v_fmac_f32 v107, v205, v211
    v_fmac_f32 v108, v205, v212
    v_fmac_f32 v109, v205, v213
    v_fmac_f32 v110, v205, v214
    v_fmac_f32 v111, v205, v215
    v_fmac_f32 v112, v206, v208
    v_fmac_f32 v113, v206, v209
    v_fmac_f32 v114, v206, v210
    v_fmac_f32 v115, v206, v211
    v_fmac_f32 v116, v206, v212
    v_fmac_f32 v117, v206, v213
    v_fmac_f32 v118, v206, v214
    v_fmac_f32 v119, v206, v215
    v_fmac_f32 v120, v207, v208
    v_fmac_f32 v121, v207, v209
    v_fmac_f32 v122, v207, v210
    v_fmac_f32 v123, v207, v211
    v_fmac_f32 v124, v207, v212
    v_fmac_f32 v125, v207, v213
    v_fmac_f32 v126, v207, v214
    v_fmac_f32 v127, v207, v215
    ds_read_b128 v[200:203], v7 offset:8192
    ds_read_b128 v[204:207], v7 offset:8208
    v_lshlrev_b32 v208, 16, v160
    v_and_b32 v209, 0xffff0000, v160
    v_lshlrev_b32 v210, 16, v161
    v_and_b32 v211, 0xffff0000, v161
    v_lshlrev_b32 v212, 16, v162
    v_and_b32 v213, 0xffff0000, v162
    v_lshlrev_b32 v214, 16, v163
    v_and_b32 v215, 0xffff0000, v163
    s_waitcnt lgkmcnt(0)
    v_fmac_f32 v64, v200, v208
    v_fmac_f32 v65, v200, v209
    v_fmac_f32 v66, v200, v210
    v_fmac_f32 v67, v200, v211
    v_fmac_f32 v68, v200, v212
    v_fmac_f32 v69, v200, v213
    v_fmac_f32 v70, v200, v214
    v_fmac_f32 v71, v200, v215
    v_fmac_f32 v72, v201, v208
    v_fmac_f32 v73, v201, v209
    v_fmac_f32 v74, v201, v210
    v_fmac_f32 v75, v201, v211
    v_fmac_f32 v76, v201, v212
    v_fmac_f32 v77, v201, v213
    v_fmac_f32 v78, v201, v214
    v_fmac_f32 v79, v201, v215
    v_fmac_f32 v80, v202, v208
    v_fmac_f32 v81, v202, v209
    v_fmac_f32 v82, v202, v210
    v_fmac_f32 v83, v202, v211
    v_fmac_f32 v84, v202, v212
    v_fmac_f32 v85, v202, v213
    v_fmac_f32 v86, v202, v214
    v_fmac_f32 v87, v202, v215
    v_fmac_f32 v88, v203, v208
    v_fmac_f32 v89, v203, v209
    v_fmac_f32 v90, v203, v210
    v_fmac_f32 v91, v203, v211
    v_fmac_f32 v92, v203, v212
    v_fmac_f32 v93, v203, v213
    v_fmac_f32 v94, v203, v214
    v_fmac_f32 v95, v203, v215
    v_fmac_f32 v96, v204, v208
    v_fmac_f32 v97, v204, v209
    v_fmac_f32 v98, v204, v210
    v_fmac_f32 v99, v204, v211
    v_fmac_f32 v100, v204, v212
    v_fmac_f32 v101, v204, v213
    v_fmac_f32 v102, v204, v214
    v_fmac_f32 v103, v204, v215
    v_fmac_f32 v104, v205, v208
    v_fmac_f32 v105, v205, v209
    v_fmac_f32 v106, v205, v210
    v_fmac_f32 v107, v205, v211
    v_fmac_f32 v108, v205, v212
    v_fmac_f32 v109, v205, v213
    v_fmac_f32 v110, v205, v214
    v_fmac_f32 v111, v205, v215
    v_fmac_f32 v112, v206, v208
    v_fmac_f32 v113, v206, v209
    v_fmac_f32 v114, v206, v210
    v_fmac_f32 v115, v206, v211
    v_fmac_f32 v116, v206, v212
    v_fmac_f32 v117, v206, v213
    v_fmac_f32 v118, v206, v214
    v_fmac_f32 v119, v206, v215
    v_fmac_f32 v120, v207, v208
    v_fmac_f32 v121, v207, v209
    v_fmac_f32 v122, v207, v210
    v_fmac_f32 v123, v207, v211
    v_fmac_f32 v124, v207, v212
    v_fmac_f32 v125, v207, v213
    v_fmac_f32 v126, v207, v214
    v_fmac_f32 v127, v207, v215
    ds_read_b128 v[200:203], v7 offset:9216
    ds_read_b128 v[204:207], v7 offset:9232
    v_lshlrev_b32 v208, 16, v164
    v_and_b32 v209, 0xffff0000, v164
    v_lshlrev_b32 v210, 16, v165
    v_and_b32 v211, 0xffff0000, v165
    v_lshlrev_b32 v212, 16, v166
    v_and_b32 v213, 0xffff0000, v166
    v_lshlrev_b32 v214, 16, v167
    v_and_b32 v215, 0xffff0000, v167
    s_waitcnt lgkmcnt(0)
    v_fmac_f32 v64, v200, v208
    v_fmac_f32 v65, v200, v209
    v_fmac_f32 v66, v200, v210
    v_fmac_f32 v67, v200, v211
    v_fmac_f32 v68, v200, v212
    v_fmac_f32 v69, v200, v213
    v_fmac_f32 v70, v200, v214
    v_fmac_f32 v71, v200, v215
    v_fmac_f32 v72, v201, v208
    v_fmac_f32 v73, v201, v209
    v_fmac_f32 v74, v201, v210
    v_fmac_f32 v75, v201, v211
    v_fmac_f32 v76, v201, v212
    v_fmac_f32 v77, v201, v213
    v_fmac_f32 v78, v201, v214
    v_fmac_f32 v79, v201, v215
    v_fmac_f32 v80, v202, v208
    v_fmac_f32 v81, v202, v209
    v_fmac_f32 v82, v202, v210
    v_fmac_f32 v83, v202, v211
    v_fmac_f32 v84, v202, v212
    v_fmac_f32 v85, v202, v213
    v_fmac_f32 v86, v202, v214
    v_fmac_f32 v87, v202, v215
    v_fmac_f32 v88, v203, v208
    v_fmac_f32 v89, v203, v209
    v_fmac_f32 v90, v203, v210
    v_fmac_f32 v91, v203, v211
    v_fmac_f32 v92, v203, v212
    v_fmac_f32 v93, v203, v213
    v_fmac_f32 v94, v203, v214
    v_fmac_f32 v95, v203, v215
    v_fmac_f32 v96, v204, v208
    v_fmac_f32 v97, v204, v209
    v_fmac_f32 v98, v204, v210
    v_fmac_f32 v99, v204, v211
    v_fmac_f32 v100, v204, v212
    v_fmac_f32 v101, v204, v213
    v_fmac_f32 v102, v204, v214
    v_fmac_f32 v103, v204, v215
    v_fmac_f32 v104, v205, v208
    v_fmac_f32 v105, v205, v209
    v_fmac_f32 v106, v205, v210
    v_fmac_f32 v107, v205, v211
    v_fmac_f32 v108, v205, v212
    v_fmac_f32 v109, v205, v213
    v_fmac_f32 v110, v205, v214
    v_fmac_f32 v111, v205, v215
    v_fmac_f32 v112, v206, v208
    v_fmac_f32 v113, v206, v209
    v_fmac_f32 v114, v206, v210
    v_fmac_f32 v115, v206, v211
    v_fmac_f32 v116, v206, v212
    v_fmac_f32 v117, v206, v213
    v_fmac_f32 v118, v206, v214
    v_fmac_f32 v119, v206, v215
    v_fmac_f32 v120, v207, v208
    v_fmac_f32 v121, v207, v209
    v_fmac_f32 v122, v207, v210
    v_fmac_f32 v123, v207, v211
    v_fmac_f32 v124, v207, v212
    v_fmac_f32 v125, v207, v213
    v_fmac_f32 v126, v207, v214
    v_fmac_f32 v127, v207, v215
    ds_read_b128 v[200:203], v7 offset:10240
    ds_read_b128 v[204:207], v7 offset:10256
    v_lshlrev_b32 v208, 16, v168
    v_and_b32 v209, 0xffff0000, v168
    v_lshlrev_b32 v210, 16, v169
    v_and_b32 v211, 0xffff0000, v169
    v_lshlrev_b32 v212, 16, v170
    v_and_b32 v213, 0xffff0000, v170
    v_lshlrev_b32 v214, 16, v171
    v_and_b32 v215, 0xffff0000, v171
    s_waitcnt lgkmcnt(0)
    v_fmac_f32 v64, v200, v208
    v_fmac_f32 v65, v200, v209
    v_fmac_f32 v66, v200, v210
    v_fmac_f32 v67, v200, v211
    v_fmac_f32 v68, v200, v212
    v_fmac_f32 v69, v200, v213
    v_fmac_f32 v70, v200, v214
    v_fmac_f32 v71, v200, v215
    v_fmac_f32 v72, v201, v208
    v_fmac_f32 v73, v201, v209
    v_fmac_f32 v74, v201, v210
    v_fmac_f32 v75, v201, v211
    v_fmac_f32 v76, v201, v212
    v_fmac_f32 v77, v201, v213
    v_fmac_f32 v78, v201, v214
    v_fmac_f32 v79, v201, v215
    v_fmac_f32 v80, v202, v208
    v_fmac_f32 v81, v202, v209
    v_fmac_f32 v82, v202, v210
    v_fmac_f32 v83, v202, v211
    v_fmac_f32 v84, v202, v212
    v_fmac_f32 v85, v202, v213
    v_fmac_f32 v86, v202, v214
    v_fmac_f32 v87, v202, v215
    v_fmac_f32 v88, v203, v208
    v_fmac_f32 v89, v203, v209
    v_fmac_f32 v90, v203, v210
    v_fmac_f32 v91, v203, v211
    v_fmac_f32 v92, v203, v212
    v_fmac_f32 v93, v203, v213
    v_fmac_f32 v94, v203, v214
    v_fmac_f32 v95, v203, v215
    v_fmac_f32 v96, v204, v208
    v_fmac_f32 v97, v204, v209
    v_fmac_f32 v98, v204, v210
    v_fmac_f32 v99, v204, v211
    v_fmac_f32 v100, v204, v212
    v_fmac_f32 v101, v204, v213
    v_fmac_f32 v102, v204, v214
    v_fmac_f32 v103, v204, v215
    v_fmac_f32 v104, v205, v208
    v_fmac_f32 v105, v205, v209
    v_fmac_f32 v106, v205, v210
    v_fmac_f32 v107, v205, v211
    v_fmac_f32 v108, v205, v212
    v_fmac_f32 v109, v205, v213
    v_fmac_f32 v110, v205, v214
    v_fmac_f32 v111, v205, v215
    v_fmac_f32 v112, v206, v208
    v_fmac_f32 v113, v206, v209
    v_fmac_f32 v114, v206, v210
    v_fmac_f32 v115, v206, v211
    v_fmac_f32 v116, v206, v212
    v_fmac_f32 v117, v206, v213
    v_fmac_f32 v118, v206, v214
    v_fmac_f32 v119, v206, v215
    v_fmac_f32 v120, v207, v208
    v_fmac_f32 v121, v207, v209
    v_fmac_f32 v122, v207, v210
    v_fmac_f32 v123, v207, v211
    v_fmac_f32 v124, v207, v212
    v_fmac_f32 v125, v207, v213
    v_fmac_f32 v126, v207, v214
    v_fmac_f32 v127, v207, v215
    ds_read_b128 v[200:203], v7 offset:11264
    ds_read_b128 v[204:207], v7 offset:11280
    v_lshlrev_b32 v208, 16, v172
    v_and_b32 v209, 0xffff0000, v172
    v_lshlrev_b32 v210, 16, v173
    v_and_b32 v211, 0xffff0000, v173
    v_lshlrev_b32 v212, 16, v174
    v_and_b32 v213, 0xffff0000, v174
    v_lshlrev_b32 v214, 16, v175
    v_and_b32 v215, 0xffff0000, v175
    s_waitcnt lgkmcnt(0)
    v_fmac_f32 v64, v200, v208
    v_fmac_f32 v65, v200, v209
    v_fmac_f32 v66, v200, v210
    v_fmac_f32 v67, v200, v211
    v_fmac_f32 v68, v200, v212
    v_fmac_f32 v69, v200, v213
    v_fmac_f32 v70, v200, v214
    v_fmac_f32 v71, v200, v215
    v_fmac_f32 v72, v201, v208
    v_fmac_f32 v73, v201, v209
    v_fmac_f32 v74, v201, v210
    v_fmac_f32 v75, v201, v211
    v_fmac_f32 v76, v201, v212
    v_fmac_f32 v77, v201, v213
    v_fmac_f32 v78, v201, v214
    v_fmac_f32 v79, v201, v215
    v_fmac_f32 v80, v202, v208
    v_fmac_f32 v81, v202, v209
    v_fmac_f32 v82, v202, v210
    v_fmac_f32 v83, v202, v211
    v_fmac_f32 v84, v202, v212
    v_fmac_f32 v85, v202, v213
    v_fmac_f32 v86, v202, v214
    v_fmac_f32 v87, v202, v215
    v_fmac_f32 v88, v203, v208
    v_fmac_f32 v89, v203, v209
    v_fmac_f32 v90, v203, v210
    v_fmac_f32 v91, v203, v211
    v_fmac_f32 v92, v203, v212
    v_fmac_f32 v93, v203, v213
    v_fmac_f32 v94, v203, v214
    v_fmac_f32 v95, v203, v215
    v_fmac_f32 v96, v204, v208
    v_fmac_f32 v97, v204, v209
    v_fmac_f32 v98, v204, v210
    v_fmac_f32 v99, v204, v211
    v_fmac_f32 v100, v204, v212
    v_fmac_f32 v101, v204, v213
    v_fmac_f32 v102, v204, v214
    v_fmac_f32 v103, v204, v215
    v_fmac_f32 v104, v205, v208
    v_fmac_f32 v105, v205, v209
    v_fmac_f32 v106, v205, v210
    v_fmac_f32 v107, v205, v211
    v_fmac_f32 v108, v205, v212
    v_fmac_f32 v109, v205, v213
    v_fmac_f32 v110, v205, v214
    v_fmac_f32 v111, v205, v215
    v_fmac_f32 v112, v206, v208
    v_fmac_f32 v113, v206, v209
    v_fmac_f32 v114, v206, v210
    v_fmac_f32 v115, v206, v211
    v_fmac_f32 v116, v206, v212
    v_fmac_f32 v117, v206, v213
    v_fmac_f32 v118, v206, v214
    v_fmac_f32 v119, v206, v215
    v_fmac_f32 v120, v207, v208
    v_fmac_f32 v121, v207, v209
    v_fmac_f32 v122, v207, v210
    v_fmac_f32 v123, v207, v211
    v_fmac_f32 v124, v207, v212
    v_fmac_f32 v125, v207, v213
    v_fmac_f32 v126, v207, v214
    v_fmac_f32 v127, v207, v215
    ds_read_b128 v[200:203], v7 offset:12288
    ds_read_b128 v[204:207], v7 offset:12304
    v_lshlrev_b32 v208, 16, v176
    v_and_b32 v209, 0xffff0000, v176
    v_lshlrev_b32 v210, 16, v177
    v_and_b32 v211, 0xffff0000, v177
    v_lshlrev_b32 v212, 16, v178
    v_and_b32 v213, 0xffff0000, v178
    v_lshlrev_b32 v214, 16, v179
    v_and_b32 v215, 0xffff0000, v179
    s_waitcnt lgkmcnt(0)
    v_fmac_f32 v64, v200, v208
    v_fmac_f32 v65, v200, v209
    v_fmac_f32 v66, v200, v210
    v_fmac_f32 v67, v200, v211
    v_fmac_f32 v68, v200, v212
    v_fmac_f32 v69, v200, v213
    v_fmac_f32 v70, v200, v214
    v_fmac_f32 v71, v200, v215
    v_fmac_f32 v72, v201, v208
    v_fmac_f32 v73, v201, v209
    v_fmac_f32 v74, v201, v210
    v_fmac_f32 v75, v201, v211
    v_fmac_f32 v76, v201, v212
    v_fmac_f32 v77, v201, v213
    v_fmac_f32 v78, v201, v214
    v_fmac_f32 v79, v201, v215
    v_fmac_f32 v80, v202, v208
    v_fmac_f32 v81, v202, v209
    v_fmac_f32 v82, v202, v210
    v_fmac_f32 v83, v202, v211
    v_fmac_f32 v84, v202, v212
    v_fmac_f32 v85, v202, v213
    v_fmac_f32 v86, v202, v214
    v_fmac_f32 v87, v202, v215
    v_fmac_f32 v88, v203, v208
    v_fmac_f32 v89, v203, v209
    v_fmac_f32 v90, v203, v210
    v_fmac_f32 v91, v203, v211
    v_fmac_f32 v92, v203, v212
    v_fmac_f32 v93, v203, v213
    v_fmac_f32 v94, v203, v214
    v_fmac_f32 v95, v203, v215
    v_fmac_f32 v96, v204, v208
    v_fmac_f32 v97, v204, v209
    v_fmac_f32 v98, v204, v210
    v_fmac_f32 v99, v204, v211
    v_fmac_f32 v100, v204, v212
    v_fmac_f32 v101, v204, v213
    v_fmac_f32 v102, v204, v214
    v_fmac_f32 v103, v204, v215
    v_fmac_f32 v104, v205, v208
    v_fmac_f32 v105, v205, v209
    v_fmac_f32 v106, v205, v210
    v_fmac_f32 v107, v205, v211
    v_fmac_f32 v108, v205, v212
    v_fmac_f32 v109, v205, v213
    v_fmac_f32 v110, v205, v214
    v_fmac_f32 v111, v205, v215
    v_fmac_f32 v112, v206, v208
    v_fmac_f32 v113, v206, v209
    v_fmac_f32 v114, v206, v210
    v_fmac_f32 v115, v206, v211
    v_fmac_f32 v116, v206, v212
    v_fmac_f32 v117, v206, v213
    v_fmac_f32 v118, v206, v214
    v_fmac_f32 v119, v206, v215
    v_fmac_f32 v120, v207, v208
    v_fmac_f32 v121, v207, v209
    v_fmac_f32 v122, v207, v210
    v_fmac_f32 v123, v207, v211
    v_fmac_f32 v124, v207, v212
    v_fmac_f32 v125, v207, v213
    v_fmac_f32 v126, v207, v214
    v_fmac_f32 v127, v207, v215
    ds_read_b128 v[200:203], v7 offset:13312
    ds_read_b128 v[204:207], v7 offset:13328
    v_lshlrev_b32 v208, 16, v180
    v_and_b32 v209, 0xffff0000, v180
    v_lshlrev_b32 v210, 16, v181
    v_and_b32 v211, 0xffff0000, v181
    v_lshlrev_b32 v212, 16, v182
    v_and_b32 v213, 0xffff0000, v182
    v_lshlrev_b32 v214, 16, v183
    v_and_b32 v215, 0xffff0000, v183
    s_waitcnt lgkmcnt(0)
    v_fmac_f32 v64, v200, v208
    v_fmac_f32 v65, v200, v209
    v_fmac_f32 v66, v200, v210
    v_fmac_f32 v67, v200, v211
    v_fmac_f32 v68, v200, v212
    v_fmac_f32 v69, v200, v213
    v_fmac_f32 v70, v200, v214
    v_fmac_f32 v71, v200, v215
    v_fmac_f32 v72, v201, v208
    v_fmac_f32 v73, v201, v209
    v_fmac_f32 v74, v201, v210
    v_fmac_f32 v75, v201, v211
    v_fmac_f32 v76, v201, v212
    v_fmac_f32 v77, v201, v213
    v_fmac_f32 v78, v201, v214
    v_fmac_f32 v79, v201, v215
    v_fmac_f32 v80, v202, v208
    v_fmac_f32 v81, v202, v209
    v_fmac_f32 v82, v202, v210
    v_fmac_f32 v83, v202, v211
    v_fmac_f32 v84, v202, v212
    v_fmac_f32 v85, v202, v213
    v_fmac_f32 v86, v202, v214
    v_fmac_f32 v87, v202, v215
    v_fmac_f32 v88, v203, v208
    v_fmac_f32 v89, v203, v209
    v_fmac_f32 v90, v203, v210
    v_fmac_f32 v91, v203, v211
    v_fmac_f32 v92, v203, v212
    v_fmac_f32 v93, v203, v213
    v_fmac_f32 v94, v203, v214
    v_fmac_f32 v95, v203, v215
    v_fmac_f32 v96, v204, v208
    v_fmac_f32 v97, v204, v209
    v_fmac_f32 v98, v204, v210
    v_fmac_f32 v99, v204, v211
    v_fmac_f32 v100, v204, v212
    v_fmac_f32 v101, v204, v213
    v_fmac_f32 v102, v204, v214
    v_fmac_f32 v103, v204, v215
    v_fmac_f32 v104, v205, v208
    v_fmac_f32 v105, v205, v209
    v_fmac_f32 v106, v205, v210
    v_fmac_f32 v107, v205, v211
    v_fmac_f32 v108, v205, v212
    v_fmac_f32 v109, v205, v213
    v_fmac_f32 v110, v205, v214
    v_fmac_f32 v111, v205, v215
    v_fmac_f32 v112, v206, v208
    v_fmac_f32 v113, v206, v209
    v_fmac_f32 v114, v206, v210
    v_fmac_f32 v115, v206, v211
    v_fmac_f32 v116, v206, v212
    v_fmac_f32 v117, v206, v213
    v_fmac_f32 v118, v206, v214
    v_fmac_f32 v119, v206, v215
    v_fmac_f32 v120, v207, v208
    v_fmac_f32 v121, v207, v209
    v_fmac_f32 v122, v207, v210
    v_fmac_f32 v123, v207, v211
    v_fmac_f32 v124, v207, v212
    v_fmac_f32 v125, v207, v213
    v_fmac_f32 v126, v207, v214
    v_fmac_f32 v127, v207, v215
    ds_read_b128 v[200:203], v7 offset:14336
    ds_read_b128 v[204:207], v7 offset:14352
    v_lshlrev_b32 v208, 16, v184
    v_and_b32 v209, 0xffff0000, v184
    v_lshlrev_b32 v210, 16, v185
    v_and_b32 v211, 0xffff0000, v185
    v_lshlrev_b32 v212, 16, v186
    v_and_b32 v213, 0xffff0000, v186
    v_lshlrev_b32 v214, 16, v187
    v_and_b32 v215, 0xffff0000, v187
    s_waitcnt lgkmcnt(0)
    v_fmac_f32 v64, v200, v208
    v_fmac_f32 v65, v200, v209
    v_fmac_f32 v66, v200, v210
    v_fmac_f32 v67, v200, v211
    v_fmac_f32 v68, v200, v212
    v_fmac_f32 v69, v200, v213
    v_fmac_f32 v70, v200, v214
    v_fmac_f32 v71, v200, v215
    v_fmac_f32 v72, v201, v208
    v_fmac_f32 v73, v201, v209
    v_fmac_f32 v74, v201, v210
    v_fmac_f32 v75, v201, v211
    v_fmac_f32 v76, v201, v212
    v_fmac_f32 v77, v201, v213
    v_fmac_f32 v78, v201, v214
    v_fmac_f32 v79, v201, v215
    v_fmac_f32 v80, v202, v208
    v_fmac_f32 v81, v202, v209
    v_fmac_f32 v82, v202, v210
    v_fmac_f32 v83, v202, v211
    v_fmac_f32 v84, v202, v212
    v_fmac_f32 v85, v202, v213
    v_fmac_f32 v86, v202, v214
    v_fmac_f32 v87, v202, v215
    v_fmac_f32 v88, v203, v208
    v_fmac_f32 v89, v203, v209
    v_fmac_f32 v90, v203, v210
    v_fmac_f32 v91, v203, v211
    v_fmac_f32 v92, v203, v212
    v_fmac_f32 v93, v203, v213
    v_fmac_f32 v94, v203, v214
    v_fmac_f32 v95, v203, v215
    v_fmac_f32 v96, v204, v208
    v_fmac_f32 v97, v204, v209
    v_fmac_f32 v98, v204, v210
    v_fmac_f32 v99, v204, v211
    v_fmac_f32 v100, v204, v212
    v_fmac_f32 v101, v204, v213
    v_fmac_f32 v102, v204, v214
    v_fmac_f32 v103, v204, v215
    v_fmac_f32 v104, v205, v208
    v_fmac_f32 v105, v205, v209
    v_fmac_f32 v106, v205, v210
    v_fmac_f32 v107, v205, v211
    v_fmac_f32 v108, v205, v212
    v_fmac_f32 v109, v205, v213
    v_fmac_f32 v110, v205, v214
    v_fmac_f32 v111, v205, v215
    v_fmac_f32 v112, v206, v208
    v_fmac_f32 v113, v206, v209
    v_fmac_f32 v114, v206, v210
    v_fmac_f32 v115, v206, v211
    v_fmac_f32 v116, v206, v212
    v_fmac_f32 v117, v206, v213
    v_fmac_f32 v118, v206, v214
    v_fmac_f32 v119, v206, v215
    v_fmac_f32 v120, v207, v208
    v_fmac_f32 v121, v207, v209
    v_fmac_f32 v122, v207, v210
    v_fmac_f32 v123, v207, v211
    v_fmac_f32 v124, v207, v212
    v_fmac_f32 v125, v207, v213
    v_fmac_f32 v126, v207, v214
    v_fmac_f32 v127, v207, v215
    ds_read_b128 v[200:203], v7 offset:15360
    ds_read_b128 v[204:207], v7 offset:15376
    v_lshlrev_b32 v208, 16, v188
    v_and_b32 v209, 0xffff0000, v188
    v_lshlrev_b32 v210, 16, v189
    v_and_b32 v211, 0xffff0000, v189
    v_lshlrev_b32 v212, 16, v190
    v_and_b32 v213, 0xffff0000, v190
    v_lshlrev_b32 v214, 16, v191
    v_and_b32 v215, 0xffff0000, v191
    s_waitcnt lgkmcnt(0)
    v_fmac_f32 v64, v200, v208
    v_fmac_f32 v65, v200, v209
    v_fmac_f32 v66, v200, v210
    v_fmac_f32 v67, v200, v211
    v_fmac_f32 v68, v200, v212
    v_fmac_f32 v69, v200, v213
    v_fmac_f32 v70, v200, v214
    v_fmac_f32 v71, v200, v215
    v_fmac_f32 v72, v201, v208
    v_fmac_f32 v73, v201, v209
    v_fmac_f32 v74, v201, v210
    v_fmac_f32 v75, v201, v211
    v_fmac_f32 v76, v201, v212
    v_fmac_f32 v77, v201, v213
    v_fmac_f32 v78, v201, v214
    v_fmac_f32 v79, v201, v215
    v_fmac_f32 v80, v202, v208
    v_fmac_f32 v81, v202, v209
    v_fmac_f32 v82, v202, v210
    v_fmac_f32 v83, v202, v211
    v_fmac_f32 v84, v202, v212
    v_fmac_f32 v85, v202, v213
    v_fmac_f32 v86, v202, v214
    v_fmac_f32 v87, v202, v215
    v_fmac_f32 v88, v203, v208
    v_fmac_f32 v89, v203, v209
    v_fmac_f32 v90, v203, v210
    v_fmac_f32 v91, v203, v211
    v_fmac_f32 v92, v203, v212
    v_fmac_f32 v93, v203, v213
    v_fmac_f32 v94, v203, v214
    v_fmac_f32 v95, v203, v215
    v_fmac_f32 v96, v204, v208
    v_fmac_f32 v97, v204, v209
    v_fmac_f32 v98, v204, v210
    v_fmac_f32 v99, v204, v211
    v_fmac_f32 v100, v204, v212
    v_fmac_f32 v101, v204, v213
    v_fmac_f32 v102, v204, v214
    v_fmac_f32 v103, v204, v215
    v_fmac_f32 v104, v205, v208
    v_fmac_f32 v105, v205, v209
    v_fmac_f32 v106, v205, v210
    v_fmac_f32 v107, v205, v211
    v_fmac_f32 v108, v205, v212
    v_fmac_f32 v109, v205, v213
    v_fmac_f32 v110, v205, v214
    v_fmac_f32 v111, v205, v215
    v_fmac_f32 v112, v206, v208
    v_fmac_f32 v113, v206, v209
    v_fmac_f32 v114, v206, v210
    v_fmac_f32 v115, v206, v211
    v_fmac_f32 v116, v206, v212
    v_fmac_f32 v117, v206, v213
    v_fmac_f32 v118, v206, v214
    v_fmac_f32 v119, v206, v215
    v_fmac_f32 v120, v207, v208
    v_fmac_f32 v121, v207, v209
    v_fmac_f32 v122, v207, v210
    v_fmac_f32 v123, v207, v211
    v_fmac_f32 v124, v207, v212
    v_fmac_f32 v125, v207, v213
    v_fmac_f32 v126, v207, v214
    v_fmac_f32 v127, v207, v215
    ds_read_b128 v[200:203], v7 offset:16384
    ds_read_b128 v[204:207], v7 offset:16400
    v_lshlrev_b32 v208, 16, v192
    v_and_b32 v209, 0xffff0000, v192
    v_lshlrev_b32 v210, 16, v193
    v_and_b32 v211, 0xffff0000, v193
    v_lshlrev_b32 v212, 16, v194
    v_and_b32 v213, 0xffff0000, v194
    v_lshlrev_b32 v214, 16, v195
    v_and_b32 v215, 0xffff0000, v195
    s_waitcnt lgkmcnt(0)
    v_fmac_f32 v64, v200, v208
    v_fmac_f32 v65, v200, v209
    v_fmac_f32 v66, v200, v210
    v_fmac_f32 v67, v200, v211
    v_fmac_f32 v68, v200, v212
    v_fmac_f32 v69, v200, v213
    v_fmac_f32 v70, v200, v214
    v_fmac_f32 v71, v200, v215
    v_fmac_f32 v72, v201, v208
    v_fmac_f32 v73, v201, v209
    v_fmac_f32 v74, v201, v210
    v_fmac_f32 v75, v201, v211
    v_fmac_f32 v76, v201, v212
    v_fmac_f32 v77, v201, v213
    v_fmac_f32 v78, v201, v214
    v_fmac_f32 v79, v201, v215
    v_fmac_f32 v80, v202, v208
    v_fmac_f32 v81, v202, v209
    v_fmac_f32 v82, v202, v210
    v_fmac_f32 v83, v202, v211
    v_fmac_f32 v84, v202, v212
    v_fmac_f32 v85, v202, v213
    v_fmac_f32 v86, v202, v214
    v_fmac_f32 v87, v202, v215
    v_fmac_f32 v88, v203, v208
    v_fmac_f32 v89, v203, v209
    v_fmac_f32 v90, v203, v210
    v_fmac_f32 v91, v203, v211
    v_fmac_f32 v92, v203, v212
    v_fmac_f32 v93, v203, v213
    v_fmac_f32 v94, v203, v214
    v_fmac_f32 v95, v203, v215
    v_fmac_f32 v96, v204, v208
    v_fmac_f32 v97, v204, v209
    v_fmac_f32 v98, v204, v210
    v_fmac_f32 v99, v204, v211
    v_fmac_f32 v100, v204, v212
    v_fmac_f32 v101, v204, v213
    v_fmac_f32 v102, v204, v214
    v_fmac_f32 v103, v204, v215
    v_fmac_f32 v104, v205, v208
    v_fmac_f32 v105, v205, v209
    v_fmac_f32 v106, v205, v210
    v_fmac_f32 v107, v205, v211
    v_fmac_f32 v108, v205, v212
    v_fmac_f32 v109, v205, v213
    v_fmac_f32 v110, v205, v214
    v_fmac_f32 v111, v205, v215
    v_fmac_f32 v112, v206, v208
    v_fmac_f32 v113, v206, v209
    v_fmac_f32 v114, v206, v210
    v_fmac_f32 v115, v206, v211
    v_fmac_f32 v116, v206, v212
    v_fmac_f32 v117, v206, v213
    v_fmac_f32 v118, v206, v214
    v_fmac_f32 v119, v206, v215
    v_fmac_f32 v120, v207, v208
    v_fmac_f32 v121, v207, v209
    v_fmac_f32 v122, v207, v210
    v_fmac_f32 v123, v207, v211
    v_fmac_f32 v124, v207, v212
    v_fmac_f32 v125, v207, v213
    v_fmac_f32 v126, v207, v214
    v_fmac_f32 v127, v207, v215
    ds_read_b128 v[200:203], v7 offset:17408
    ds_read_b128 v[204:207], v7 offset:17424
    v_lshlrev_b32 v208, 16, v196
    v_and_b32 v209, 0xffff0000, v196
    v_lshlrev_b32 v210, 16, v197
    v_and_b32 v211, 0xffff0000, v197
    v_lshlrev_b32 v212, 16, v198
    v_and_b32 v213, 0xffff0000, v198
    v_lshlrev_b32 v214, 16, v199
    v_and_b32 v215, 0xffff0000, v199
    s_waitcnt lgkmcnt(0)
    v_fmac_f32 v64, v200, v208
    v_fmac_f32 v65, v200, v209
    v_fmac_f32 v66, v200, v210
    v_fmac_f32 v67, v200, v211
    v_fmac_f32 v68, v200, v212
    v_fmac_f32 v69, v200, v213
    v_fmac_f32 v70, v200, v214
    v_fmac_f32 v71, v200, v215
    v_fmac_f32 v72, v201, v208
    v_fmac_f32 v73, v201, v209
    v_fmac_f32 v74, v201, v210
    v_fmac_f32 v75, v201, v211
    v_fmac_f32 v76, v201, v212
    v_fmac_f32 v77, v201, v213
    v_fmac_f32 v78, v201, v214
    v_fmac_f32 v79, v201, v215
    v_fmac_f32 v80, v202, v208
    v_fmac_f32 v81, v202, v209
    v_fmac_f32 v82, v202, v210
    v_fmac_f32 v83, v202, v211
    v_fmac_f32 v84, v202, v212
    v_fmac_f32 v85, v202, v213
    v_fmac_f32 v86, v202, v214
    v_fmac_f32 v87, v202, v215
    v_fmac_f32 v88, v203, v208
    v_fmac_f32 v89, v203, v209
    v_fmac_f32 v90, v203, v210
    v_fmac_f32 v91, v203, v211
    v_fmac_f32 v92, v203, v212
    v_fmac_f32 v93, v203, v213
    v_fmac_f32 v94, v203, v214
    v_fmac_f32 v95, v203, v215
    v_fmac_f32 v96, v204, v208
    v_fmac_f32 v97, v204, v209
    v_fmac_f32 v98, v204, v210
    v_fmac_f32 v99, v204, v211
    v_fmac_f32 v100, v204, v212
    v_fmac_f32 v101, v204, v213
    v_fmac_f32 v102, v204, v214
    v_fmac_f32 v103, v204, v215
    v_fmac_f32 v104, v205, v208
    v_fmac_f32 v105, v205, v209
    v_fmac_f32 v106, v205, v210
    v_fmac_f32 v107, v205, v211
    v_fmac_f32 v108, v205, v212
    v_fmac_f32 v109, v205, v213
    v_fmac_f32 v110, v205, v214
    v_fmac_f32 v111, v205, v215
    v_fmac_f32 v112, v206, v208
    v_fmac_f32 v113, v206, v209
    v_fmac_f32 v114, v206, v210
    v_fmac_f32 v115, v206, v211
    v_fmac_f32 v116, v206, v212
    v_fmac_f32 v117, v206, v213
    v_fmac_f32 v118, v206, v214
    v_fmac_f32 v119, v206, v215
    v_fmac_f32 v120, v207, v208
    v_fmac_f32 v121, v207, v209
    v_fmac_f32 v122, v207, v210
    v_fmac_f32 v123, v207, v211
    v_fmac_f32 v124, v207, v212
    v_fmac_f32 v125, v207, v213
    v_fmac_f32 v126, v207, v214
    v_fmac_f32 v127, v207, v215
    v_lshlrev_b32 v8, 11, v5
    v_lshl_add_u32 v8, v4, 5, v8
    v_add_u32 v8, 18432, v8
    ds_write_b128 v8, v[64:67] offset:0
    ds_write_b128 v8, v[68:71] offset:16
    ds_write_b128 v8, v[72:75] offset:256
    ds_write_b128 v8, v[76:79] offset:272
    ds_write_b128 v8, v[80:83] offset:512
    ds_write_b128 v8, v[84:87] offset:528
    ds_write_b128 v8, v[88:91] offset:768
    ds_write_b128 v8, v[92:95] offset:784
    ds_write_b128 v8, v[96:99] offset:1024
    ds_write_b128 v8, v[100:103] offset:1040
    ds_write_b128 v8, v[104:107] offset:1280
    ds_write_b128 v8, v[108:111] offset:1296
    ds_write_b128 v8, v[112:115] offset:1536
    ds_write_b128 v8, v[116:119] offset:1552
    ds_write_b128 v8, v[120:123] offset:1792
    ds_write_b128 v8, v[124:127] offset:1808
    s_waitcnt lgkmcnt(0)
    s_barrier
    v_lshrrev_b32 v9, 5, v0
    v_and_b32 v10, 31, v0
    v_lshlrev_b32 v11, 8, v9
    v_lshl_add_u32 v11, v10, 3, v11
    v_add_u32 v11, 18432, v11
    ds_read_b64 v[64:65], v11 offset:0
    ds_read_b64 v[66:67], v11 offset:2048
    ds_read_b64 v[68:69], v11 offset:4096
    ds_read_b64 v[70:71], v11 offset:6144
    ds_read_b64 v[72:73], v11 offset:8192
    ds_read_b64 v[74:75], v11 offset:10240
    ds_read_b64 v[76:77], v11 offset:12288
    ds_read_b64 v[78:79], v11 offset:14336
    ds_read_b64 v[80:81], v11 offset:16384
    ds_read_b64 v[82:83], v11 offset:18432
    ds_read_b64 v[84:85], v11 offset:20480
    ds_read_b64 v[86:87], v11 offset:22528
    ds_read_b64 v[88:89], v11 offset:24576
    ds_read_b64 v[90:91], v11 offset:26624
    ds_read_b64 v[92:93], v11 offset:28672
    ds_read_b64 v[94:95], v11 offset:30720
    ds_read_b64 v[96:97], v11 offset:32768
    ds_read_b64 v[98:99], v11 offset:34816
    ds_read_b64 v[100:101], v11 offset:36864
    ds_read_b64 v[102:103], v11 offset:38912
    ds_read_b64 v[104:105], v11 offset:40960
    ds_read_b64 v[106:107], v11 offset:43008
    ds_read_b64 v[108:109], v11 offset:45056
    ds_read_b64 v[110:111], v11 offset:47104
    ds_read_b64 v[112:113], v11 offset:49152
    ds_read_b64 v[114:115], v11 offset:51200
    ds_read_b64 v[116:117], v11 offset:53248
    ds_read_b64 v[118:119], v11 offset:55296
    ds_read_b64 v[120:121], v11 offset:57344
    ds_read_b64 v[122:123], v11 offset:59392
    ds_read_b64 v[124:125], v11 offset:61440
    ds_read_b64 v[126:127], v11 offset:63488
    s_waitcnt lgkmcnt(0)
    v_add_f32 v64, v64, v66
    v_add_f32 v65, v65, v67
    v_add_f32 v64, v64, v68
    v_add_f32 v65, v65, v69
    v_add_f32 v64, v64, v70
    v_add_f32 v65, v65, v71
    v_add_f32 v64, v64, v72
    v_add_f32 v65, v65, v73
    v_add_f32 v64, v64, v74
    v_add_f32 v65, v65, v75
    v_add_f32 v64, v64, v76
    v_add_f32 v65, v65, v77
    v_add_f32 v64, v64, v78
    v_add_f32 v65, v65, v79
    v_add_f32 v64, v64, v80
    v_add_f32 v65, v65, v81
    v_add_f32 v64, v64, v82
    v_add_f32 v65, v65, v83
    v_add_f32 v64, v64, v84
    v_add_f32 v65, v65, v85
    v_add_f32 v64, v64, v86
    v_add_f32 v65, v65, v87
    v_add_f32 v64, v64, v88
    v_add_f32 v65, v65, v89
    v_add_f32 v64, v64, v90
    v_add_f32 v65, v65, v91
    v_add_f32 v64, v64, v92
    v_add_f32 v65, v65, v93
    v_add_f32 v64, v64, v94
    v_add_f32 v65, v65, v95
    v_add_f32 v64, v64, v96
    v_add_f32 v65, v65, v97
    v_add_f32 v64, v64, v98
    v_add_f32 v65, v65, v99
    v_add_f32 v64, v64, v100
    v_add_f32 v65, v65, v101
    v_add_f32 v64, v64, v102
    v_add_f32 v65, v65, v103
    v_add_f32 v64, v64, v104
    v_add_f32 v65, v65, v105
    v_add_f32 v64, v64, v106
    v_add_f32 v65, v65, v107
    v_add_f32 v64, v64, v108
    v_add_f32 v65, v65, v109
    v_add_f32 v64, v64, v110
    v_add_f32 v65, v65, v111
    v_add_f32 v64, v64, v112
    v_add_f32 v65, v65, v113
    v_add_f32 v64, v64, v114
    v_add_f32 v65, v65, v115
    v_add_f32 v64, v64, v116
    v_add_f32 v65, v65, v117
    v_add_f32 v64, v64, v118
    v_add_f32 v65, v65, v119
    v_add_f32 v64, v64, v120
    v_add_f32 v65, v65, v121
    v_add_f32 v64, v64, v122
    v_add_f32 v65, v65, v123
    v_add_f32 v64, v64, v124
    v_add_f32 v65, v65, v125
    v_add_f32 v64, v64, v126
    v_add_f32 v65, v65, v127
    s_mul_i32 s40, s31, 18432
    s_lshl_b32 s41, s30, 8
    s_add_u32 s40, s40, s41
    s_add_u32 s40, s40, 1966080
    s_mov_b32 s41, 2304
    v_mul_lo_u32 v12, v9, s41
    v_lshl_add_u32 v12, v10, 3, v12
    buffer_store_dwordx2 v[64:65], v12, s[12:15], s40 offen
    s_waitcnt vmcnt(0)
L_end_kf_kernel:
    s_endpgm
.globl kg_kernel
.p2align 8
.type kg_kernel,@function
kg_kernel:
    s_cmp_ge_u32 s2, 18
    s_cbranch_scc1 L_end_kg_kernel
    s_load_dwordx2 s[36:37], s[0:1], 104
    s_load_dwordx2 s[38:39], s[0:1], 88
    s_waitcnt lgkmcnt(0)
    s_mov_b32 s12, s36
    s_and_b32 s13, s37, 0xffff
    s_mov_b32 s14, 0x40000000
    s_mov_b32 s15, 0x20000
    s_mov_b32 s16, s38
    s_and_b32 s17, s39, 0xffff
    s_mov_b32 s18, 0x2400
    s_mov_b32 s19, 0x20000
    s_lshl_b32 s40, s2, 8
    v_add_u32 v1, s40, v0
    v_lshlrev_b32 v2, 2, v1
    s_mov_b32 s48, 1966080
    buffer_load_dword v8, v2, s[12:15], s48 offen
    s_mov_b32 s49, 1984512
    buffer_load_dword v9, v2, s[12:15], s49 offen
    s_mov_b32 s50, 2002944
    buffer_load_dword v10, v2, s[12:15], s50 offen
    s_mov_b32 s51, 2021376
    buffer_load_dword v11, v2, s[12:15], s51 offen
    s_mov_b32 s52, 2039808
    buffer_load_dword v12, v2, s[12:15], s52 offen
    s_mov_b32 s53, 2058240
    buffer_load_dword v13, v2, s[12:15], s53 offen
    s_mov_b32 s54, 2076672
    buffer_load_dword v14, v2, s[12:15], s54 offen
    s_mov_b32 s55, 2095104
    buffer_load_dword v15, v2, s[12:15], s55 offen
    s_mov_b32 s41, 1572864
    buffer_load_dword v16, v2, s[12:15], s41 offen
    s_mov_b32 s42, 7456541
    v_mul_hi_u32 v3, v1, s42
    v_mul_u32_u24 v3, 2880, v3
    v_add_u32 v3, v3, v1
    v_add_u32 v3, 2880, v3
    v_lshlrev_b32 v3, 2, v3
    buffer_load_dword v17, v3, s[12:15], 0 offen offset:0
    s_waitcnt vmcnt(0)
    v_add_f32 v8, v8, v9
    v_add_f32 v8, v8, v10
    v_add_f32 v8, v8, v11
    v_add_f32 v8, v8, v12
    v_add_f32 v8, v8, v13
    v_add_f32 v8, v8, v14
    v_add_f32 v8, v8, v15
    v_fma_f32 v8, v8, v17, v16
    v_cvt_pk_bf16_f32 v8, v8, v8
    v_lshlrev_b32 v2, 1, v1
    buffer_store_short v8, v2, s[16:19], 0 offen
    s_waitcnt vmcnt(0)
L_end_kg_kernel:
    s_endpgm
.section .rodata,"a"
.p2align 6
.amdhsa_kernel ka_kernel
  .amdhsa_next_free_vgpr 256
  .amdhsa_next_free_sgpr 102
  .amdhsa_accum_offset 256
  .amdhsa_group_segment_fixed_size 0
  .amdhsa_kernarg_size 112
  .amdhsa_user_sgpr_count 2
  .amdhsa_user_sgpr_kernarg_segment_ptr 1
  .amdhsa_system_sgpr_workgroup_id_x 1
.end_amdhsa_kernel
.amdhsa_kernel kb_kernel
  .amdhsa_next_free_vgpr 256
  .amdhsa_next_free_sgpr 102
  .amdhsa_accum_offset 256
  .amdhsa_group_segment_fixed_size 0
  .amdhsa_kernarg_size 112
  .amdhsa_user_sgpr_count 2
  .amdhsa_user_sgpr_kernarg_segment_ptr 1
  .amdhsa_system_sgpr_workgroup_id_x 1
.end_amdhsa_kernel
.amdhsa_kernel kc_kernel
  .amdhsa_next_free_vgpr 128
  .amdhsa_next_free_sgpr 102
  .amdhsa_accum_offset 128
  .amdhsa_group_segment_fixed_size 0
  .amdhsa_kernarg_size 112
  .amdhsa_user_sgpr_count 2
  .amdhsa_user_sgpr_kernarg_segment_ptr 1
  .amdhsa_system_sgpr_workgroup_id_x 1
.end_amdhsa_kernel
.amdhsa_kernel kd_kernel
  .amdhsa_next_free_vgpr 256
  .amdhsa_next_free_sgpr 102
  .amdhsa_accum_offset 256
  .amdhsa_group_segment_fixed_size 0
  .amdhsa_kernarg_size 112
  .amdhsa_user_sgpr_count 2
  .amdhsa_user_sgpr_kernarg_segment_ptr 1
  .amdhsa_system_sgpr_workgroup_id_x 1
.end_amdhsa_kernel
.amdhsa_kernel ke_kernel
  .amdhsa_next_free_vgpr 256
  .amdhsa_next_free_sgpr 102
  .amdhsa_accum_offset 256
  .amdhsa_group_segment_fixed_size 0
  .amdhsa_kernarg_size 112
  .amdhsa_user_sgpr_count 2
  .amdhsa_user_sgpr_kernarg_segment_ptr 1
  .amdhsa_system_sgpr_workgroup_id_x 1
.end_amdhsa_kernel
.amdhsa_kernel kf_kernel
  .amdhsa_next_free_vgpr 256
  .amdhsa_next_free_sgpr 102
  .amdhsa_accum_offset 256
  .amdhsa_group_segment_fixed_size 0
  .amdhsa_kernarg_size 112
  .amdhsa_user_sgpr_count 2
  .amdhsa_user_sgpr_kernarg_segment_ptr 1
  .amdhsa_system_sgpr_workgroup_id_x 1
.end_amdhsa_kernel
.amdhsa_kernel kg_kernel
  .amdhsa_next_free_vgpr 256
  .amdhsa_next_free_sgpr 102
  .amdhsa_accum_offset 256
  .amdhsa_group_segment_fixed_size 0
  .amdhsa_kernarg_size 112
  .amdhsa_user_sgpr_count 2
  .amdhsa_user_sgpr_kernarg_segment_ptr 1
  .amdhsa_system_sgpr_workgroup_id_x 1
.end_amdhsa_kernel
```
